```python
import torch

def _softmax(x, axis=-1):
    return torch.softmax(x, dim=axis)
def _gelu(x):
    return torch.nn.functional.gelu(x, approximate="tanh")
def _silu(x):
    return torch.nn.functional.silu(x)
def _sigmoid(x):
    return torch.sigmoid(x)
def _layernorm(x, axis=-1, eps=1e-5):
    m = x.mean(dim=axis, keepdim=True)
    v = x.var(dim=axis, keepdim=True, unbiased=False)
    return (x - m) / torch.sqrt(v + eps)
def _scatter_add(tgt, idx, src, axis=0):
    return tgt.clone().index_add_(axis, idx, src)
def _segment_sum(src, seg, n):
    out = torch.zeros((n,) + src.shape[1:], dtype=src.dtype)
    return out.index_add_(0, seg, src)
def _pad(x, pw):
    flat = tuple(v for pair in reversed(pw) for v in pair)
    return torch.nn.functional.pad(x, flat)

kernel_name = 'gated_mix__mha_block__geglu_ffn__prompt'

def setup_inputs():

    _w = (lambda a: (lambda t: t.to(torch.bfloat16) if t.is_floating_point() else t)(torch.as_tensor(a)))
    def _A_setup():
        B, S, D, H = 1, 2048, 640, 32
        return {
            "x": _w((lambda *s: torch.randn(*s, dtype=torch.bfloat16) * 0.05)(B, S, D)),
            "wqkv": _w((lambda *s: torch.randn(*s, dtype=torch.bfloat16) * 0.8)(D, 3 * D)),
            "wo": _w((lambda *s: torch.randn(*s, dtype=torch.bfloat16) * 0.05)(D, D)),
        }
    _A_in = _A_setup()

    def _B_setup():
        B, S, D, F = 1, 2048, 640, 1536
        return {
            "x": _w((lambda *s: torch.randn(*s, dtype=torch.bfloat16) * 0.05)(B, S, D)),
            "w_gate": _w((lambda *s: torch.randn(*s, dtype=torch.bfloat16) * 0.1)(D, F)),
            "w_up": _w((lambda *s: torch.randn(*s, dtype=torch.bfloat16) * 0.1)(D, F)),
            "w_down": _w((lambda *s: torch.randn(*s, dtype=torch.bfloat16) * 0.1)(F, D)),
        }
    _B_in = _B_setup()

    return {
        "A_x": _A_in["x"],
        "A_wqkv": _A_in["wqkv"],
        "A_wo": _A_in["wo"],
        "B_x": _B_in["x"],
        "B_w_gate": _B_in["w_gate"],
        "B_w_up": _B_in["w_up"],
        "B_w_down": _B_in["w_down"],
        "gate_w": _w((lambda *s: torch.randn(*s, dtype=torch.bfloat16) * 0.05)(640) * 16.0),
    }

def reference(A_x, A_wqkv, A_wo, B_x, B_w_gate, B_w_up, B_w_down, gate_w):
    def _A_ref(x, wqkv, wo):
        B, S, D = x.shape
        H = 32
        Dh = D // H
        qkv = (lambda x, *d: x.permute(*d))((x @ wqkv).reshape(B, S, 3, H, Dh), 2, 0, 3, 1, 4)
        q, k, v = qkv[0], qkv[1], qkv[2]
        scores = torch.einsum("bhqd,bhkd->bhqk", q, k) * (Dh ** -0.5)
        p = _softmax(scores, axis=-1)
        o = torch.einsum("bhqk,bhkd->bhqd", p, v)
        return (lambda x, *d: x.permute(*d))(o, 0, 2, 1, 3).reshape(B, S, D) @ wo

    def _B_ref(x, w_gate, w_up, w_down):
        return (_gelu(x @ w_gate) * (x @ w_up)) @ w_down

    x = A_x
    g = _sigmoid((x * gate_w).sum(-1, keepdims=True))
    a = _A_ref(x, A_wqkv, A_wo)
    b = _B_ref(x, B_w_gate, B_w_up, B_w_down)
    return g * a + (1 - g) * b
```

```asm
; @launch kernel=k1_kernel grid=(256,1,1) block=(768,1,1) lds=163840
.amdgcn_target "amdgcn-amd-amdhsa--gfx950"
.text
.globl k1_kernel
.p2align 8
.type k1_kernel,@function
k1_kernel:
    s_cmp_ge_u32 s2, 256
    s_cbranch_scc1 L_end
    s_load_dwordx4 s[4:7], s[0:1], 0
    s_load_dwordx8 s[8:15], s[0:1], 32
    s_load_dwordx2 s[18:19], s[0:1], 80
    v_lshrrev_b32 v2, 6, v0
    v_and_b32 v1, 63, v0
    v_readfirstlane_b32 s96, v2
    s_bfe_u32 s24, s2, 0x10002
    s_lshl_b32 s24, s24, 3
    s_bfe_u32 s25, s2, 0x30003
    s_add_u32 s21, s24, s25
    s_and_b32 s24, s2, 3
    s_lshl_b32 s24, s24, 2
    s_lshr_b32 s25, s2, 6
    s_add_u32 s22, s24, s25
    s_lshr_b32 s23, s22, 1
    s_cmp_ge_u32 s96, 8
    s_cbranch_scc0 L_comp
    s_setprio 3
    s_cmp_ge_u32 s96, 10
    s_cbranch_scc1 L_aux2
    s_mul_i32 s24, s23, 384
    s_lshl_b32 s25, s23, 9
    s_add_u32 s26, s24, 256
    s_add_u32 s27, s24, 128
    s_add_u32 s98, s25, 128
    s_add_u32 s99, s25, 256
    s_add_u32 s100, s25, 384
    s_bitcmp1_b32 s22, 0
    s_cselect_b32 s97, s26, s24
    s_cselect_b32 s98, s98, s27
    s_cselect_b32 s99, s99, s27
    s_cselect_b32 s100, s100, s25
    s_cmp_eq_u32 s22, 15
    s_cselect_b32 s99, 1073741824, s99
    s_cselect_b32 s100, 1073741824, s100
    s_and_b32 s56, s96, 1
    v_lshrrev_b32 v2, 3, v1
    v_and_b32 v3, 7, v1
    v_lshrrev_b32 v4, 4, v1
    s_lshl_b32 s24, s21, 1
    s_add_u32 s24, s24, s56
    s_mul_i32 s20, s24, 81920
    v_mul_u32_u24 v5, 1280, v2
    v_xor_b32 v6, v3, v4
    v_lshl_add_u32 v10, v6, 4, v5
    v_xor_b32 v11, 64, v10
    v_add_u32 v11, 9216, v11
    v_add_u32 v12, 18432, v10
    v_add_u32 v13, 18432, v11
    v_and_b32 v4, 1, v4
    v_lshlrev_b32 v4, 2, v4
    v_xor_b32 v4, v4, v3
    v_lshlrev_b32 v4, 4, v4
    s_lshl_b32 s24, s56, 4
    v_add_u32 v5, s24, v2
    v_mul_u32_u24 v6, 3072, v5
    v_add_u32 v14, v6, v4
    v_xor_b32 v15, 32, v14
    v_add_u32 v15, 23552, v15
    v_mul_u32_u24 v6, 3840, v5
    v_add_u32 v16, v6, v4
    v_xor_b32 v17, 32, v16
    v_add_u32 v17, 29696, v17
    s_bitcmp1_b32 s22, 0
    s_cselect_b64 vcc, -1, 0
    v_cndmask_b32 v18, v14, v16, vcc
    v_cndmask_b32 v19, v15, v17, vcc
    s_lshl_b32 s57, s56, 13
    s_lshl_b32 s56, s56, 11
    s_and_b32 s24, s22, 3
    s_and_b32 s101, s21, 7
    s_add_u32 s24, s24, s101
    s_lshl_b32 s24, s24, 1
    s_lshl_b32 s101, s101, 2
    s_mov_b32 s58, 1985229328
    s_mov_b32 s59, 1412567192
    s_lshr_b32 s25, 1198372, s24
    s_and_b32 s25, s25, 3
    s_cmp_eq_u32 s25, 1
    s_cselect_b32 s26, 6386225, 0
    s_xor_b32 s58, s58, s26
    s_cmp_eq_u32 s25, 2
    s_cselect_b32 s26, 1532690, 0
    s_xor_b32 s58, s58, s26
    s_waitcnt lgkmcnt(0)
    s_mov_b32 s52, s4
    s_and_b32 s53, s5, 0xffff
    s_mov_b32 s54, 2621440
    s_mov_b32 s55, 0x00020000
    s_bfe_u32 s101, s58, 262144
    s_lshl_b32 s101, s101, 7
    s_add_u32 s24, s20, s101
    s_add_u32 m0, s57, 102400
    s_nop 0
    buffer_load_dwordx4 v10, s[52:55], s24 offen offset:0 lds
    buffer_load_dwordx4 v11, s[52:55], s24 offen offset:1024 lds
    buffer_load_dwordx4 v12, s[52:55], s24 offen offset:2048 lds
    buffer_load_dwordx4 v13, s[52:55], s24 offen offset:3072 lds
    s_add_u32 m0, s57, 106496
    s_add_u32 s24, s24, 40960
    buffer_load_dwordx4 v10, s[52:55], s24 offen offset:0 lds
    buffer_load_dwordx4 v11, s[52:55], s24 offen offset:1024 lds
    buffer_load_dwordx4 v12, s[52:55], s24 offen offset:2048 lds
    buffer_load_dwordx4 v13, s[52:55], s24 offen offset:3072 lds
    s_mov_b32 s28, s8
    s_and_b32 s29, s9, 0xffff
    s_mov_b32 s30, 1966080
    s_mov_b32 s31, 0x00020000
    s_mov_b32 s36, s10
    s_and_b32 s37, s11, 0xffff
    s_mov_b32 s38, 1966080
    s_mov_b32 s39, 0x00020000
    s_mov_b32 s48, s6
    s_and_b32 s49, s7, 0xffff
    s_mov_b32 s50, 2457600
    s_mov_b32 s51, 0x00020000
    s_bitcmp1_b32 s22, 0
    s_cselect_b32 s40, s48, s28
    s_cselect_b32 s41, s49, s29
    s_cselect_b32 s42, s50, s30
    s_mov_b32 s43, 0x00020000
    s_cselect_b32 s44, s48, s36
    s_cselect_b32 s45, s49, s37
    s_cselect_b32 s46, s50, s38
    s_mov_b32 s47, 0x00020000
    s_cselect_b32 s3, 768, 0
    s_add_u32 s3, s3, 3072
    s_bfe_u32 s101, s58, 262144
    s_lshl_b32 s101, s101, 6
    s_add_u32 m0, s56, 151552
    s_mul_i32 s24, s101, s3
    s_add_u32 s24, s24, s98
    buffer_load_dwordx4 v18, s[40:43], s24 offen offset:0 lds
    buffer_load_dwordx4 v19, s[40:43], s24 offen offset:1024 lds
    s_add_u32 m0, s56, 159744
    s_mul_i32 s24, s101, s3
    s_add_u32 s24, s24, s99
    buffer_load_dwordx4 v18, s[44:47], s24 offen offset:0 lds
    buffer_load_dwordx4 v19, s[44:47], s24 offen offset:1024 lds
    s_add_u32 m0, s56, 155648
    s_mul_i32 s24, s101, 3840
    s_add_u32 s24, s24, s100
    buffer_load_dwordx4 v16, s[48:51], s24 offen offset:0 lds
    buffer_load_dwordx4 v17, s[48:51], s24 offen offset:1024 lds
    s_bfe_u32 s101, s58, 262144
    s_lshl_b32 s101, s101, 6
    s_add_u32 s101, s101, 32
    s_add_u32 m0, s56, 139264
    s_mul_i32 s24, s101, s3
    s_add_u32 s24, s24, s98
    buffer_load_dwordx4 v18, s[40:43], s24 offen offset:0 lds
    buffer_load_dwordx4 v19, s[40:43], s24 offen offset:1024 lds
    s_add_u32 m0, s56, 147456
    s_mul_i32 s24, s101, s3
    s_add_u32 s24, s24, s99
    buffer_load_dwordx4 v18, s[44:47], s24 offen offset:0 lds
    buffer_load_dwordx4 v19, s[44:47], s24 offen offset:1024 lds
    s_add_u32 m0, s56, 143360
    s_mul_i32 s24, s101, 3840
    s_add_u32 s24, s24, s100
    buffer_load_dwordx4 v16, s[48:51], s24 offen offset:0 lds
    buffer_load_dwordx4 v17, s[48:51], s24 offen offset:1024 lds
    s_and_b32 s24, s22, 3
    s_and_b32 s101, s21, 7
    s_add_u32 s24, s24, s101
    s_lshl_b32 s24, s24, 1
    s_lshl_b32 s101, s101, 2
    s_lshr_b32 s25, 2417892, s24
    s_and_b32 s25, s25, 3
    s_cmp_eq_u32 s25, 1
    s_cselect_b32 s26, 4043309056, 0
    s_cselect_b32 s27, 241, 0
    s_xor_b32 s58, s58, s26
    s_xor_b32 s59, s59, s27
    s_cmp_eq_u32 s25, 2
    s_cselect_b32 s26, 3992977408, 0
    s_cselect_b32 s27, 238, 0
    s_xor_b32 s58, s58, s26
    s_xor_b32 s59, s59, s27
    s_cmp_eq_u32 s25, 3
    s_cselect_b32 s26, 520093696, 0
    s_cselect_b32 s27, 31, 0
    s_xor_b32 s58, s58, s26
    s_xor_b32 s59, s59, s27
    s_lshr_b32 s25, 273953296, s101
    s_and_b32 s25, s25, 15
    s_cmp_eq_u32 s25, 1
    s_cselect_b32 s27, 1366372608, 0
    s_xor_b32 s59, s59, s27
    s_cmp_eq_u32 s25, 2
    s_cselect_b32 s27, 1147544064, 0
    s_xor_b32 s59, s59, s27
    s_cmp_eq_u32 s25, 3
    s_cselect_b32 s27, 1966560000, 0
    s_xor_b32 s59, s59, s27
    s_cmp_eq_u32 s25, 4
    s_cselect_b32 s27, 1713521664, 0
    s_xor_b32 s59, s59, s27
    s_cmp_eq_u32 s25, 5
    s_cselect_b32 s27, 387126528, 0
    s_xor_b32 s59, s59, s27
    s_mov_b32 s32, s18
    s_and_b32 s33, s19, 0xffff
    s_mov_b32 s34, 31457280
    s_mov_b32 s35, 0x00020000
    s_and_b32 s24, s2, 7
    s_lshl_b32 s24, s24, 2
    s_lshr_b32 s25, s2, 6
    s_add_u32 s16, s24, s25
    s_bfe_u32 s17, s2, 0x30003
    s_and_b32 s13, s16, 1
    s_lshr_b32 s26, s16, 1
    s_mul_i32 s26, s26, 5
    s_lshl_b32 s27, s13, 1
    s_add_u32 s26, s26, s27
    s_lshl_b32 s10, s26, 9
    s_memrealtime s[14:15]
    s_and_b32 s19, s96, 3
    s_lshl_b32 s25, s19, 1
    v_lshlrev_b32 v164, 4, v1
    s_mul_i32 s24, s25, 123392
    s_add_u32 s24, s24, s10
    v_add_u32 v88, s24, v164
    v_and_b32 v165, 511, v164
    v_lshrrev_b32 v167, 9, v164
    v_mul_u32_u24 v166, 39936, v167
    v_add3_u32 v89, v165, v166, s24
    v_lshlrev_b32 v166, 6, v167
    v_add_u32 v166, 64, v166
    v_xor_b32 v166, v166, v164
    s_add_u32 s24, s24, 39424
    v_add_u32 v90, s24, v166
    s_mul_i32 s4, s19, 3136
    s_add_u32 s4, s4, 110592
    s_mov_b32 s8, 0x01010101
    s_mov_b32 s9, 0x01010101
    v_lshrrev_b32 v164, 3, v1
    v_and_b32 v165, 7, v1
    v_lshlrev_b32 v165, 2, v165
    v_lshl_add_u32 v165, v164, 8, v165
    s_lshr_b32 s24, s19, 1
    s_lshl_b32 s24, s24, 5
    s_lshl_b32 s5, s16, 11
    s_add_u32 s5, s5, s24
    s_add_u32 s5, s5, 22282240
    s_lshl_b32 s13, s17, 3
    s_lshl_b64 s[6:7], 3, s13
    s_lshr_b32 s13, s13, 1
    s_mul_i32 s11, s17, 987136
    s_mul_i32 s12, s19, 3072
    v_min_u32 v163, 7, v1
    v_mul_u32_u24 v163, 3136, v163
    v_add_u32 v163, 110592, v163
    v_mov_b32 v152, 0x3f803f80
    v_mov_b32 v153, 0x3f803f80
    v_mov_b32 v154, 0x3c00
    v_mov_b32 v155, 0
    v_mov_b32 v156, 0
    v_mov_b32 v157, 0
    v_mov_b32 v158, 15952
    v_mov_b32 v159, 0
    v_add_u32 v96, 0, v1
    v_mul_u32_u24 v97, 6554, v96
    v_lshrrev_b32 v97, 16, v97
    v_mad_i32_i24 v96, v97, -10, v96
    v_lshrrev_b32 v98, 1, v97
    v_xor_b32 v98, v98, v97
    v_and_b32 v98, 4, v98
    v_mul_u32_u24 v98, 3, v98
    v_xor_b32 v97, v97, v98
    v_mul_u32_u24 v97, 1280, v97
    v_lshl_add_u32 v91, v96, 4, v97
    v_add_u32 v96, 64, v1
    v_mul_u32_u24 v97, 6554, v96
    v_lshrrev_b32 v97, 16, v97
    v_mad_i32_i24 v96, v97, -10, v96
    v_lshrrev_b32 v98, 1, v97
    v_xor_b32 v98, v98, v97
    v_and_b32 v98, 4, v98
    v_mul_u32_u24 v98, 3, v98
    v_xor_b32 v97, v97, v98
    v_mul_u32_u24 v97, 1280, v97
    v_lshl_add_u32 v92, v96, 4, v97
    v_subrev_u32 v92, 1024, v92
    v_add_u32 v96, 128, v1
    v_mul_u32_u24 v97, 6554, v96
    v_lshrrev_b32 v97, 16, v97
    v_mad_i32_i24 v96, v97, -10, v96
    v_lshrrev_b32 v98, 1, v97
    v_xor_b32 v98, v98, v97
    v_and_b32 v98, 4, v98
    v_mul_u32_u24 v98, 3, v98
    v_xor_b32 v97, v97, v98
    v_mul_u32_u24 v97, 1280, v97
    v_lshl_add_u32 v93, v96, 4, v97
    v_subrev_u32 v93, 2048, v93
    v_add_u32 v96, 192, v1
    v_mul_u32_u24 v97, 6554, v96
    v_lshrrev_b32 v97, 16, v97
    v_mad_i32_i24 v96, v97, -10, v96
    v_lshrrev_b32 v98, 1, v97
    v_xor_b32 v98, v98, v97
    v_and_b32 v98, 4, v98
    v_mul_u32_u24 v98, 3, v98
    v_xor_b32 v97, v97, v98
    v_mul_u32_u24 v97, 1280, v97
    v_lshl_add_u32 v94, v96, 4, v97
    v_subrev_u32 v94, 3072, v94
    v_add_u32 v96, 256, v1
    v_mul_u32_u24 v97, 6554, v96
    v_lshrrev_b32 v97, 16, v97
    v_mad_i32_i24 v96, v97, -10, v96
    v_lshrrev_b32 v98, 1, v97
    v_xor_b32 v98, v98, v97
    v_and_b32 v98, 4, v98
    v_mul_u32_u24 v98, 3, v98
    v_xor_b32 v97, v97, v98
    v_mul_u32_u24 v97, 1280, v97
    v_lshl_add_u32 v95, v96, 4, v97
    s_waitcnt lgkmcnt(0)
    s_add_u32 s14, s14, 200000
    s_bfe_u32 s101, s58, 262148
    s_lshl_b32 s101, s101, 7
    s_add_u32 s24, s20, s101
    s_add_u32 m0, s57, 86016
    s_nop 0
    buffer_load_dwordx4 v10, s[52:55], s24 offen offset:0 lds
    buffer_load_dwordx4 v11, s[52:55], s24 offen offset:1024 lds
    buffer_load_dwordx4 v12, s[52:55], s24 offen offset:2048 lds
    buffer_load_dwordx4 v13, s[52:55], s24 offen offset:3072 lds
    s_add_u32 m0, s57, 90112
    s_add_u32 s24, s24, 40960
    buffer_load_dwordx4 v10, s[52:55], s24 offen offset:0 lds
    buffer_load_dwordx4 v11, s[52:55], s24 offen offset:1024 lds
    buffer_load_dwordx4 v12, s[52:55], s24 offen offset:2048 lds
    buffer_load_dwordx4 v13, s[52:55], s24 offen offset:3072 lds
    s_bfe_u32 s101, s58, 262148
    s_lshl_b32 s101, s101, 6
    s_add_u32 m0, s56, 4096
    s_mul_i32 s24, s101, s3
    s_add_u32 s24, s24, s98
    buffer_load_dwordx4 v18, s[40:43], s24 offen offset:0 lds
    buffer_load_dwordx4 v19, s[40:43], s24 offen offset:1024 lds
    s_add_u32 m0, s56, 135168
    s_mul_i32 s24, s101, s3
    s_add_u32 s24, s24, s99
    buffer_load_dwordx4 v18, s[44:47], s24 offen offset:0 lds
    buffer_load_dwordx4 v19, s[44:47], s24 offen offset:1024 lds
    s_add_u32 m0, s56, 8192
    s_mul_i32 s24, s101, 3840
    s_add_u32 s24, s24, s100
    buffer_load_dwordx4 v16, s[48:51], s24 offen offset:0 lds
    buffer_load_dwordx4 v17, s[48:51], s24 offen offset:1024 lds
    s_waitcnt vmcnt(20)
    s_barrier
    s_bfe_u32 s101, s58, 262148
    s_lshl_b32 s101, s101, 6
    s_add_u32 s101, s101, 32
    s_add_u32 m0, s56, 126976
    s_mul_i32 s24, s101, s3
    s_add_u32 s24, s24, s98
    buffer_load_dwordx4 v18, s[40:43], s24 offen offset:0 lds
    buffer_load_dwordx4 v19, s[40:43], s24 offen offset:1024 lds
    s_add_u32 m0, s56, 0
    s_mul_i32 s24, s101, s3
    s_add_u32 s24, s24, s99
    buffer_load_dwordx4 v18, s[44:47], s24 offen offset:0 lds
    buffer_load_dwordx4 v19, s[44:47], s24 offen offset:1024 lds
    s_add_u32 m0, s56, 131072
    s_mul_i32 s24, s101, 3840
    s_add_u32 s24, s24, s100
    buffer_load_dwordx4 v16, s[48:51], s24 offen offset:0 lds
    buffer_load_dwordx4 v17, s[48:51], s24 offen offset:1024 lds
    s_waitcnt vmcnt(20)
    s_barrier
    s_bfe_u32 s101, s58, 262152
    s_lshl_b32 s101, s101, 7
    s_add_u32 s24, s20, s101
    s_add_u32 m0, s57, 69632
    s_nop 0
    buffer_load_dwordx4 v10, s[52:55], s24 offen offset:0 lds
    buffer_load_dwordx4 v11, s[52:55], s24 offen offset:1024 lds
    buffer_load_dwordx4 v12, s[52:55], s24 offen offset:2048 lds
    buffer_load_dwordx4 v13, s[52:55], s24 offen offset:3072 lds
    s_add_u32 m0, s57, 73728
    s_add_u32 s24, s24, 40960
    buffer_load_dwordx4 v10, s[52:55], s24 offen offset:0 lds
    buffer_load_dwordx4 v11, s[52:55], s24 offen offset:1024 lds
    buffer_load_dwordx4 v12, s[52:55], s24 offen offset:2048 lds
    buffer_load_dwordx4 v13, s[52:55], s24 offen offset:3072 lds
    s_bfe_u32 s101, s58, 262152
    s_lshl_b32 s101, s101, 6
    s_add_u32 m0, s56, 49152
    s_mul_i32 s24, s101, s3
    s_add_u32 s24, s24, s98
    buffer_load_dwordx4 v18, s[40:43], s24 offen offset:0 lds
    buffer_load_dwordx4 v19, s[40:43], s24 offen offset:1024 lds
    s_add_u32 m0, s56, 122880
    s_mul_i32 s24, s101, s3
    s_add_u32 s24, s24, s99
    buffer_load_dwordx4 v18, s[44:47], s24 offen offset:0 lds
    buffer_load_dwordx4 v19, s[44:47], s24 offen offset:1024 lds
    s_add_u32 m0, s56, 118784
    s_mul_i32 s24, s101, 3840
    s_add_u32 s24, s24, s100
    buffer_load_dwordx4 v16, s[48:51], s24 offen offset:0 lds
    buffer_load_dwordx4 v17, s[48:51], s24 offen offset:1024 lds
    s_waitcnt vmcnt(20)
    s_barrier
    s_bfe_u32 s101, s58, 262152
    s_lshl_b32 s101, s101, 6
    s_add_u32 s101, s101, 32
    s_add_u32 m0, s56, 151552
    s_mul_i32 s24, s101, s3
    s_add_u32 s24, s24, s98
    buffer_load_dwordx4 v18, s[40:43], s24 offen offset:0 lds
    buffer_load_dwordx4 v19, s[40:43], s24 offen offset:1024 lds
    s_add_u32 m0, s56, 159744
    s_mul_i32 s24, s101, s3
    s_add_u32 s24, s24, s99
    buffer_load_dwordx4 v18, s[44:47], s24 offen offset:0 lds
    buffer_load_dwordx4 v19, s[44:47], s24 offen offset:1024 lds
    s_add_u32 m0, s56, 155648
    s_mul_i32 s24, s101, 3840
    s_add_u32 s24, s24, s100
    buffer_load_dwordx4 v16, s[48:51], s24 offen offset:0 lds
    buffer_load_dwordx4 v17, s[48:51], s24 offen offset:1024 lds
    s_waitcnt vmcnt(20)
    s_barrier
    s_bfe_u32 s101, s58, 262156
    s_lshl_b32 s101, s101, 7
    s_add_u32 s24, s20, s101
    s_add_u32 m0, s57, 102400
    s_nop 0
    buffer_load_dwordx4 v10, s[52:55], s24 offen offset:0 lds
    buffer_load_dwordx4 v11, s[52:55], s24 offen offset:1024 lds
    buffer_load_dwordx4 v12, s[52:55], s24 offen offset:2048 lds
    buffer_load_dwordx4 v13, s[52:55], s24 offen offset:3072 lds
    s_add_u32 m0, s57, 106496
    s_add_u32 s24, s24, 40960
    buffer_load_dwordx4 v10, s[52:55], s24 offen offset:0 lds
    buffer_load_dwordx4 v11, s[52:55], s24 offen offset:1024 lds
    buffer_load_dwordx4 v12, s[52:55], s24 offen offset:2048 lds
    buffer_load_dwordx4 v13, s[52:55], s24 offen offset:3072 lds
    s_bfe_u32 s101, s58, 262156
    s_lshl_b32 s101, s101, 6
    s_add_u32 m0, s56, 139264
    s_mul_i32 s24, s101, s3
    s_add_u32 s24, s24, s98
    buffer_load_dwordx4 v18, s[40:43], s24 offen offset:0 lds
    buffer_load_dwordx4 v19, s[40:43], s24 offen offset:1024 lds
    s_add_u32 m0, s56, 147456
    s_mul_i32 s24, s101, s3
    s_add_u32 s24, s24, s99
    buffer_load_dwordx4 v18, s[44:47], s24 offen offset:0 lds
    buffer_load_dwordx4 v19, s[44:47], s24 offen offset:1024 lds
    s_add_u32 m0, s56, 143360
    s_mul_i32 s24, s101, 3840
    s_add_u32 s24, s24, s100
    buffer_load_dwordx4 v16, s[48:51], s24 offen offset:0 lds
    buffer_load_dwordx4 v17, s[48:51], s24 offen offset:1024 lds
    s_bfe_u32 s101, s58, 262156
    s_lshl_b32 s101, s101, 6
    s_add_u32 s101, s101, 32
    s_add_u32 m0, s56, 36864
    s_mul_i32 s24, s101, s3
    s_add_u32 s24, s24, s98
    buffer_load_dwordx4 v18, s[40:43], s24 offen offset:0 lds
    buffer_load_dwordx4 v19, s[40:43], s24 offen offset:1024 lds
    s_add_u32 m0, s56, 45056
    s_mul_i32 s24, s101, s3
    s_add_u32 s24, s24, s99
    buffer_load_dwordx4 v18, s[44:47], s24 offen offset:0 lds
    buffer_load_dwordx4 v19, s[44:47], s24 offen offset:1024 lds
    s_add_u32 m0, s56, 40960
    s_mul_i32 s24, s101, 3840
    s_add_u32 s24, s24, s100
    buffer_load_dwordx4 v16, s[48:51], s24 offen offset:0 lds
    buffer_load_dwordx4 v17, s[48:51], s24 offen offset:1024 lds
    s_waitcnt vmcnt(26)
    s_barrier
    s_waitcnt vmcnt(20)
    s_barrier
    s_bfe_u32 s101, s58, 262160
    s_lshl_b32 s101, s101, 7
    s_add_u32 s24, s20, s101
    s_add_u32 m0, s57, 86016
    s_nop 0
    buffer_load_dwordx4 v10, s[52:55], s24 offen offset:0 lds
    buffer_load_dwordx4 v11, s[52:55], s24 offen offset:1024 lds
    buffer_load_dwordx4 v12, s[52:55], s24 offen offset:2048 lds
    buffer_load_dwordx4 v13, s[52:55], s24 offen offset:3072 lds
    s_add_u32 m0, s57, 90112
    s_add_u32 s24, s24, 40960
    buffer_load_dwordx4 v10, s[52:55], s24 offen offset:0 lds
    buffer_load_dwordx4 v11, s[52:55], s24 offen offset:1024 lds
    buffer_load_dwordx4 v12, s[52:55], s24 offen offset:2048 lds
    buffer_load_dwordx4 v13, s[52:55], s24 offen offset:3072 lds
    s_bfe_u32 s101, s58, 262160
    s_lshl_b32 s101, s101, 6
    s_add_u32 m0, s56, 4096
    s_mul_i32 s24, s101, s3
    s_add_u32 s24, s24, s98
    buffer_load_dwordx4 v18, s[40:43], s24 offen offset:0 lds
    buffer_load_dwordx4 v19, s[40:43], s24 offen offset:1024 lds
    s_add_u32 m0, s56, 135168
    s_mul_i32 s24, s101, s3
    s_add_u32 s24, s24, s99
    buffer_load_dwordx4 v18, s[44:47], s24 offen offset:0 lds
    buffer_load_dwordx4 v19, s[44:47], s24 offen offset:1024 lds
    s_add_u32 m0, s56, 8192
    s_mul_i32 s24, s101, 3840
    s_add_u32 s24, s24, s100
    buffer_load_dwordx4 v16, s[48:51], s24 offen offset:0 lds
    buffer_load_dwordx4 v17, s[48:51], s24 offen offset:1024 lds
    s_waitcnt vmcnt(20)
    s_barrier
    s_bfe_u32 s101, s58, 262160
    s_lshl_b32 s101, s101, 6
    s_add_u32 s101, s101, 32
    s_add_u32 m0, s56, 126976
    s_mul_i32 s24, s101, s3
    s_add_u32 s24, s24, s98
    buffer_load_dwordx4 v18, s[40:43], s24 offen offset:0 lds
    buffer_load_dwordx4 v19, s[40:43], s24 offen offset:1024 lds
    s_add_u32 m0, s56, 0
    s_mul_i32 s24, s101, s3
    s_add_u32 s24, s24, s99
    buffer_load_dwordx4 v18, s[44:47], s24 offen offset:0 lds
    buffer_load_dwordx4 v19, s[44:47], s24 offen offset:1024 lds
    s_add_u32 m0, s56, 131072
    s_mul_i32 s24, s101, 3840
    s_add_u32 s24, s24, s100
    buffer_load_dwordx4 v16, s[48:51], s24 offen offset:0 lds
    buffer_load_dwordx4 v17, s[48:51], s24 offen offset:1024 lds
    s_waitcnt vmcnt(20)
    s_barrier
    s_bfe_u32 s101, s58, 262164
    s_lshl_b32 s101, s101, 7
    s_add_u32 s24, s20, s101
    s_add_u32 m0, s57, 69632
    s_nop 0
    buffer_load_dwordx4 v10, s[52:55], s24 offen offset:0 lds
    buffer_load_dwordx4 v11, s[52:55], s24 offen offset:1024 lds
    buffer_load_dwordx4 v12, s[52:55], s24 offen offset:2048 lds
    buffer_load_dwordx4 v13, s[52:55], s24 offen offset:3072 lds
    s_add_u32 m0, s57, 73728
    s_add_u32 s24, s24, 40960
    buffer_load_dwordx4 v10, s[52:55], s24 offen offset:0 lds
    buffer_load_dwordx4 v11, s[52:55], s24 offen offset:1024 lds
    buffer_load_dwordx4 v12, s[52:55], s24 offen offset:2048 lds
    buffer_load_dwordx4 v13, s[52:55], s24 offen offset:3072 lds
    s_bfe_u32 s101, s58, 262164
    s_lshl_b32 s101, s101, 6
    s_add_u32 m0, s56, 151552
    s_mul_i32 s24, s101, s3
    s_add_u32 s24, s24, s98
    buffer_load_dwordx4 v18, s[40:43], s24 offen offset:0 lds
    buffer_load_dwordx4 v19, s[40:43], s24 offen offset:1024 lds
    s_add_u32 m0, s56, 159744
    s_mul_i32 s24, s101, s3
    s_add_u32 s24, s24, s99
    buffer_load_dwordx4 v18, s[44:47], s24 offen offset:0 lds
    buffer_load_dwordx4 v19, s[44:47], s24 offen offset:1024 lds
    s_add_u32 m0, s56, 155648
    s_mul_i32 s24, s101, 3840
    s_add_u32 s24, s24, s100
    buffer_load_dwordx4 v16, s[48:51], s24 offen offset:0 lds
    buffer_load_dwordx4 v17, s[48:51], s24 offen offset:1024 lds
    s_waitcnt vmcnt(20)
    s_barrier
    s_bfe_u32 s101, s58, 262164
    s_lshl_b32 s101, s101, 6
    s_add_u32 s101, s101, 32
    s_add_u32 m0, s56, 139264
    s_mul_i32 s24, s101, s3
    s_add_u32 s24, s24, s98
    buffer_load_dwordx4 v18, s[40:43], s24 offen offset:0 lds
    buffer_load_dwordx4 v19, s[40:43], s24 offen offset:1024 lds
    s_add_u32 m0, s56, 147456
    s_mul_i32 s24, s101, s3
    s_add_u32 s24, s24, s99
    buffer_load_dwordx4 v18, s[44:47], s24 offen offset:0 lds
    buffer_load_dwordx4 v19, s[44:47], s24 offen offset:1024 lds
    s_add_u32 m0, s56, 143360
    s_mul_i32 s24, s101, 3840
    s_add_u32 s24, s24, s100
    buffer_load_dwordx4 v16, s[48:51], s24 offen offset:0 lds
    buffer_load_dwordx4 v17, s[48:51], s24 offen offset:1024 lds
    s_bfe_u32 s101, s58, 262168
    s_lshl_b32 s101, s101, 7
    s_add_u32 s24, s20, s101
    s_add_u32 m0, s57, 53248
    s_nop 0
    buffer_load_dwordx4 v10, s[52:55], s24 offen offset:0 lds
    buffer_load_dwordx4 v11, s[52:55], s24 offen offset:1024 lds
    buffer_load_dwordx4 v12, s[52:55], s24 offen offset:2048 lds
    buffer_load_dwordx4 v13, s[52:55], s24 offen offset:3072 lds
    s_add_u32 m0, s57, 57344
    s_add_u32 s24, s24, 40960
    buffer_load_dwordx4 v10, s[52:55], s24 offen offset:0 lds
    buffer_load_dwordx4 v11, s[52:55], s24 offen offset:1024 lds
    buffer_load_dwordx4 v12, s[52:55], s24 offen offset:2048 lds
    buffer_load_dwordx4 v13, s[52:55], s24 offen offset:3072 lds
    s_waitcnt vmcnt(28)
    s_barrier
    s_bfe_u32 s101, s58, 262168
    s_lshl_b32 s101, s101, 6
    s_add_u32 m0, s56, 114688
    s_mul_i32 s24, s101, 3072
    s_add_u32 s24, s24, s97
    buffer_load_dwordx4 v14, s[28:31], s24 offen offset:0 lds
    buffer_load_dwordx4 v15, s[28:31], s24 offen offset:1024 lds
    s_add_u32 m0, s56, 110592
    s_nop 0
    buffer_load_dwordx4 v14, s[36:39], s24 offen offset:0 lds
    buffer_load_dwordx4 v15, s[36:39], s24 offen offset:1024 lds
    s_bfe_u32 s101, s58, 262168
    s_lshl_b32 s101, s101, 6
    s_add_u32 m0, s56, 122880
    s_mul_i32 s24, s101, s3
    s_add_u32 s24, s24, s98
    buffer_load_dwordx4 v18, s[40:43], s24 offen offset:0 lds
    buffer_load_dwordx4 v19, s[40:43], s24 offen offset:1024 lds
    s_add_u32 m0, s56, 106496
    s_mul_i32 s24, s101, s3
    s_add_u32 s24, s24, s99
    buffer_load_dwordx4 v18, s[44:47], s24 offen offset:0 lds
    buffer_load_dwordx4 v19, s[44:47], s24 offen offset:1024 lds
    s_add_u32 m0, s56, 102400
    s_mul_i32 s24, s101, 3840
    s_add_u32 s24, s24, s100
    buffer_load_dwordx4 v16, s[48:51], s24 offen offset:0 lds
    buffer_load_dwordx4 v17, s[48:51], s24 offen offset:1024 lds
    s_bfe_u32 s101, s58, 262168
    s_lshl_b32 s101, s101, 6
    s_add_u32 s101, s101, 32
    s_add_u32 m0, s56, 118784
    s_mul_i32 s24, s101, 3072
    s_add_u32 s24, s24, s97
    buffer_load_dwordx4 v14, s[28:31], s24 offen offset:0 lds
    buffer_load_dwordx4 v15, s[28:31], s24 offen offset:1024 lds
    s_add_u32 m0, s56, 49152
    s_nop 0
    buffer_load_dwordx4 v14, s[36:39], s24 offen offset:0 lds
    buffer_load_dwordx4 v15, s[36:39], s24 offen offset:1024 lds
    s_waitcnt vmcnt(28)
    s_barrier
    s_waitcnt vmcnt(22)
    s_barrier
    s_bfe_u32 s101, s58, 262168
    s_lshl_b32 s101, s101, 6
    s_add_u32 s101, s101, 32
    s_add_u32 m0, s56, 4096
    s_mul_i32 s24, s101, s3
    s_add_u32 s24, s24, s98
    buffer_load_dwordx4 v18, s[40:43], s24 offen offset:0 lds
    buffer_load_dwordx4 v19, s[40:43], s24 offen offset:1024 lds
    s_add_u32 m0, s56, 135168
    s_mul_i32 s24, s101, s3
    s_add_u32 s24, s24, s99
    buffer_load_dwordx4 v18, s[44:47], s24 offen offset:0 lds
    buffer_load_dwordx4 v19, s[44:47], s24 offen offset:1024 lds
    s_add_u32 m0, s56, 8192
    s_mul_i32 s24, s101, 3840
    s_add_u32 s24, s24, s100
    buffer_load_dwordx4 v16, s[48:51], s24 offen offset:0 lds
    buffer_load_dwordx4 v17, s[48:51], s24 offen offset:1024 lds
    s_bfe_u32 s101, s58, 262172
    s_lshl_b32 s101, s101, 7
    s_add_u32 s24, s20, s101
    s_add_u32 m0, s57, 86016
    s_nop 0
    buffer_load_dwordx4 v10, s[52:55], s24 offen offset:0 lds
    buffer_load_dwordx4 v11, s[52:55], s24 offen offset:1024 lds
    buffer_load_dwordx4 v12, s[52:55], s24 offen offset:2048 lds
    buffer_load_dwordx4 v13, s[52:55], s24 offen offset:3072 lds
    s_add_u32 m0, s57, 90112
    s_add_u32 s24, s24, 40960
    buffer_load_dwordx4 v10, s[52:55], s24 offen offset:0 lds
    buffer_load_dwordx4 v11, s[52:55], s24 offen offset:1024 lds
    buffer_load_dwordx4 v12, s[52:55], s24 offen offset:2048 lds
    buffer_load_dwordx4 v13, s[52:55], s24 offen offset:3072 lds
    s_waitcnt vmcnt(18)
    s_barrier
    s_bfe_u32 s101, s58, 262172
    s_lshl_b32 s101, s101, 6
    s_add_u32 m0, s56, 159744
    s_mul_i32 s24, s101, 3072
    s_add_u32 s24, s24, s97
    buffer_load_dwordx4 v14, s[28:31], s24 offen offset:0 lds
    buffer_load_dwordx4 v15, s[28:31], s24 offen offset:1024 lds
    s_add_u32 m0, s56, 155648
    s_nop 0
    buffer_load_dwordx4 v14, s[36:39], s24 offen offset:0 lds
    buffer_load_dwordx4 v15, s[36:39], s24 offen offset:1024 lds
    s_bfe_u32 s101, s58, 262172
    s_lshl_b32 s101, s101, 6
    s_add_u32 m0, s56, 131072
    s_mul_i32 s24, s101, s3
    s_add_u32 s24, s24, s98
    buffer_load_dwordx4 v18, s[40:43], s24 offen offset:0 lds
    buffer_load_dwordx4 v19, s[40:43], s24 offen offset:1024 lds
    s_add_u32 m0, s56, 151552
    s_mul_i32 s24, s101, s3
    s_add_u32 s24, s24, s99
    buffer_load_dwordx4 v18, s[44:47], s24 offen offset:0 lds
    buffer_load_dwordx4 v19, s[44:47], s24 offen offset:1024 lds
    s_add_u32 m0, s56, 0
    s_mul_i32 s24, s101, 3840
    s_add_u32 s24, s24, s100
    buffer_load_dwordx4 v16, s[48:51], s24 offen offset:0 lds
    buffer_load_dwordx4 v17, s[48:51], s24 offen offset:1024 lds
    s_waitcnt vmcnt(18)
    s_barrier
    s_bfe_u32 s101, s58, 262172
    s_lshl_b32 s101, s101, 6
    s_add_u32 s101, s101, 32
    s_add_u32 m0, s56, 147456
    s_mul_i32 s24, s101, 3072
    s_add_u32 s24, s24, s97
    buffer_load_dwordx4 v14, s[28:31], s24 offen offset:0 lds
    buffer_load_dwordx4 v15, s[28:31], s24 offen offset:1024 lds
    s_add_u32 m0, s56, 143360
    s_nop 0
    buffer_load_dwordx4 v14, s[36:39], s24 offen offset:0 lds
    buffer_load_dwordx4 v15, s[36:39], s24 offen offset:1024 lds
    s_bfe_u32 s101, s58, 262172
    s_lshl_b32 s101, s101, 6
    s_add_u32 s101, s101, 32
    s_add_u32 m0, s56, 45056
    s_mul_i32 s24, s101, s3
    s_add_u32 s24, s24, s98
    buffer_load_dwordx4 v18, s[40:43], s24 offen offset:0 lds
    buffer_load_dwordx4 v19, s[40:43], s24 offen offset:1024 lds
    s_add_u32 m0, s56, 139264
    s_mul_i32 s24, s101, s3
    s_add_u32 s24, s24, s99
    buffer_load_dwordx4 v18, s[44:47], s24 offen offset:0 lds
    buffer_load_dwordx4 v19, s[44:47], s24 offen offset:1024 lds
    s_add_u32 m0, s56, 126976
    s_mul_i32 s24, s101, 3840
    s_add_u32 s24, s24, s100
    buffer_load_dwordx4 v16, s[48:51], s24 offen offset:0 lds
    buffer_load_dwordx4 v17, s[48:51], s24 offen offset:1024 lds
    s_bfe_u32 s101, s59, 262144
    s_lshl_b32 s101, s101, 7
    s_add_u32 s24, s20, s101
    s_add_u32 m0, s57, 69632
    s_nop 0
    buffer_load_dwordx4 v10, s[52:55], s24 offen offset:0 lds
    buffer_load_dwordx4 v11, s[52:55], s24 offen offset:1024 lds
    buffer_load_dwordx4 v12, s[52:55], s24 offen offset:2048 lds
    buffer_load_dwordx4 v13, s[52:55], s24 offen offset:3072 lds
    s_add_u32 m0, s57, 73728
    s_add_u32 s24, s24, 40960
    buffer_load_dwordx4 v10, s[52:55], s24 offen offset:0 lds
    buffer_load_dwordx4 v11, s[52:55], s24 offen offset:1024 lds
    buffer_load_dwordx4 v12, s[52:55], s24 offen offset:2048 lds
    buffer_load_dwordx4 v13, s[52:55], s24 offen offset:3072 lds
    s_bfe_u32 s101, s59, 262144
    s_lshl_b32 s101, s101, 6
    s_add_u32 m0, s56, 40960
    s_mul_i32 s24, s101, 3072
    s_add_u32 s24, s24, s97
    buffer_load_dwordx4 v14, s[28:31], s24 offen offset:0 lds
    buffer_load_dwordx4 v15, s[28:31], s24 offen offset:1024 lds
    s_add_u32 m0, s56, 36864
    s_nop 0
    buffer_load_dwordx4 v14, s[36:39], s24 offen offset:0 lds
    buffer_load_dwordx4 v15, s[36:39], s24 offen offset:1024 lds
    s_waitcnt vmcnt(22)
    s_barrier
    s_bfe_u32 s101, s59, 262144
    s_lshl_b32 s101, s101, 6
    s_add_u32 m0, s56, 106496
    s_mul_i32 s24, s101, s3
    s_add_u32 s24, s24, s98
    buffer_load_dwordx4 v18, s[40:43], s24 offen offset:0 lds
    buffer_load_dwordx4 v19, s[40:43], s24 offen offset:1024 lds
    s_add_u32 m0, s56, 114688
    s_mul_i32 s24, s101, s3
    s_add_u32 s24, s24, s99
    buffer_load_dwordx4 v18, s[44:47], s24 offen offset:0 lds
    buffer_load_dwordx4 v19, s[44:47], s24 offen offset:1024 lds
    s_add_u32 m0, s56, 110592
    s_mul_i32 s24, s101, 3840
    s_add_u32 s24, s24, s100
    buffer_load_dwordx4 v16, s[48:51], s24 offen offset:0 lds
    buffer_load_dwordx4 v17, s[48:51], s24 offen offset:1024 lds
    s_bfe_u32 s101, s59, 262144
    s_lshl_b32 s101, s101, 6
    s_add_u32 s101, s101, 32
    s_add_u32 m0, s56, 102400
    s_mul_i32 s24, s101, 3072
    s_add_u32 s24, s24, s97
    buffer_load_dwordx4 v14, s[28:31], s24 offen offset:0 lds
    buffer_load_dwordx4 v15, s[28:31], s24 offen offset:1024 lds
    s_add_u32 m0, s56, 122880
    s_nop 0
    buffer_load_dwordx4 v14, s[36:39], s24 offen offset:0 lds
    buffer_load_dwordx4 v15, s[36:39], s24 offen offset:1024 lds
    s_bfe_u32 s101, s59, 262144
    s_lshl_b32 s101, s101, 6
    s_add_u32 s101, s101, 32
    s_add_u32 m0, s56, 24576
    s_mul_i32 s24, s101, s3
    s_add_u32 s24, s24, s98
    buffer_load_dwordx4 v18, s[40:43], s24 offen offset:0 lds
    buffer_load_dwordx4 v19, s[40:43], s24 offen offset:1024 lds
    s_add_u32 m0, s56, 32768
    s_mul_i32 s24, s101, s3
    s_add_u32 s24, s24, s99
    buffer_load_dwordx4 v18, s[44:47], s24 offen offset:0 lds
    buffer_load_dwordx4 v19, s[44:47], s24 offen offset:1024 lds
    s_add_u32 m0, s56, 28672
    s_mul_i32 s24, s101, 3840
    s_add_u32 s24, s24, s100
    buffer_load_dwordx4 v16, s[48:51], s24 offen offset:0 lds
    buffer_load_dwordx4 v17, s[48:51], s24 offen offset:1024 lds
    s_waitcnt vmcnt(28)
    s_barrier
    s_bfe_u32 s101, s59, 262148
    s_lshl_b32 s101, s101, 7
    s_add_u32 s24, s20, s101
    s_add_u32 m0, s57, 53248
    s_nop 0
    buffer_load_dwordx4 v10, s[52:55], s24 offen offset:0 lds
    buffer_load_dwordx4 v11, s[52:55], s24 offen offset:1024 lds
    buffer_load_dwordx4 v12, s[52:55], s24 offen offset:2048 lds
    buffer_load_dwordx4 v13, s[52:55], s24 offen offset:3072 lds
    s_add_u32 m0, s57, 57344
    s_add_u32 s24, s24, 40960
    buffer_load_dwordx4 v10, s[52:55], s24 offen offset:0 lds
    buffer_load_dwordx4 v11, s[52:55], s24 offen offset:1024 lds
    buffer_load_dwordx4 v12, s[52:55], s24 offen offset:2048 lds
    buffer_load_dwordx4 v13, s[52:55], s24 offen offset:3072 lds
    s_bfe_u32 s101, s59, 262148
    s_lshl_b32 s101, s101, 6
    s_add_u32 m0, s56, 135168
    s_mul_i32 s24, s101, 3072
    s_add_u32 s24, s24, s97
    buffer_load_dwordx4 v14, s[28:31], s24 offen offset:0 lds
    buffer_load_dwordx4 v15, s[28:31], s24 offen offset:1024 lds
    s_add_u32 m0, s56, 8192
    s_nop 0
    buffer_load_dwordx4 v14, s[36:39], s24 offen offset:0 lds
    buffer_load_dwordx4 v15, s[36:39], s24 offen offset:1024 lds
    s_bfe_u32 s101, s59, 262148
    s_lshl_b32 s101, s101, 6
    s_add_u32 m0, s56, 49152
    s_mul_i32 s24, s101, s3
    s_add_u32 s24, s24, s98
    buffer_load_dwordx4 v18, s[40:43], s24 offen offset:0 lds
    buffer_load_dwordx4 v19, s[40:43], s24 offen offset:1024 lds
    s_add_u32 m0, s56, 4096
    s_mul_i32 s24, s101, s3
    s_add_u32 s24, s24, s99
    buffer_load_dwordx4 v18, s[44:47], s24 offen offset:0 lds
    buffer_load_dwordx4 v19, s[44:47], s24 offen offset:1024 lds
    s_add_u32 m0, s56, 118784
    s_mul_i32 s24, s101, 3840
    s_add_u32 s24, s24, s100
    buffer_load_dwordx4 v16, s[48:51], s24 offen offset:0 lds
    buffer_load_dwordx4 v17, s[48:51], s24 offen offset:1024 lds
    s_waitcnt vmcnt(28)
    s_barrier
    s_bfe_u32 s101, s59, 262148
    s_lshl_b32 s101, s101, 6
    s_add_u32 s101, s101, 32
    s_add_u32 m0, s56, 159744
    s_mul_i32 s24, s101, 3072
    s_add_u32 s24, s24, s97
    buffer_load_dwordx4 v14, s[28:31], s24 offen offset:0 lds
    buffer_load_dwordx4 v15, s[28:31], s24 offen offset:1024 lds
    s_add_u32 m0, s56, 155648
    s_nop 0
    buffer_load_dwordx4 v14, s[36:39], s24 offen offset:0 lds
    buffer_load_dwordx4 v15, s[36:39], s24 offen offset:1024 lds
    s_bfe_u32 s101, s59, 262148
    s_lshl_b32 s101, s101, 6
    s_add_u32 s101, s101, 32
    s_add_u32 m0, s56, 131072
    s_mul_i32 s24, s101, s3
    s_add_u32 s24, s24, s98
    buffer_load_dwordx4 v18, s[40:43], s24 offen offset:0 lds
    buffer_load_dwordx4 v19, s[40:43], s24 offen offset:1024 lds
    s_add_u32 m0, s56, 151552
    s_mul_i32 s24, s101, s3
    s_add_u32 s24, s24, s99
    buffer_load_dwordx4 v18, s[44:47], s24 offen offset:0 lds
    buffer_load_dwordx4 v19, s[44:47], s24 offen offset:1024 lds
    s_add_u32 m0, s56, 0
    s_mul_i32 s24, s101, 3840
    s_add_u32 s24, s24, s100
    buffer_load_dwordx4 v16, s[48:51], s24 offen offset:0 lds
    buffer_load_dwordx4 v17, s[48:51], s24 offen offset:1024 lds
    s_waitcnt vmcnt(28)
    s_barrier
    s_bfe_u32 s101, s59, 262152
    s_lshl_b32 s101, s101, 7
    s_add_u32 s24, s20, s101
    s_add_u32 m0, s57, 86016
    s_nop 0
    buffer_load_dwordx4 v10, s[52:55], s24 offen offset:0 lds
    buffer_load_dwordx4 v11, s[52:55], s24 offen offset:1024 lds
    buffer_load_dwordx4 v12, s[52:55], s24 offen offset:2048 lds
    buffer_load_dwordx4 v13, s[52:55], s24 offen offset:3072 lds
    s_add_u32 m0, s57, 90112
    s_add_u32 s24, s24, 40960
    buffer_load_dwordx4 v10, s[52:55], s24 offen offset:0 lds
    buffer_load_dwordx4 v11, s[52:55], s24 offen offset:1024 lds
    buffer_load_dwordx4 v12, s[52:55], s24 offen offset:2048 lds
    buffer_load_dwordx4 v13, s[52:55], s24 offen offset:3072 lds
    s_bfe_u32 s101, s59, 262152
    s_lshl_b32 s101, s101, 6
    s_add_u32 m0, s56, 147456
    s_mul_i32 s24, s101, 3072
    s_add_u32 s24, s24, s97
    buffer_load_dwordx4 v14, s[28:31], s24 offen offset:0 lds
    buffer_load_dwordx4 v15, s[28:31], s24 offen offset:1024 lds
    s_add_u32 m0, s56, 143360
    s_nop 0
    buffer_load_dwordx4 v14, s[36:39], s24 offen offset:0 lds
    buffer_load_dwordx4 v15, s[36:39], s24 offen offset:1024 lds
    s_waitcnt vmcnt(22)
    s_barrier
    s_bfe_u32 s101, s59, 262152
    s_lshl_b32 s101, s101, 6
    s_add_u32 s101, s101, 32
    s_add_u32 m0, s56, 139264
    s_mul_i32 s24, s101, 3072
    s_add_u32 s24, s24, s97
    buffer_load_dwordx4 v14, s[28:31], s24 offen offset:0 lds
    buffer_load_dwordx4 v15, s[28:31], s24 offen offset:1024 lds
    s_add_u32 m0, s56, 126976
    s_nop 0
    buffer_load_dwordx4 v14, s[36:39], s24 offen offset:0 lds
    buffer_load_dwordx4 v15, s[36:39], s24 offen offset:1024 lds
    s_bfe_u32 s101, s59, 262156
    s_lshl_b32 s101, s101, 6
    s_add_u32 m0, s56, 45056
    s_mul_i32 s24, s101, 3072
    s_add_u32 s24, s24, s97
    buffer_load_dwordx4 v14, s[28:31], s24 offen offset:0 lds
    buffer_load_dwordx4 v15, s[28:31], s24 offen offset:1024 lds
    s_add_u32 m0, s56, 40960
    s_nop 0
    buffer_load_dwordx4 v14, s[36:39], s24 offen offset:0 lds
    buffer_load_dwordx4 v15, s[36:39], s24 offen offset:1024 lds
    s_bfe_u32 s101, s59, 262156
    s_lshl_b32 s101, s101, 6
    s_add_u32 s101, s101, 32
    s_add_u32 m0, s56, 36864
    s_mul_i32 s24, s101, 3072
    s_add_u32 s24, s24, s97
    buffer_load_dwordx4 v14, s[28:31], s24 offen offset:0 lds
    buffer_load_dwordx4 v15, s[28:31], s24 offen offset:1024 lds
    s_add_u32 m0, s56, 20480
    s_nop 0
    buffer_load_dwordx4 v14, s[36:39], s24 offen offset:0 lds
    buffer_load_dwordx4 v15, s[36:39], s24 offen offset:1024 lds
    s_waitcnt vmcnt(24)
    s_barrier
    s_bfe_u32 s101, s59, 262156
    s_lshl_b32 s101, s101, 7
    s_add_u32 s24, s20, s101
    s_add_u32 m0, s57, 69632
    s_nop 0
    buffer_load_dwordx4 v10, s[52:55], s24 offen offset:0 lds
    buffer_load_dwordx4 v11, s[52:55], s24 offen offset:1024 lds
    buffer_load_dwordx4 v12, s[52:55], s24 offen offset:2048 lds
    buffer_load_dwordx4 v13, s[52:55], s24 offen offset:3072 lds
    s_add_u32 m0, s57, 73728
    s_add_u32 s24, s24, 40960
    buffer_load_dwordx4 v10, s[52:55], s24 offen offset:0 lds
    buffer_load_dwordx4 v11, s[52:55], s24 offen offset:1024 lds
    buffer_load_dwordx4 v12, s[52:55], s24 offen offset:2048 lds
    buffer_load_dwordx4 v13, s[52:55], s24 offen offset:3072 lds
    s_waitcnt vmcnt(20)
    s_barrier
    s_bfe_u32 s101, s59, 262160
    s_lshl_b32 s101, s101, 6
    s_add_u32 m0, s56, 135168
    s_mul_i32 s24, s101, 3072
    s_add_u32 s24, s24, s97
    buffer_load_dwordx4 v14, s[28:31], s24 offen offset:0 lds
    buffer_load_dwordx4 v15, s[28:31], s24 offen offset:1024 lds
    s_add_u32 m0, s56, 8192
    s_nop 0
    buffer_load_dwordx4 v14, s[36:39], s24 offen offset:0 lds
    buffer_load_dwordx4 v15, s[36:39], s24 offen offset:1024 lds
    s_bfe_u32 s101, s59, 262160
    s_lshl_b32 s101, s101, 6
    s_add_u32 s101, s101, 32
    s_add_u32 m0, s56, 4096
    s_mul_i32 s24, s101, 3072
    s_add_u32 s24, s24, s97
    buffer_load_dwordx4 v14, s[28:31], s24 offen offset:0 lds
    buffer_load_dwordx4 v15, s[28:31], s24 offen offset:1024 lds
    s_add_u32 m0, s56, 122880
    s_nop 0
    buffer_load_dwordx4 v14, s[36:39], s24 offen offset:0 lds
    buffer_load_dwordx4 v15, s[36:39], s24 offen offset:1024 lds
    s_bfe_u32 s101, s59, 262164
    s_lshl_b32 s101, s101, 6
    s_add_u32 m0, s56, 118784
    s_mul_i32 s24, s101, 3072
    s_add_u32 s24, s24, s97
    buffer_load_dwordx4 v14, s[28:31], s24 offen offset:0 lds
    buffer_load_dwordx4 v15, s[28:31], s24 offen offset:1024 lds
    s_add_u32 m0, s56, 49152
    s_nop 0
    buffer_load_dwordx4 v14, s[36:39], s24 offen offset:0 lds
    buffer_load_dwordx4 v15, s[36:39], s24 offen offset:1024 lds
    s_bfe_u32 s101, s59, 262164
    s_lshl_b32 s101, s101, 6
    s_add_u32 s101, s101, 32
    s_add_u32 m0, s56, 32768
    s_mul_i32 s24, s101, 3072
    s_add_u32 s24, s24, s97
    buffer_load_dwordx4 v14, s[28:31], s24 offen offset:0 lds
    buffer_load_dwordx4 v15, s[28:31], s24 offen offset:1024 lds
    s_add_u32 m0, s56, 28672
    s_nop 0
    buffer_load_dwordx4 v14, s[36:39], s24 offen offset:0 lds
    buffer_load_dwordx4 v15, s[36:39], s24 offen offset:1024 lds
    s_bfe_u32 s101, s59, 262168
    s_lshl_b32 s101, s101, 6
    s_add_u32 m0, s56, 24576
    s_mul_i32 s24, s101, 3072
    s_add_u32 s24, s24, s97
    buffer_load_dwordx4 v14, s[28:31], s24 offen offset:0 lds
    buffer_load_dwordx4 v15, s[28:31], s24 offen offset:1024 lds
    s_add_u32 m0, s56, 16384
    s_nop 0
    buffer_load_dwordx4 v14, s[36:39], s24 offen offset:0 lds
    buffer_load_dwordx4 v15, s[36:39], s24 offen offset:1024 lds
    s_waitcnt vmcnt(36)
    s_barrier
    s_bfe_u32 s101, s59, 262160
    s_lshl_b32 s101, s101, 7
    s_add_u32 s24, s20, s101
    s_add_u32 m0, s57, 53248
    s_nop 0
    buffer_load_dwordx4 v10, s[52:55], s24 offen offset:0 lds
    buffer_load_dwordx4 v11, s[52:55], s24 offen offset:1024 lds
    buffer_load_dwordx4 v12, s[52:55], s24 offen offset:2048 lds
    buffer_load_dwordx4 v13, s[52:55], s24 offen offset:3072 lds
    s_add_u32 m0, s57, 57344
    s_add_u32 s24, s24, 40960
    buffer_load_dwordx4 v10, s[52:55], s24 offen offset:0 lds
    buffer_load_dwordx4 v11, s[52:55], s24 offen offset:1024 lds
    buffer_load_dwordx4 v12, s[52:55], s24 offen offset:2048 lds
    buffer_load_dwordx4 v13, s[52:55], s24 offen offset:3072 lds
    s_waitcnt vmcnt(28)
    s_barrier
    s_bfe_u32 s101, s59, 262164
    s_lshl_b32 s101, s101, 7
    s_add_u32 s24, s20, s101
    s_add_u32 m0, s57, 102400
    s_nop 0
    buffer_load_dwordx4 v10, s[52:55], s24 offen offset:0 lds
    buffer_load_dwordx4 v11, s[52:55], s24 offen offset:1024 lds
    buffer_load_dwordx4 v12, s[52:55], s24 offen offset:2048 lds
    buffer_load_dwordx4 v13, s[52:55], s24 offen offset:3072 lds
    s_add_u32 m0, s57, 106496
    s_add_u32 s24, s24, 40960
    buffer_load_dwordx4 v10, s[52:55], s24 offen offset:0 lds
    buffer_load_dwordx4 v11, s[52:55], s24 offen offset:1024 lds
    buffer_load_dwordx4 v12, s[52:55], s24 offen offset:2048 lds
    buffer_load_dwordx4 v13, s[52:55], s24 offen offset:3072 lds
    s_barrier
    s_bfe_u32 s101, s59, 262168
    s_lshl_b32 s101, s101, 7
    s_add_u32 s24, s20, s101
    s_add_u32 m0, s57, 86016
    s_nop 0
    buffer_load_dwordx4 v10, s[52:55], s24 offen offset:0 lds
    buffer_load_dwordx4 v11, s[52:55], s24 offen offset:1024 lds
    buffer_load_dwordx4 v12, s[52:55], s24 offen offset:2048 lds
    buffer_load_dwordx4 v13, s[52:55], s24 offen offset:3072 lds
    s_add_u32 m0, s57, 90112
    s_add_u32 s24, s24, 40960
    buffer_load_dwordx4 v10, s[52:55], s24 offen offset:0 lds
    buffer_load_dwordx4 v11, s[52:55], s24 offen offset:1024 lds
    buffer_load_dwordx4 v12, s[52:55], s24 offen offset:2048 lds
    buffer_load_dwordx4 v13, s[52:55], s24 offen offset:3072 lds
    s_bfe_u32 s101, s59, 262168
    s_lshl_b32 s101, s101, 6
    s_add_u32 s101, s101, 32
    s_add_u32 m0, s56, 131072
    s_mul_i32 s24, s101, 3072
    s_add_u32 s24, s24, s97
    buffer_load_dwordx4 v14, s[28:31], s24 offen offset:0 lds
    buffer_load_dwordx4 v15, s[28:31], s24 offen offset:1024 lds
    s_add_u32 m0, s56, 126976
    s_nop 0
    buffer_load_dwordx4 v14, s[36:39], s24 offen offset:0 lds
    buffer_load_dwordx4 v15, s[36:39], s24 offen offset:1024 lds
    s_waitcnt vmcnt(20)
    s_barrier
    s_bfe_u32 s101, s59, 262172
    s_lshl_b32 s101, s101, 6
    s_add_u32 m0, s56, 45056
    s_mul_i32 s24, s101, 3072
    s_add_u32 s24, s24, s97
    buffer_load_dwordx4 v14, s[28:31], s24 offen offset:0 lds
    buffer_load_dwordx4 v15, s[28:31], s24 offen offset:1024 lds
    s_add_u32 m0, s56, 40960
    s_nop 0
    buffer_load_dwordx4 v14, s[36:39], s24 offen offset:0 lds
    buffer_load_dwordx4 v15, s[36:39], s24 offen offset:1024 lds
    s_barrier
    s_bfe_u32 s101, s59, 262172
    s_lshl_b32 s101, s101, 7
    s_add_u32 s24, s20, s101
    s_add_u32 m0, s57, 69632
    s_nop 0
    buffer_load_dwordx4 v10, s[52:55], s24 offen offset:0 lds
    buffer_load_dwordx4 v11, s[52:55], s24 offen offset:1024 lds
    buffer_load_dwordx4 v12, s[52:55], s24 offen offset:2048 lds
    buffer_load_dwordx4 v13, s[52:55], s24 offen offset:3072 lds
    s_add_u32 m0, s57, 73728
    s_add_u32 s24, s24, 40960
    buffer_load_dwordx4 v10, s[52:55], s24 offen offset:0 lds
    buffer_load_dwordx4 v11, s[52:55], s24 offen offset:1024 lds
    buffer_load_dwordx4 v12, s[52:55], s24 offen offset:2048 lds
    buffer_load_dwordx4 v13, s[52:55], s24 offen offset:3072 lds
    s_bfe_u32 s101, s59, 262172
    s_lshl_b32 s101, s101, 6
    s_add_u32 s101, s101, 32
    s_add_u32 m0, s56, 36864
    s_mul_i32 s24, s101, 3072
    s_add_u32 s24, s24, s97
    buffer_load_dwordx4 v14, s[28:31], s24 offen offset:0 lds
    buffer_load_dwordx4 v15, s[28:31], s24 offen offset:1024 lds
    s_add_u32 m0, s56, 20480
    s_nop 0
    buffer_load_dwordx4 v14, s[36:39], s24 offen offset:0 lds
    buffer_load_dwordx4 v15, s[36:39], s24 offen offset:1024 lds
    s_waitcnt vmcnt(28)
    s_barrier
    s_barrier
    s_waitcnt vmcnt(20)
    s_barrier
    s_waitcnt vmcnt(16)
    s_barrier
    s_waitcnt vmcnt(0)
    s_barrier
    s_branch L_g
L_aux2:
    s_load_dwordx2 s[44:45], s[0:1], 72
    s_waitcnt lgkmcnt(0)
    s_mov_b32 s36, s14
    s_and_b32 s37, s15, 0xffff
    s_mov_b32 s38, 1280
    s_mov_b32 s39, 0x00020000
    s_mov_b32 s40, s4
    s_and_b32 s41, s5, 0xffff
    s_mov_b32 s42, 2621440
    s_mov_b32 s43, 0x00020000
    s_mov_b32 s44, s44
    s_and_b32 s45, s45, 0xffff
    s_mov_b32 s46, 256
    s_mov_b32 s47, 0x00020000
    s_mov_b32 s32, s18
    s_and_b32 s33, s19, 0xffff
    s_mov_b32 s34, 31457280
    s_mov_b32 s35, 0x00020000
    s_and_b32 s24, s2, 7
    s_lshl_b32 s24, s24, 2
    s_lshr_b32 s25, s2, 6
    s_add_u32 s16, s24, s25
    s_bfe_u32 s17, s2, 0x30003
    s_and_b32 s13, s16, 1
    s_lshr_b32 s26, s16, 1
    s_mul_i32 s26, s26, 5
    s_lshl_b32 s27, s13, 1
    s_add_u32 s26, s26, s27
    s_lshl_b32 s10, s26, 9
    s_memrealtime s[14:15]
    s_and_b32 s19, s96, 3
    s_lshl_b32 s25, s19, 1
    v_lshlrev_b32 v164, 4, v1
    s_mul_i32 s24, s25, 123392
    s_add_u32 s24, s24, s10
    v_add_u32 v88, s24, v164
    v_and_b32 v165, 511, v164
    v_lshrrev_b32 v167, 9, v164
    v_mul_u32_u24 v166, 39936, v167
    v_add3_u32 v89, v165, v166, s24
    v_lshlrev_b32 v166, 6, v167
    v_add_u32 v166, 64, v166
    v_xor_b32 v166, v166, v164
    s_add_u32 s24, s24, 39424
    v_add_u32 v90, s24, v166
    s_mul_i32 s4, s19, 3136
    s_add_u32 s4, s4, 110592
    s_mov_b32 s8, 0x01010101
    s_mov_b32 s9, 0x01010101
    v_lshrrev_b32 v164, 3, v1
    v_and_b32 v165, 7, v1
    v_lshlrev_b32 v165, 2, v165
    v_lshl_add_u32 v165, v164, 8, v165
    s_lshr_b32 s24, s19, 1
    s_lshl_b32 s24, s24, 5
    s_lshl_b32 s5, s16, 11
    s_add_u32 s5, s5, s24
    s_add_u32 s5, s5, 22282240
    s_lshl_b32 s13, s17, 3
    s_lshl_b64 s[6:7], 3, s13
    s_lshr_b32 s13, s13, 1
    s_mul_i32 s11, s17, 987136
    s_mul_i32 s12, s19, 3072
    v_min_u32 v163, 7, v1
    v_mul_u32_u24 v163, 3136, v163
    v_add_u32 v163, 110592, v163
    v_mov_b32 v152, 0x3f803f80
    v_mov_b32 v153, 0x3f803f80
    v_mov_b32 v154, 0x3c00
    v_mov_b32 v155, 0
    v_mov_b32 v156, 0
    v_mov_b32 v157, 0
    v_mov_b32 v158, 15952
    v_mov_b32 v159, 0
    v_add_u32 v96, 0, v1
    v_mul_u32_u24 v97, 6554, v96
    v_lshrrev_b32 v97, 16, v97
    v_mad_i32_i24 v96, v97, -10, v96
    v_lshrrev_b32 v98, 1, v97
    v_xor_b32 v98, v98, v97
    v_and_b32 v98, 4, v98
    v_mul_u32_u24 v98, 3, v98
    v_xor_b32 v97, v97, v98
    v_mul_u32_u24 v97, 1280, v97
    v_lshl_add_u32 v91, v96, 4, v97
    v_add_u32 v96, 64, v1
    v_mul_u32_u24 v97, 6554, v96
    v_lshrrev_b32 v97, 16, v97
    v_mad_i32_i24 v96, v97, -10, v96
    v_lshrrev_b32 v98, 1, v97
    v_xor_b32 v98, v98, v97
    v_and_b32 v98, 4, v98
    v_mul_u32_u24 v98, 3, v98
    v_xor_b32 v97, v97, v98
    v_mul_u32_u24 v97, 1280, v97
    v_lshl_add_u32 v92, v96, 4, v97
    v_subrev_u32 v92, 1024, v92
    v_add_u32 v96, 128, v1
    v_mul_u32_u24 v97, 6554, v96
    v_lshrrev_b32 v97, 16, v97
    v_mad_i32_i24 v96, v97, -10, v96
    v_lshrrev_b32 v98, 1, v97
    v_xor_b32 v98, v98, v97
    v_and_b32 v98, 4, v98
    v_mul_u32_u24 v98, 3, v98
    v_xor_b32 v97, v97, v98
    v_mul_u32_u24 v97, 1280, v97
    v_lshl_add_u32 v93, v96, 4, v97
    v_subrev_u32 v93, 2048, v93
    v_add_u32 v96, 192, v1
    v_mul_u32_u24 v97, 6554, v96
    v_lshrrev_b32 v97, 16, v97
    v_mad_i32_i24 v96, v97, -10, v96
    v_lshrrev_b32 v98, 1, v97
    v_xor_b32 v98, v98, v97
    v_and_b32 v98, 4, v98
    v_mul_u32_u24 v98, 3, v98
    v_xor_b32 v97, v97, v98
    v_mul_u32_u24 v97, 1280, v97
    v_lshl_add_u32 v94, v96, 4, v97
    v_subrev_u32 v94, 3072, v94
    v_add_u32 v96, 256, v1
    v_mul_u32_u24 v97, 6554, v96
    v_lshrrev_b32 v97, 16, v97
    v_mad_i32_i24 v96, v97, -10, v96
    v_lshrrev_b32 v98, 1, v97
    v_xor_b32 v98, v98, v97
    v_and_b32 v98, 4, v98
    v_mul_u32_u24 v98, 3, v98
    v_xor_b32 v97, v97, v98
    v_mul_u32_u24 v97, 1280, v97
    v_lshl_add_u32 v95, v96, 4, v97
    s_waitcnt lgkmcnt(0)
    s_add_u32 s14, s14, 200000
    s_cmp_eq_u32 s96, 10
    s_cbranch_scc1 L_k1_job
L_k1_mb:
    v_lshlrev_b32 v15, 2, v1
    v_mov_b32 v10, 0
    v_mov_b32 v11, 1
    s_lshl_b32 s24, s2, 8
    s_add_u32 s24, s24, 22282240
    buffer_store_dword v10, v15, s[32:35], s24 offen sc1
    s_add_u32 s24, s24, 0x10000
    buffer_store_dword v10, v15, s[32:35], s24 offen sc1
    v_lshrrev_b32 v13, 2, v1
    v_mul_u32_u24 v13, 5, v13
    v_and_b32 v12, 2, v1
    v_add_u32 v13, v13, v12
    v_and_b32 v12, 1, v1
    v_lshl_add_u32 v13, v12, 1, v13
    v_and_b32 v14, 24, v13
    v_min_u32 v14, 1, v14
    v_lshrrev_b32 v15, 5, v13
    v_lshl_add_u32 v14, v15, 1, v14
    v_cmp_eq_u32 s[48:49], s22, v14
    v_add_u32 v13, 80, v13
    v_and_b32 v14, 24, v13
    v_min_u32 v14, 1, v14
    v_lshrrev_b32 v15, 5, v13
    v_lshl_add_u32 v14, v15, 1, v14
    v_cmp_eq_u32 s[50:51], s22, v14
    v_add_u32 v13, 80, v13
    v_and_b32 v14, 24, v13
    v_min_u32 v14, 1, v14
    v_lshrrev_b32 v15, 5, v13
    v_lshl_add_u32 v14, v15, 1, v14
    v_cmp_eq_u32 s[52:53], s22, v14
    v_add_u32 v13, 80, v13
    v_lshrrev_b32 v13, 1, v1
    v_lshlrev_b32 v12, 2, v12
    v_lshl_add_u32 v12, v13, 11, v12
    s_lshr_b32 s26, s21, 1
    s_lshl_b32 s26, s26, 8
    s_and_b32 s27, s21, 1
    s_lshl_b32 s27, s27, 5
    s_add_u32 s54, s26, s27
    s_add_u32 s54, s54, 22282240
    s_mov_b64 exec, 1
    s_mul_i32 s55, s2, 14
    s_lshr_b32 s55, s55, 8
    s_barrier
    s_barrier
    s_barrier
    s_barrier
    s_barrier
    s_cmp_eq_u32 s55, 0
    s_cbranch_scc0 L_k1_at4
    s_waitcnt vmcnt(0)
    buffer_atomic_add v11, off, s[44:47], 0 sc1
L_k1_at4:
    s_barrier
    s_cmp_eq_u32 s55, 1
    s_cbranch_scc0 L_k1_at5
    s_waitcnt vmcnt(0)
    buffer_atomic_add v11, off, s[44:47], 0 sc1
L_k1_at5:
    s_barrier
    s_cmp_eq_u32 s55, 2
    s_cbranch_scc0 L_k1_at6
    s_waitcnt vmcnt(0)
    buffer_atomic_add v11, off, s[44:47], 0 sc1
L_k1_at6:
    s_barrier
    s_cmp_eq_u32 s55, 3
    s_cbranch_scc0 L_k1_at7
    s_waitcnt vmcnt(0)
    buffer_atomic_add v11, off, s[44:47], 0 sc1
L_k1_at7:
    s_barrier
    s_cmp_eq_u32 s55, 4
    s_cbranch_scc0 L_k1_at8
    s_waitcnt vmcnt(0)
    buffer_atomic_add v11, off, s[44:47], 0 sc1
L_k1_at8:
    s_barrier
    s_cmp_eq_u32 s55, 5
    s_cbranch_scc0 L_k1_at9
    s_waitcnt vmcnt(0)
    buffer_atomic_add v11, off, s[44:47], 0 sc1
L_k1_at9:
    s_barrier
    s_cmp_eq_u32 s55, 6
    s_cbranch_scc0 L_k1_at10
    s_waitcnt vmcnt(0)
    buffer_atomic_add v11, off, s[44:47], 0 sc1
L_k1_at10:
    s_barrier
    s_cmp_eq_u32 s55, 7
    s_cbranch_scc0 L_k1_at11
    s_waitcnt vmcnt(0)
    buffer_atomic_add v11, off, s[44:47], 0 sc1
L_k1_at11:
    s_barrier
    s_cmp_eq_u32 s55, 8
    s_cbranch_scc0 L_k1_at12
    s_waitcnt vmcnt(0)
    buffer_atomic_add v11, off, s[44:47], 0 sc1
L_k1_at12:
    s_barrier
    s_cmp_eq_u32 s55, 9
    s_cbranch_scc0 L_k1_at13
    s_waitcnt vmcnt(0)
    buffer_atomic_add v11, off, s[44:47], 0 sc1
L_k1_at13:
    s_barrier
    s_cmp_eq_u32 s55, 10
    s_cbranch_scc0 L_k1_at14
    s_waitcnt vmcnt(0)
    buffer_atomic_add v11, off, s[44:47], 0 sc1
L_k1_at14:
    s_barrier
    s_cmp_eq_u32 s55, 11
    s_cbranch_scc0 L_k1_at15
    s_waitcnt vmcnt(0)
    buffer_atomic_add v11, off, s[44:47], 0 sc1
L_k1_at15:
    s_barrier
    s_cmp_eq_u32 s55, 12
    s_cbranch_scc0 L_k1_at16
    s_waitcnt vmcnt(0)
    buffer_atomic_add v11, off, s[44:47], 0 sc1
L_k1_at16:
    s_barrier
    s_cmp_eq_u32 s55, 13
    s_cbranch_scc0 L_k1_at17
    s_waitcnt vmcnt(0)
    buffer_atomic_add v11, off, s[44:47], 0 sc1
L_k1_at17:
    s_barrier
    s_barrier
    buffer_load_dword v10, off, s[44:47], 0 sc1
    s_barrier
    s_barrier
    s_barrier
L_k1_ck:
    s_memrealtime s[26:27]
    s_waitcnt vmcnt(0) lgkmcnt(0)
    v_readfirstlane_b32 s24, v10
    s_nop 0
    s_cmp_ge_u32 s24, 256
    s_cbranch_scc1 L_k1_ckx
    s_sub_u32 s26, s26, s14
    s_cmp_ge_i32 s26, 0
    s_cbranch_scc1 L_k1_ckx
    s_sleep 32
    buffer_load_dword v10, off, s[44:47], 0 sc1
    s_branch L_k1_ck
L_k1_ckx:
    s_barrier
    s_barrier
    s_barrier
    s_and_b64 exec, s[48:49], -1
    s_cbranch_scc0 L_k1_mk0_24
    buffer_store_dword v11, v12, s[32:35], s54 offen offset:0 sc1
L_k1_mk0_24:
    s_and_b64 exec, s[50:51], -1
    s_cbranch_scc0 L_k1_mk1_24
    buffer_store_dword v11, v12, s[32:35], s54 offen offset:8 sc1
L_k1_mk1_24:
    s_and_b64 exec, s[52:53], -1
    s_cbranch_scc0 L_k1_mk2_24
    buffer_store_dword v11, v12, s[32:35], s54 offen offset:16 sc1
L_k1_mk2_24:
L_k1_np24:
    s_mov_b64 exec, -1
    s_barrier
    s_barrier
    s_barrier
    s_barrier
    s_barrier
    s_branch L_g
L_k1_job:
    v_lshrrev_b32 v2, 3, v1
    v_and_b32 v3, 7, v1
    v_mul_u32_u24 v4, 1280, v2
    v_lshl_add_u32 v7, v3, 4, v4
    s_lshl_b32 s24, s21, 4
    s_add_u32 s24, s24, s22
    s_mul_i32 s48, s24, 10240
    s_lshl_b32 s24, s24, 5
    s_add_u32 s24, s24, 22216704
    v_lshlrev_b32 v4, 4, v3
    v_lshlrev_b32 v6, 2, v2
    v_lshl_add_u32 v6, v3, 27, v6
    v_mov_b32 v5, 0
    s_mov_b32 s25, 0xbfb8aa3b
    s_barrier
    s_barrier
    s_barrier
    s_barrier
    buffer_load_dwordx4 v[8:11], v4, s[36:39], 0 offen offset:0
    buffer_load_dwordx4 v[12:15], v4, s[36:39], 0 offen offset:128
    buffer_load_dwordx4 v[16:19], v4, s[36:39], 0 offen offset:256
    buffer_load_dwordx4 v[20:23], v4, s[36:39], 0 offen offset:384
    buffer_load_dwordx4 v[24:27], v4, s[36:39], 0 offen offset:512
    buffer_load_dwordx4 v[28:31], v4, s[36:39], 0 offen offset:640
    buffer_load_dwordx4 v[32:35], v4, s[36:39], 0 offen offset:768
    buffer_load_dwordx4 v[36:39], v4, s[36:39], 0 offen offset:896
    buffer_load_dwordx4 v[40:43], v4, s[36:39], 0 offen offset:1024
    buffer_load_dwordx4 v[44:47], v4, s[36:39], 0 offen offset:1152
    s_barrier
    s_barrier
    s_barrier
    s_barrier
    s_barrier
    s_barrier
    s_barrier
    s_barrier
    s_barrier
    s_barrier
    s_barrier
    s_barrier
    buffer_load_dwordx4 v[48:51], v7, s[40:43], s48 offen offset:0
    buffer_load_dwordx4 v[52:55], v7, s[40:43], s48 offen offset:128
    buffer_load_dwordx4 v[56:59], v7, s[40:43], s48 offen offset:256
    buffer_load_dwordx4 v[60:63], v7, s[40:43], s48 offen offset:384
    buffer_load_dwordx4 v[64:67], v7, s[40:43], s48 offen offset:512
    buffer_load_dwordx4 v[68:71], v7, s[40:43], s48 offen offset:640
    buffer_load_dwordx4 v[72:75], v7, s[40:43], s48 offen offset:768
    buffer_load_dwordx4 v[76:79], v7, s[40:43], s48 offen offset:896
    buffer_load_dwordx4 v[80:83], v7, s[40:43], s48 offen offset:1024
    buffer_load_dwordx4 v[84:87], v7, s[40:43], s48 offen offset:1152
    s_barrier
    s_barrier
    s_barrier
    s_waitcnt vmcnt(0)
    v_dot2c_f32_bf16 v5, v48, v8
    v_dot2c_f32_bf16 v5, v49, v9
    v_dot2c_f32_bf16 v5, v50, v10
    v_dot2c_f32_bf16 v5, v51, v11
    v_dot2c_f32_bf16 v5, v52, v12
    v_dot2c_f32_bf16 v5, v53, v13
    v_dot2c_f32_bf16 v5, v54, v14
    v_dot2c_f32_bf16 v5, v55, v15
    v_dot2c_f32_bf16 v5, v56, v16
    v_dot2c_f32_bf16 v5, v57, v17
    v_dot2c_f32_bf16 v5, v58, v18
    v_dot2c_f32_bf16 v5, v59, v19
    v_dot2c_f32_bf16 v5, v60, v20
    v_dot2c_f32_bf16 v5, v61, v21
    v_dot2c_f32_bf16 v5, v62, v22
    v_dot2c_f32_bf16 v5, v63, v23
    v_dot2c_f32_bf16 v5, v64, v24
    v_dot2c_f32_bf16 v5, v65, v25
    v_dot2c_f32_bf16 v5, v66, v26
    v_dot2c_f32_bf16 v5, v67, v27
    v_dot2c_f32_bf16 v5, v68, v28
    v_dot2c_f32_bf16 v5, v69, v29
    v_dot2c_f32_bf16 v5, v70, v30
    v_dot2c_f32_bf16 v5, v71, v31
    v_dot2c_f32_bf16 v5, v72, v32
    v_dot2c_f32_bf16 v5, v73, v33
    v_dot2c_f32_bf16 v5, v74, v34
    v_dot2c_f32_bf16 v5, v75, v35
    v_dot2c_f32_bf16 v5, v76, v36
    v_dot2c_f32_bf16 v5, v77, v37
    v_dot2c_f32_bf16 v5, v78, v38
    v_dot2c_f32_bf16 v5, v79, v39
    v_dot2c_f32_bf16 v5, v80, v40
    v_dot2c_f32_bf16 v5, v81, v41
    v_dot2c_f32_bf16 v5, v82, v42
    v_dot2c_f32_bf16 v5, v83, v43
    v_dot2c_f32_bf16 v5, v84, v44
    v_dot2c_f32_bf16 v5, v85, v45
    v_dot2c_f32_bf16 v5, v86, v46
    v_dot2c_f32_bf16 v5, v87, v47
    s_nop 2
    v_add_f32_dpp v5, v5, v5 quad_perm:[1,0,3,2] row_mask:0xf bank_mask:0xf
    s_nop 1
    v_add_f32_dpp v5, v5, v5 quad_perm:[2,3,0,1] row_mask:0xf bank_mask:0xf
    s_nop 1
    v_add_f32_dpp v5, v5, v5 row_half_mirror row_mask:0xf bank_mask:0xf
    v_cvt_pk_bf16_f32 v5, v5, v5
    v_lshlrev_b32 v5, 16, v5
    v_mul_f32 v5, s25, v5
    v_exp_f32 v5, v5
    s_nop 0
    v_add_f32 v5, 1.0, v5
    v_rcp_f32 v5, v5
    s_nop 0
    v_cvt_pk_bf16_f32 v5, v5, v5
    v_lshlrev_b32 v5, 16, v5
    buffer_store_dword v5, v6, s[32:35], s24 offen sc1
    s_barrier
    s_barrier
    s_barrier
    s_barrier
    s_barrier
    s_barrier
    s_barrier
    s_barrier
    s_barrier
    s_barrier
    s_barrier
    s_waitcnt vmcnt(0) lgkmcnt(0)
    s_barrier
L_g:
    buffer_load_dword v164, v165, s[32:35], s5 offen sc1
    s_load_dwordx2 s[36:37], s[0:1], 48
    s_load_dwordx2 s[40:41], s[0:1], 16
    s_load_dwordx2 s[44:45], s[0:1], 64
    s_mov_b64 s[30:31], 0
    ds_write_b128 v163, v[152:155] offset:28160
    ds_write_b128 v163, v[156:159] offset:28176
    s_branch L_k2_p0y
L_k2_p0:
    buffer_load_dword v164, v165, s[32:35], s5 offen sc1
L_k2_p0y:
    s_memrealtime s[50:51]
    s_waitcnt vmcnt(0) lgkmcnt(0)
    s_sub_u32 s50, s14, s50
    s_ashr_i32 s50, s50, 31
    v_or_b32 v164, s50, v164
    v_cmp_eq_u32 vcc, 0, v164
    s_nop 0
    s_lshr_b64 s[28:29], vcc, 2
    s_lshr_b64 s[50:51], s[28:29], 1
    s_or_b64 s[28:29], s[28:29], s[50:51]
    s_lshr_b64 s[50:51], s[28:29], 2
    s_or_b64 s[28:29], s[28:29], s[50:51]
    s_and_b64 vcc, vcc, s[6:7]
    s_cselect_b64 s[50:51], -1, 0
    s_or_b64 s[48:49], s[28:29], s[50:51]
    s_andn2_b64 s[48:49], s[8:9], s[48:49]
    s_cbranch_scc1 L_k2_p0x
    s_sleep 4
    s_branch L_k2_p0
L_k2_p0x:
    s_ff1_i32_b64 s24, s[48:49]
    s_bitset1_b64 s[30:31], s24
    s_mul_i32 s3, s24, 123392
    s_add_u32 m0, s4, 25088
    s_add_u32 s3, s3, 40960
    buffer_load_dwordx4 v88, s[32:35], s3 offen offset:0 sc1 lds
    buffer_load_dwordx4 v89, s[32:35], s3 offen offset:1024 sc1 lds
    buffer_load_dwordx4 v90, s[32:35], s3 offen offset:2048 sc1 lds
    s_add_u32 m0, s4, 37632
    s_add_u32 s3, s3, 123392
    buffer_load_dwordx4 v88, s[32:35], s3 offen offset:0 sc1 lds
    buffer_load_dwordx4 v89, s[32:35], s3 offen offset:1024 sc1 lds
    buffer_load_dwordx4 v90, s[32:35], s3 offen offset:2048 sc1 lds
    s_add_u32 m0, s12, 0
    s_nop 0
    buffer_load_dwordx4 v88, s[32:35], s11 offen sc1 lds
    s_mov_b64 exec, 0xffffffff
    buffer_load_dwordx4 v89, s[32:35], s11 offen offset:1024 sc1 lds
    s_mov_b64 exec, -1
    s_add_u32 s11, s11, 123392
    s_add_u32 m0, s12, 1536
    s_nop 0
    buffer_load_dwordx4 v88, s[32:35], s11 offen sc1 lds
    s_mov_b64 exec, 0xffffffff
    buffer_load_dwordx4 v89, s[32:35], s11 offen offset:1024 sc1 lds
    s_mov_b64 exec, -1
    s_add_u32 s11, s11, 123392
    s_mov_b32 s36, s36
    s_and_b32 s37, s37, 0xffff
    s_mov_b32 s38, 1966080
    s_mov_b32 s39, 0x00020000
    s_mov_b32 s40, s40
    s_and_b32 s41, s41, 0xffff
    s_mov_b32 s42, 819200
    s_mov_b32 s43, 0x00020000
    s_mov_b32 s44, s44
    s_and_b32 s45, s45, 0xffff
    s_mov_b32 s46, 2621440
    s_mov_b32 s47, 0x00020000
    v_lshlrev_b32 v5, 7, v1
    s_bfe_u32 s24, s2, 0x20003
    s_lshl_b32 s24, s24, 1
    s_lshr_b32 s25, s2, 5
    s_add_u32 s24, s24, s25
    s_mul_i32 s24, s24, 3
    s_lshr_b32 s24, s24, 1
    s_cmp_ge_u32 s24, 12
    s_cselect_b32 s25, 12, 0
    s_sub_u32 s24, s24, s25
    s_mov_b32 s24, 0
    s_mul_i32 s18, s24, 40960
    s_lshl_b32 s11, s24, 11
    s_and_b32 s24, s2, 7
    s_lshl_b32 s24, s24, 2
    s_bfe_u32 s25, s2, 0x20003
    s_add_u32 s24, s24, s25
    s_lshr_b32 s26, s2, 5
    s_mul_i32 s26, s26, 160
    s_mul_i32 s56, s19, 491520
    s_add_u32 s56, s56, s26
    s_mul_i32 s57, s19, 40
    s_add_u32 s57, s57, s26
    s_mul_i32 s57, s57, 640
    s_lshl_b32 s25, s24, 2
    s_add_u32 s25, s25, s19
    s_mul_i32 s97, s25, 20480
    s_add_u32 s97, s97, s26
    s_lshl_b32 s59, s25, 6
    s_add_u32 s59, s59, 22216704
    s_lshr_b32 s26, s25, 1
    s_mul_i32 s58, s26, 123392
    s_and_b32 s26, s25, 1
    s_lshl_b32 s26, s26, 8
    s_add_u32 s58, s58, s26
    s_lshr_b32 s26, s24, 1
    s_lshl_b32 s99, s26, 8
    s_add_u32 s99, s99, 22282368
    s_lshl_b32 s100, s21, 8
    s_lshl_b32 s26, s22, 2
    s_add_u32 s100, s100, s26
    s_add_u32 s100, s100, 22282368
    s_lshl_b32 s26, s19, 2
    s_lshl_b64 s[16:17], 15, s26
    s_mul_i32 s98, s19, 25600
    s_mul_i32 s24, s24, 197632
    s_mul_i32 s25, s19, 24576
    s_add_u32 s24, s24, s25
    s_add_u32 s24, s24, 8388608
    s_lshr_b32 s25, s2, 5
    s_lshl_b32 s23, s25, 13
    s_add_u32 s23, s23, s24
    s_cmp_ge_u32 s25, 3
    s_cselect_b32 s26, 74240, 0
    s_add_u32 s23, s23, s26
    s_cmp_ge_u32 s25, 6
    s_cselect_b32 s23, 1073741824, s23
    s_add_u32 s25, s19, 0
    s_and_b32 s25, s25, 3
    s_lshr_b32 s26, s25, 1
    s_mul_i32 s26, s26, 98816
    s_and_b32 s25, s25, 1
    s_lshl_b32 s25, s25, 8
    s_add_u32 s25, s25, s26
    s_add_u32 s52, s24, s25
    s_add_u32 s25, s19, 1
    s_and_b32 s25, s25, 3
    s_mul_i32 s6, s25, 25600
    s_lshr_b32 s26, s25, 1
    s_mul_i32 s26, s26, 98816
    s_and_b32 s25, s25, 1
    s_lshl_b32 s25, s25, 8
    s_add_u32 s25, s25, s26
    s_add_u32 s53, s24, s25
    s_add_u32 s25, s19, 2
    s_and_b32 s25, s25, 3
    s_mul_i32 s7, s25, 25600
    s_lshr_b32 s26, s25, 1
    s_mul_i32 s26, s26, 98816
    s_and_b32 s25, s25, 1
    s_lshl_b32 s25, s25, 8
    s_add_u32 s25, s25, s26
    s_add_u32 s54, s24, s25
    s_add_u32 s25, s19, 3
    s_and_b32 s25, s25, 3
    s_mul_i32 s12, s25, 25600
    s_lshr_b32 s26, s25, 1
    s_mul_i32 s26, s26, 98816
    s_and_b32 s25, s25, 1
    s_lshl_b32 s25, s25, 8
    s_add_u32 s25, s25, s26
    s_add_u32 s55, s24, s25
    v_lshrrev_b32 v8, 5, v1
    v_bfe_u32 v9, v1, 2, 3
    v_lshl_add_u32 v8, v8, 4, v9
    v_mul_u32_u24 v8, 160, v8
    v_and_b32 v9, 3, v1
    v_lshl_add_u32 v3, v9, 3, v8
    v_add_u32 v2, s98, v3
    v_lshrrev_b32 v8, 4, v1
    v_and_b32 v9, 15, v1
    v_lshlrev_b32 v10, 4, v9
    v_lshl_add_u32 v0, v8, 9, v10
    v_mul_u32_u24 v10, 1280, v9
    v_lshl_add_u32 v6, v8, 3, v10
    v_lshlrev_b32 v4, 2, v9
    v_mov_b32 v167, 1
    s_waitcnt vmcnt(0)
    s_barrier
    s_or_b64 s[48:49], s[28:29], s[30:31]
    s_andn2_b64 s[48:49], s[8:9], s[48:49]
    s_cbranch_scc1 L_k2_pc0x
L_k2_pc0:
    buffer_load_dword v164, v165, s[32:35], s5 offen sc1
L_k2_pc0y:
    s_memrealtime s[50:51]
    s_waitcnt vmcnt(0) lgkmcnt(0)
    s_sub_u32 s50, s14, s50
    s_ashr_i32 s50, s50, 31
    v_or_b32 v164, s50, v164
    v_cmp_eq_u32 vcc, 0, v164
    s_nop 0
    s_lshr_b64 s[28:29], vcc, 2
    s_lshr_b64 s[50:51], s[28:29], 1
    s_or_b64 s[28:29], s[28:29], s[50:51]
    s_lshr_b64 s[50:51], s[28:29], 2
    s_or_b64 s[28:29], s[28:29], s[50:51]
    s_or_b64 s[48:49], s[28:29], s[30:31]
    s_andn2_b64 s[48:49], s[8:9], s[48:49]
    s_cbranch_scc1 L_k2_pc0x
    s_sleep 4
    s_branch L_k2_pc0
L_k2_pc0x:
    s_lshr_b32 s24, 1126253345, s13
    s_lshl_b32 s24, s24, 3
    s_lshl_b64 s[50:51], -1, s24
    s_and_b64 s[50:51], s[50:51], s[48:49]
    s_cselect_b64 s[48:49], s[50:51], s[48:49]
    s_ff1_i32_b64 s24, s[48:49]
    s_bitset1_b64 s[30:31], s24
    s_mul_i32 s3, s24, 123392
    s_add_u32 m0, s4, 0
    s_add_u32 s3, s3, 40960
    buffer_load_dwordx4 v88, s[32:35], s3 offen offset:0 sc1 lds
    buffer_load_dwordx4 v89, s[32:35], s3 offen offset:1024 sc1 lds
    buffer_load_dwordx4 v90, s[32:35], s3 offen offset:2048 sc1 lds
    s_add_u32 m0, s4, 12544
    s_add_u32 s3, s3, 123392
    buffer_load_dwordx4 v88, s[32:35], s3 offen offset:0 sc1 lds
    buffer_load_dwordx4 v89, s[32:35], s3 offen offset:1024 sc1 lds
    buffer_load_dwordx4 v90, s[32:35], s3 offen offset:2048 sc1 lds
    ds_write_b128 v163, v[152:155] offset:3072
    ds_write_b128 v163, v[156:159] offset:3088
    s_min_u32 s24, s19, 2
    s_lshl_b32 s24, s24, 10
    s_add_u32 s24, s24, 160768
    v_lshl_add_u32 v7, v1, 3, s24
    ds_write_b64 v7, v[156:157] offset:0
    ds_write_b64 v7, v[156:157] offset:512
    v_lshlrev_b32 v1, 4, v1
    s_waitcnt lgkmcnt(0)
    s_setprio 3
    s_lshr_b32 s24, s2, 3
    s_mul_i32 s25, s19, 60
    s_add_u32 s24, s24, s25
    s_lshl_b32 s24, s24, 13
    buffer_load_dword v7, v5, s[36:39], s24 offen
    s_sub_u32 s24, s2, 56
    s_mul_i32 s25, s24, 205
    s_lshr_b32 s25, s25, 11
    s_mul_i32 s26, s25, 10
    s_sub_u32 s26, s24, s26
    s_lshl_b32 s10, s26, 8
    s_lshl2_add_u32 s10, s25, s10
    s_add_u32 s10, s10, 22302848
    s_lshl2_add_u32 s26, s26, s19
    s_mul_i32 s24, s25, 40960
    s_lshl_b32 s27, s26, 5
    s_add_u32 s24, s24, s27
    s_mul_i32 s27, s26, 52
    s_lshr_b32 s27, s27, 8
    s_mul_i32 s27, s27, 19
    s_add_u32 s25, s25, s27
    s_mul_i32 s25, s25, 5
    s_add_u32 s25, s25, s26
    s_lshl_b32 s25, s25, 10
    s_add_u32 s101, s25, 16777216
    s_cmp_lt_u32 s2, 56
    s_cselect_b32 s24, 1073741824, s24
    s_cselect_b32 s101, 1073741824, s101
    s_cselect_b32 s10, 1073741824, s10
    v_lshrrev_b32 v16, 8, v1
    v_bfe_u32 v17, v1, 5, 3
    v_mul_u32_u24 v24, 10240, v16
    v_lshl_add_u32 v24, v17, 2, v24
    buffer_load_dword v8, v24, s[40:43], s24 offen offset:0
    buffer_load_dword v9, v24, s[40:43], s24 offen offset:1280
    buffer_load_dword v10, v24, s[40:43], s24 offen offset:2560
    buffer_load_dword v11, v24, s[40:43], s24 offen offset:3840
    s_add_u32 s24, s24, 5120
    buffer_load_dword v12, v24, s[40:43], s24 offen offset:0
    buffer_load_dword v13, v24, s[40:43], s24 offen offset:1280
    buffer_load_dword v14, v24, s[40:43], s24 offen offset:2560
    buffer_load_dword v15, v24, s[40:43], s24 offen offset:3840
    v_bfe_u32 v25, v1, 4, 1
    v_mul_u32_u24 v25, 0x202, v25
    v_lshl_or_b32 v25, v25, 16, v25
    v_add_u32 v25, 0x05040100, v25
    s_add_u32 s40, s32, 16777216
    s_addc_u32 s41, s33, 0
    s_lshr_b32 s24, s2, 5
    s_mul_i32 s24, s24, 5
    s_lshr_b32 s24, s24, 2
    s_lshl_b32 s24, s24, 8
    s_add_u32 s24, s24, 22302848
    v_lshrrev_b32 v16, 9, v1
    v_bfe_u32 v17, v1, 4, 5
    v_min_u32 v17, 19, v17
    v_lshl_add_u32 v17, v17, 2, s24
    v_lshl_add_u32 v3, v16, 8, v17
    s_waitcnt vmcnt(9)
    s_setprio 3
    s_barrier
    s_cmp_eq_u32 s19, 3
    s_cbranch_scc0 L_k2_mk
    s_mov_b64 exec, 1
    buffer_store_dword v167, off, s[32:35], s100 sc1
    s_mov_b64 exec, -1
L_k2_mk:
    s_or_b64 s[48:49], s[28:29], s[30:31]
    s_andn2_b64 s[48:49], s[8:9], s[48:49]
    s_cbranch_scc1 L_k2_pc1x
L_k2_pc1:
    buffer_load_dword v164, v165, s[32:35], s5 offen sc1
L_k2_pc1y:
    s_memrealtime s[50:51]
    s_waitcnt vmcnt(0) lgkmcnt(0)
    s_sub_u32 s50, s14, s50
    s_ashr_i32 s50, s50, 31
    v_or_b32 v164, s50, v164
    v_cmp_eq_u32 vcc, 0, v164
    s_nop 0
    s_lshr_b64 s[28:29], vcc, 2
    s_lshr_b64 s[50:51], s[28:29], 1
    s_or_b64 s[28:29], s[28:29], s[50:51]
    s_lshr_b64 s[50:51], s[28:29], 2
    s_or_b64 s[28:29], s[28:29], s[50:51]
    s_or_b64 s[48:49], s[28:29], s[30:31]
    s_andn2_b64 s[48:49], s[8:9], s[48:49]
    s_cbranch_scc1 L_k2_pc1x
    s_sleep 4
    s_branch L_k2_pc1
L_k2_pc1x:
    s_lshr_b32 s24, 1702254437, s13
    s_lshl_b32 s24, s24, 3
    s_lshl_b64 s[50:51], -1, s24
    s_and_b64 s[50:51], s[50:51], s[48:49]
    s_cselect_b64 s[48:49], s[50:51], s[48:49]
    s_ff1_i32_b64 s24, s[48:49]
    s_bitset1_b64 s[30:31], s24
    s_mul_i32 s3, s24, 123392
    s_add_u32 m0, s4, 25088
    s_add_u32 s3, s3, 40960
    buffer_load_dwordx4 v88, s[32:35], s3 offen offset:0 sc1 lds
    buffer_load_dwordx4 v89, s[32:35], s3 offen offset:1024 sc1 lds
    buffer_load_dwordx4 v90, s[32:35], s3 offen offset:2048 sc1 lds
    s_add_u32 m0, s4, 37632
    s_add_u32 s3, s3, 123392
    buffer_load_dwordx4 v88, s[32:35], s3 offen offset:0 sc1 lds
    buffer_load_dwordx4 v89, s[32:35], s3 offen offset:1024 sc1 lds
    buffer_load_dwordx4 v90, s[32:35], s3 offen offset:2048 sc1 lds
    s_setprio 3
    s_add_u32 s20, s56, s18
    s_add_u32 s18, s18, 40960
    s_cmp_ge_u32 s18, 491520
    s_cselect_b32 s18, 0, s18
    s_add_u32 m0, s98, 0
    s_nop 0
    buffer_load_dwordx4 v91, s[36:39], s20 offen offset:0 lds
    buffer_load_dwordx4 v92, s[36:39], s20 offen offset:1024 lds
    buffer_load_dwordx4 v93, s[36:39], s20 offen offset:2048 lds
    buffer_load_dwordx4 v94, s[36:39], s20 offen offset:3072 lds
    s_add_u32 m0, s98, 4096
    s_nop 0
    buffer_load_dwordx4 v95, s[36:39], s20 offen offset:0 lds
    s_add_u32 s20, s56, s18
    s_add_u32 s18, s18, 40960
    s_cmp_ge_u32 s18, 491520
    s_cselect_b32 s18, 0, s18
    s_add_u32 m0, s98, 5120
    s_nop 0
    buffer_load_dwordx4 v91, s[36:39], s20 offen offset:0 lds
    buffer_load_dwordx4 v92, s[36:39], s20 offen offset:1024 lds
    buffer_load_dwordx4 v93, s[36:39], s20 offen offset:2048 lds
    buffer_load_dwordx4 v94, s[36:39], s20 offen offset:3072 lds
    s_add_u32 m0, s98, 9216
    s_nop 0
    buffer_load_dwordx4 v95, s[36:39], s20 offen offset:0 lds
    s_add_u32 s20, s56, s18
    s_add_u32 s18, s18, 40960
    s_cmp_ge_u32 s18, 491520
    s_cselect_b32 s18, 0, s18
    s_add_u32 m0, s98, 10240
    s_nop 0
    buffer_load_dwordx4 v91, s[36:39], s20 offen offset:0 lds
    buffer_load_dwordx4 v92, s[36:39], s20 offen offset:1024 lds
    buffer_load_dwordx4 v93, s[36:39], s20 offen offset:2048 lds
    buffer_load_dwordx4 v94, s[36:39], s20 offen offset:3072 lds
    s_add_u32 m0, s98, 14336
    s_nop 0
    buffer_load_dwordx4 v95, s[36:39], s20 offen offset:0 lds
    s_waitcnt vmcnt(21)
    v_perm_b32 v16, v9, v8, v25
    v_perm_b32 v17, v11, v10, v25
    v_perm_b32 v18, v13, v12, v25
    v_perm_b32 v19, v15, v14, v25
    buffer_store_dwordx4 v[16:19], v1, s[32:35], s101 offen sc1
    s_waitcnt vmcnt(16)
    s_setprio 3
    s_barrier
    s_or_b64 s[48:49], s[28:29], s[30:31]
    s_andn2_b64 s[48:49], s[8:9], s[48:49]
    s_cbranch_scc1 L_k2_pc2x
L_k2_pc2:
    buffer_load_dword v164, v165, s[32:35], s5 offen sc1
L_k2_pc2y:
    s_memrealtime s[50:51]
    s_waitcnt vmcnt(0) lgkmcnt(0)
    s_sub_u32 s50, s14, s50
    s_ashr_i32 s50, s50, 31
    v_or_b32 v164, s50, v164
    v_cmp_eq_u32 vcc, 0, v164
    s_nop 0
    s_lshr_b64 s[28:29], vcc, 2
    s_lshr_b64 s[50:51], s[28:29], 1
    s_or_b64 s[28:29], s[28:29], s[50:51]
    s_lshr_b64 s[50:51], s[28:29], 2
    s_or_b64 s[28:29], s[28:29], s[50:51]
    s_or_b64 s[48:49], s[28:29], s[30:31]
    s_andn2_b64 s[48:49], s[8:9], s[48:49]
    s_cbranch_scc1 L_k2_pc2x
    s_sleep 4
    s_branch L_k2_pc2
L_k2_pc2x:
    s_ff1_i32_b64 s24, s[48:49]
    s_bitset1_b64 s[30:31], s24
    s_mul_i32 s3, s24, 123392
    s_add_u32 m0, s4, 0
    s_add_u32 s3, s3, 40960
    buffer_load_dwordx4 v88, s[32:35], s3 offen offset:0 sc1 lds
    buffer_load_dwordx4 v89, s[32:35], s3 offen offset:1024 sc1 lds
    buffer_load_dwordx4 v90, s[32:35], s3 offen offset:2048 sc1 lds
    s_add_u32 m0, s4, 12544
    s_add_u32 s3, s3, 123392
    buffer_load_dwordx4 v88, s[32:35], s3 offen offset:0 sc1 lds
    buffer_load_dwordx4 v89, s[32:35], s3 offen offset:1024 sc1 lds
    buffer_load_dwordx4 v90, s[32:35], s3 offen offset:2048 sc1 lds
    s_setprio 3
    s_add_u32 s20, s56, s18
    s_add_u32 s18, s18, 40960
    s_cmp_ge_u32 s18, 491520
    s_cselect_b32 s18, 0, s18
    s_add_u32 m0, s98, 15360
    s_nop 0
    buffer_load_dwordx4 v91, s[36:39], s20 offen offset:0 lds
    buffer_load_dwordx4 v92, s[36:39], s20 offen offset:1024 lds
    buffer_load_dwordx4 v93, s[36:39], s20 offen offset:2048 lds
    buffer_load_dwordx4 v94, s[36:39], s20 offen offset:3072 lds
    s_add_u32 m0, s98, 19456
    s_nop 0
    buffer_load_dwordx4 v95, s[36:39], s20 offen offset:0 lds
    v_and_b32 v165, 65519, v165
L_k2_pa:
    buffer_load_dword v7, v4, s[32:35], s99 offen sc1
    buffer_load_dword v164, v165, s[32:35], s5 offen offset:8 sc1
    s_memrealtime s[50:51]
    s_waitcnt vmcnt(0) lgkmcnt(0)
    v_cmp_eq_u32 vcc, 0, v7
    s_nop 0
    s_and_b64 s[28:29], vcc, s[16:17]
    v_cmp_eq_u32 vcc, 0, v164
    s_nop 0
    s_or_b64 s[28:29], s[28:29], vcc
    s_cbranch_scc0 L_k2_pax
    s_sub_u32 s50, s50, s14
    s_cmp_ge_i32 s50, 0
    s_cbranch_scc1 L_k2_pax
    s_sleep 8
    s_branch L_k2_pa
L_k2_pax:
    s_mov_b64 s[28:29], 0
    s_add_u32 s20, s52, s11
    buffer_load_dwordx4 v[112:115], v0, s[32:35], s20 offen sc1
    s_add_u32 s20, s53, s11
    buffer_load_dwordx4 v[116:119], v0, s[32:35], s20 offen sc1
    s_add_u32 s20, s54, s11
    buffer_load_dwordx4 v[120:123], v0, s[32:35], s20 offen sc1
    s_add_u32 s20, s55, s11
    s_add_u32 s11, s11, 2048
    s_cmp_ge_u32 s11, 24576
    s_cselect_b32 s11, 0, s11
    buffer_load_dwordx4 v[124:127], v0, s[32:35], s20 offen sc1
    s_add_u32 s20, s52, s11
    buffer_load_dwordx4 v[128:131], v0, s[32:35], s20 offen sc1
    s_add_u32 s20, s53, s11
    buffer_load_dwordx4 v[132:135], v0, s[32:35], s20 offen sc1
    s_mov_b32 s25, 0
    s_or_b64 s[48:49], s[28:29], s[30:31]
    s_andn2_b64 s[48:49], s[8:9], s[48:49]
    s_ff1_i32_b64 s24, s[48:49]
    s_bitset1_b64 s[30:31], s24
    s_lshl_b32 s24, s24, 0
    s_or_b32 s25, s25, s24
    s_or_b64 s[48:49], s[28:29], s[30:31]
    s_andn2_b64 s[48:49], s[8:9], s[48:49]
    s_ff1_i32_b64 s24, s[48:49]
    s_bitset1_b64 s[30:31], s24
    s_lshl_b32 s24, s24, 6
    s_or_b32 s25, s25, s24
    s_or_b64 s[48:49], s[28:29], s[30:31]
    s_andn2_b64 s[48:49], s[8:9], s[48:49]
    s_ff1_i32_b64 s24, s[48:49]
    s_bitset1_b64 s[30:31], s24
    s_lshl_b32 s24, s24, 12
    s_or_b32 s25, s25, s24
    s_or_b64 s[48:49], s[28:29], s[30:31]
    s_andn2_b64 s[48:49], s[8:9], s[48:49]
    s_ff1_i32_b64 s24, s[48:49]
    s_bitset1_b64 s[30:31], s24
    s_lshl_b32 s24, s24, 18
    s_or_b32 s25, s25, s24
    s_lshl2_add_u32 s24, s19, 162816
    v_mov_b32 v88, s24
    v_mov_b32 v89, s25
    ds_write_b32 v88, v89 offset:544
    s_waitcnt lgkmcnt(0)
    s_setprio 3
    s_barrier
    s_setprio 3
    s_add_u32 s20, s56, s18
    s_add_u32 s18, s18, 40960
    s_cmp_ge_u32 s18, 491520
    s_cselect_b32 s18, 0, s18
    s_add_u32 m0, s98, 20480
    s_nop 0
    buffer_load_dwordx4 v91, s[36:39], s20 offen offset:0 lds
    buffer_load_dwordx4 v92, s[36:39], s20 offen offset:1024 lds
    buffer_load_dwordx4 v93, s[36:39], s20 offen offset:2048 lds
    buffer_load_dwordx4 v94, s[36:39], s20 offen offset:3072 lds
    s_add_u32 m0, s98, 24576
    s_nop 0
    buffer_load_dwordx4 v95, s[36:39], s20 offen offset:0 lds
    s_cmp_eq_u32 s19, 3
    s_cbranch_scc0 L_k2_tf
    s_mov_b64 exec, 1
    buffer_store_dword v2, off, s[32:35], s10 sc1
    s_mov_b64 exec, -1
L_k2_tf:
    s_add_u32 s20, s54, s11
    buffer_load_dwordx4 v[136:139], v0, s[32:35], s20 offen sc1
    s_add_u32 s20, s55, s11
    s_add_u32 s11, s11, 2048
    s_cmp_ge_u32 s11, 24576
    s_cselect_b32 s11, 0, s11
    buffer_load_dwordx4 v[140:143], v0, s[32:35], s20 offen sc1
    s_add_u32 s20, s52, s11
    buffer_load_dwordx4 v[144:147], v0, s[32:35], s20 offen sc1
    s_add_u32 s20, s53, s11
    buffer_load_dwordx4 v[148:151], v0, s[32:35], s20 offen sc1
    s_add_u32 s20, s54, s11
    buffer_load_dwordx4 v[152:155], v0, s[32:35], s20 offen sc1
    s_add_u32 s20, s55, s11
    s_add_u32 s11, s11, 2048
    s_cmp_ge_u32 s11, 24576
    s_cselect_b32 s11, 0, s11
    buffer_load_dwordx4 v[156:159], v0, s[32:35], s20 offen sc1
    s_add_u32 s20, s52, s11
    buffer_load_dwordx4 v[160:163], v0, s[32:35], s20 offen sc1
    s_add_u32 s20, s53, s11
    buffer_load_dwordx4 v[164:167], v0, s[32:35], s20 offen sc1
    ds_read_b64_tr_b16 v[96:97], v2 offset:0
    ds_read_b64_tr_b16 v[98:99], v2 offset:1280
    ds_read_b64_tr_b16 v[100:101], v2 offset:32
    ds_read_b64_tr_b16 v[102:103], v2 offset:1312
    ds_read_b64_tr_b16 v[104:105], v2 offset:64
    ds_read_b64_tr_b16 v[106:107], v2 offset:1344
    ds_read_b64_tr_b16 v[108:109], v2 offset:96
    ds_read_b64_tr_b16 v[110:111], v2 offset:1376
    s_waitcnt vmcnt(18) lgkmcnt(6)
    v_mfma_f32_16x16x32_bf16 v[8:11], v[96:99], v[112:115], 0
    s_waitcnt vmcnt(17)
    v_mfma_f32_16x16x32_bf16 v[28:31], v[96:99], v[116:119], 0
    s_waitcnt vmcnt(16)
    v_mfma_f32_16x16x32_bf16 v[48:51], v[96:99], v[120:123], 0
    s_waitcnt vmcnt(15)
    v_mfma_f32_16x16x32_bf16 v[68:71], v[96:99], v[124:127], 0
    s_waitcnt lgkmcnt(4)
    v_mfma_f32_16x16x32_bf16 v[12:15], v[100:103], v[112:115], 0
    v_mfma_f32_16x16x32_bf16 v[32:35], v[100:103], v[116:119], 0
    ds_read_b64_tr_b16 v[96:97], v2 offset:128
    ds_read_b64_tr_b16 v[98:99], v2 offset:1408
    v_mfma_f32_16x16x32_bf16 v[52:55], v[100:103], v[120:123], 0
    v_mfma_f32_16x16x32_bf16 v[72:75], v[100:103], v[124:127], 0
    s_waitcnt lgkmcnt(4)
    v_mfma_f32_16x16x32_bf16 v[16:19], v[104:107], v[112:115], 0
    v_mfma_f32_16x16x32_bf16 v[36:39], v[104:107], v[116:119], 0
    ds_read_b64_tr_b16 v[100:101], v2 offset:5120
    ds_read_b64_tr_b16 v[102:103], v2 offset:6400
    v_mfma_f32_16x16x32_bf16 v[56:59], v[104:107], v[120:123], 0
    v_mfma_f32_16x16x32_bf16 v[76:79], v[104:107], v[124:127], 0
    s_waitcnt lgkmcnt(4)
    v_mfma_f32_16x16x32_bf16 v[20:23], v[108:111], v[112:115], 0
    v_mfma_f32_16x16x32_bf16 v[40:43], v[108:111], v[116:119], 0
    ds_read_b64_tr_b16 v[104:105], v2 offset:5152
    ds_read_b64_tr_b16 v[106:107], v2 offset:6432
    v_mfma_f32_16x16x32_bf16 v[60:63], v[108:111], v[120:123], 0
    v_mfma_f32_16x16x32_bf16 v[80:83], v[108:111], v[124:127], 0
    s_waitcnt lgkmcnt(4)
    v_mfma_f32_16x16x32_bf16 v[24:27], v[96:99], v[112:115], 0
    s_add_u32 s20, s56, s18
    s_add_u32 s18, s18, 40960
    s_cmp_ge_u32 s18, 491520
    s_cselect_b32 s18, 0, s18
    s_add_u32 m0, s98, 0
    s_nop 0
    buffer_load_dwordx4 v91, s[36:39], s20 offen offset:0 lds
    buffer_load_dwordx4 v92, s[36:39], s20 offen offset:1024 lds
    buffer_load_dwordx4 v93, s[36:39], s20 offen offset:2048 lds
    buffer_load_dwordx4 v94, s[36:39], s20 offen offset:3072 lds
    s_add_u32 m0, s98, 4096
    s_nop 0
    buffer_load_dwordx4 v95, s[36:39], s20 offen offset:0 lds
    v_mfma_f32_16x16x32_bf16 v[44:47], v[96:99], v[116:119], 0
    ds_read_b64_tr_b16 v[108:109], v2 offset:5184
    ds_read_b64_tr_b16 v[110:111], v2 offset:6464
    s_add_u32 s20, s54, s11
    buffer_load_dwordx4 v[112:115], v0, s[32:35], s20 offen sc1
    v_mfma_f32_16x16x32_bf16 v[64:67], v[96:99], v[120:123], 0
    s_add_u32 s20, s55, s11
    s_add_u32 s11, s11, 2048
    s_cmp_ge_u32 s11, 24576
    s_cselect_b32 s11, 0, s11
    buffer_load_dwordx4 v[116:119], v0, s[32:35], s20 offen sc1
    v_mfma_f32_16x16x32_bf16 v[84:87], v[96:99], v[124:127], 0
    s_add_u32 s20, s52, s11
    buffer_load_dwordx4 v[120:123], v0, s[32:35], s20 offen sc1
    s_waitcnt vmcnt(22) lgkmcnt(4)
    v_mfma_f32_16x16x32_bf16 v[8:11], v[100:103], v[128:131], v[8:11]
    s_add_u32 s20, s53, s11
    buffer_load_dwordx4 v[124:127], v0, s[32:35], s20 offen sc1
    s_waitcnt vmcnt(22)
    v_mfma_f32_16x16x32_bf16 v[28:31], v[100:103], v[132:135], v[28:31]
    ds_read_b64_tr_b16 v[96:97], v2 offset:5216
    ds_read_b64_tr_b16 v[98:99], v2 offset:6496
    s_waitcnt vmcnt(16)
    v_mfma_f32_16x16x32_bf16 v[48:51], v[100:103], v[136:139], v[48:51]
    s_waitcnt vmcnt(15)
    v_mfma_f32_16x16x32_bf16 v[68:71], v[100:103], v[140:143], v[68:71]
    s_waitcnt lgkmcnt(4)
    v_mfma_f32_16x16x32_bf16 v[12:15], v[104:107], v[128:131], v[12:15]
    v_mfma_f32_16x16x32_bf16 v[32:35], v[104:107], v[132:135], v[32:35]
    ds_read_b64_tr_b16 v[100:101], v2 offset:5248
    ds_read_b64_tr_b16 v[102:103], v2 offset:6528
    v_mfma_f32_16x16x32_bf16 v[52:55], v[104:107], v[136:139], v[52:55]
    v_mfma_f32_16x16x32_bf16 v[72:75], v[104:107], v[140:143], v[72:75]
    s_waitcnt lgkmcnt(4)
    v_mfma_f32_16x16x32_bf16 v[16:19], v[108:111], v[128:131], v[16:19]
    v_mfma_f32_16x16x32_bf16 v[36:39], v[108:111], v[132:135], v[36:39]
    ds_read_b64_tr_b16 v[104:105], v2 offset:10240
    ds_read_b64_tr_b16 v[106:107], v2 offset:11520
    v_mfma_f32_16x16x32_bf16 v[56:59], v[108:111], v[136:139], v[56:59]
    v_mfma_f32_16x16x32_bf16 v[76:79], v[108:111], v[140:143], v[76:79]
    s_waitcnt lgkmcnt(4)
    v_mfma_f32_16x16x32_bf16 v[20:23], v[96:99], v[128:131], v[20:23]
    v_mfma_f32_16x16x32_bf16 v[40:43], v[96:99], v[132:135], v[40:43]
    ds_read_b64_tr_b16 v[108:109], v2 offset:10272
    ds_read_b64_tr_b16 v[110:111], v2 offset:11552
    v_mfma_f32_16x16x32_bf16 v[60:63], v[96:99], v[136:139], v[60:63]
    v_mfma_f32_16x16x32_bf16 v[80:83], v[96:99], v[140:143], v[80:83]
    s_waitcnt lgkmcnt(4)
    v_mfma_f32_16x16x32_bf16 v[24:27], v[100:103], v[128:131], v[24:27]
    s_add_u32 s20, s56, s18
    s_add_u32 s18, s18, 40960
    s_cmp_ge_u32 s18, 491520
    s_cselect_b32 s18, 0, s18
    s_add_u32 m0, s98, 5120
    s_nop 0
    buffer_load_dwordx4 v91, s[36:39], s20 offen offset:0 lds
    buffer_load_dwordx4 v92, s[36:39], s20 offen offset:1024 lds
    buffer_load_dwordx4 v93, s[36:39], s20 offen offset:2048 lds
    buffer_load_dwordx4 v94, s[36:39], s20 offen offset:3072 lds
    s_add_u32 m0, s98, 9216
    s_nop 0
    buffer_load_dwordx4 v95, s[36:39], s20 offen offset:0 lds
    v_mfma_f32_16x16x32_bf16 v[44:47], v[100:103], v[132:135], v[44:47]
    ds_read_b64_tr_b16 v[96:97], v2 offset:10304
    ds_read_b64_tr_b16 v[98:99], v2 offset:11584
    s_add_u32 s20, s54, s11
    buffer_load_dwordx4 v[128:131], v0, s[32:35], s20 offen sc1
    v_mfma_f32_16x16x32_bf16 v[64:67], v[100:103], v[136:139], v[64:67]
    s_add_u32 s20, s55, s11
    s_add_u32 s11, s11, 2048
    s_cmp_ge_u32 s11, 24576
    s_cselect_b32 s11, 0, s11
    buffer_load_dwordx4 v[132:135], v0, s[32:35], s20 offen sc1
    v_mfma_f32_16x16x32_bf16 v[84:87], v[100:103], v[140:143], v[84:87]
    s_add_u32 s20, s52, s11
    buffer_load_dwordx4 v[136:139], v0, s[32:35], s20 offen sc1
    buffer_load_dword v7, v3, s[32:35], 0 offen sc1
    s_waitcnt vmcnt(23) lgkmcnt(4)
    v_mfma_f32_16x16x32_bf16 v[8:11], v[104:107], v[144:147], v[8:11]
    s_add_u32 s20, s53, s11
    buffer_load_dwordx4 v[140:143], v0, s[32:35], s20 offen sc1
    s_waitcnt vmcnt(23)
    v_mfma_f32_16x16x32_bf16 v[28:31], v[104:107], v[148:151], v[28:31]
    ds_read_b64_tr_b16 v[100:101], v2 offset:10336
    ds_read_b64_tr_b16 v[102:103], v2 offset:11616
    s_waitcnt vmcnt(22)
    v_mfma_f32_16x16x32_bf16 v[48:51], v[104:107], v[152:155], v[48:51]
    s_waitcnt vmcnt(21)
    v_mfma_f32_16x16x32_bf16 v[68:71], v[104:107], v[156:159], v[68:71]
    s_waitcnt lgkmcnt(4)
    v_mfma_f32_16x16x32_bf16 v[12:15], v[108:111], v[144:147], v[12:15]
    v_mfma_f32_16x16x32_bf16 v[32:35], v[108:111], v[148:151], v[32:35]
    ds_read_b64_tr_b16 v[104:105], v2 offset:10368
    ds_read_b64_tr_b16 v[106:107], v2 offset:11648
    v_mfma_f32_16x16x32_bf16 v[52:55], v[108:111], v[152:155], v[52:55]
    v_mfma_f32_16x16x32_bf16 v[72:75], v[108:111], v[156:159], v[72:75]
    s_waitcnt lgkmcnt(4)
    v_mfma_f32_16x16x32_bf16 v[16:19], v[96:99], v[144:147], v[16:19]
    v_mfma_f32_16x16x32_bf16 v[36:39], v[96:99], v[148:151], v[36:39]
    ds_read_b64_tr_b16 v[108:109], v2 offset:15360
    ds_read_b64_tr_b16 v[110:111], v2 offset:16640
    v_mfma_f32_16x16x32_bf16 v[56:59], v[96:99], v[152:155], v[56:59]
    v_mfma_f32_16x16x32_bf16 v[76:79], v[96:99], v[156:159], v[76:79]
    s_waitcnt lgkmcnt(4)
    v_mfma_f32_16x16x32_bf16 v[20:23], v[100:103], v[144:147], v[20:23]
    v_mfma_f32_16x16x32_bf16 v[40:43], v[100:103], v[148:151], v[40:43]
    ds_read_b64_tr_b16 v[96:97], v2 offset:15392
    ds_read_b64_tr_b16 v[98:99], v2 offset:16672
    v_mfma_f32_16x16x32_bf16 v[60:63], v[100:103], v[152:155], v[60:63]
    v_mfma_f32_16x16x32_bf16 v[80:83], v[100:103], v[156:159], v[80:83]
    s_waitcnt lgkmcnt(4)
    v_mfma_f32_16x16x32_bf16 v[24:27], v[104:107], v[144:147], v[24:27]
    s_add_u32 s20, s56, s18
    s_add_u32 s18, s18, 40960
    s_cmp_ge_u32 s18, 491520
    s_cselect_b32 s18, 0, s18
    s_add_u32 m0, s98, 10240
    s_nop 0
    buffer_load_dwordx4 v91, s[36:39], s20 offen offset:0 lds
    buffer_load_dwordx4 v92, s[36:39], s20 offen offset:1024 lds
    buffer_load_dwordx4 v93, s[36:39], s20 offen offset:2048 lds
    buffer_load_dwordx4 v94, s[36:39], s20 offen offset:3072 lds
    s_add_u32 m0, s98, 14336
    s_nop 0
    buffer_load_dwordx4 v95, s[36:39], s20 offen offset:0 lds
    v_mfma_f32_16x16x32_bf16 v[44:47], v[104:107], v[148:151], v[44:47]
    ds_read_b64_tr_b16 v[100:101], v2 offset:15424
    ds_read_b64_tr_b16 v[102:103], v2 offset:16704
    s_add_u32 s20, s54, s11
    buffer_load_dwordx4 v[144:147], v0, s[32:35], s20 offen sc1
    v_mfma_f32_16x16x32_bf16 v[64:67], v[104:107], v[152:155], v[64:67]
    s_add_u32 s20, s55, s11
    s_add_u32 s11, s11, 2048
    s_cmp_ge_u32 s11, 24576
    s_cselect_b32 s11, 0, s11
    buffer_load_dwordx4 v[148:151], v0, s[32:35], s20 offen sc1
    v_mfma_f32_16x16x32_bf16 v[84:87], v[104:107], v[156:159], v[84:87]
    s_add_u32 s20, s52, s11
    buffer_load_dwordx4 v[152:155], v0, s[32:35], s20 offen sc1
    s_waitcnt vmcnt(28) lgkmcnt(4)
    v_mfma_f32_16x16x32_bf16 v[8:11], v[108:111], v[160:163], v[8:11]
    s_add_u32 s20, s53, s11
    buffer_load_dwordx4 v[156:159], v0, s[32:35], s20 offen sc1
    s_waitcnt vmcnt(28)
    v_mfma_f32_16x16x32_bf16 v[28:31], v[108:111], v[164:167], v[28:31]
    ds_read_b64_tr_b16 v[104:105], v2 offset:15456
    ds_read_b64_tr_b16 v[106:107], v2 offset:16736
    s_waitcnt vmcnt(22)
    v_mfma_f32_16x16x32_bf16 v[48:51], v[108:111], v[112:115], v[48:51]
    s_waitcnt vmcnt(21)
    v_mfma_f32_16x16x32_bf16 v[68:71], v[108:111], v[116:119], v[68:71]
    s_waitcnt lgkmcnt(4)
    v_mfma_f32_16x16x32_bf16 v[12:15], v[96:99], v[160:163], v[12:15]
    v_mfma_f32_16x16x32_bf16 v[32:35], v[96:99], v[164:167], v[32:35]
    ds_read_b64_tr_b16 v[108:109], v2 offset:15488
    ds_read_b64_tr_b16 v[110:111], v2 offset:16768
    v_mfma_f32_16x16x32_bf16 v[52:55], v[96:99], v[112:115], v[52:55]
    v_mfma_f32_16x16x32_bf16 v[72:75], v[96:99], v[116:119], v[72:75]
    s_waitcnt lgkmcnt(4)
    v_mfma_f32_16x16x32_bf16 v[16:19], v[100:103], v[160:163], v[16:19]
    v_mfma_f32_16x16x32_bf16 v[36:39], v[100:103], v[164:167], v[36:39]
    ds_read_b64_tr_b16 v[96:97], v2 offset:20480
    ds_read_b64_tr_b16 v[98:99], v2 offset:21760
    v_mfma_f32_16x16x32_bf16 v[56:59], v[100:103], v[112:115], v[56:59]
    v_mfma_f32_16x16x32_bf16 v[76:79], v[100:103], v[116:119], v[76:79]
    s_waitcnt lgkmcnt(4)
    v_mfma_f32_16x16x32_bf16 v[20:23], v[104:107], v[160:163], v[20:23]
    v_mfma_f32_16x16x32_bf16 v[40:43], v[104:107], v[164:167], v[40:43]
    ds_read_b64_tr_b16 v[100:101], v2 offset:20512
    ds_read_b64_tr_b16 v[102:103], v2 offset:21792
    v_mfma_f32_16x16x32_bf16 v[60:63], v[104:107], v[112:115], v[60:63]
    v_mfma_f32_16x16x32_bf16 v[80:83], v[104:107], v[116:119], v[80:83]
    s_waitcnt lgkmcnt(4)
    v_mfma_f32_16x16x32_bf16 v[24:27], v[108:111], v[160:163], v[24:27]
    s_add_u32 s20, s56, s18
    s_add_u32 s18, s18, 40960
    s_cmp_ge_u32 s18, 491520
    s_cselect_b32 s18, 0, s18
    s_add_u32 m0, s98, 15360
    s_nop 0
    buffer_load_dwordx4 v91, s[36:39], s20 offen offset:0 lds
    buffer_load_dwordx4 v92, s[36:39], s20 offen offset:1024 lds
    buffer_load_dwordx4 v93, s[36:39], s20 offen offset:2048 lds
    buffer_load_dwordx4 v94, s[36:39], s20 offen offset:3072 lds
    s_add_u32 m0, s98, 19456
    s_nop 0
    buffer_load_dwordx4 v95, s[36:39], s20 offen offset:0 lds
    v_mfma_f32_16x16x32_bf16 v[44:47], v[108:111], v[164:167], v[44:47]
    ds_read_b64_tr_b16 v[104:105], v2 offset:20544
    ds_read_b64_tr_b16 v[106:107], v2 offset:21824
    s_add_u32 s20, s54, s11
    buffer_load_dwordx4 v[160:163], v0, s[32:35], s20 offen sc1
    v_mfma_f32_16x16x32_bf16 v[64:67], v[108:111], v[112:115], v[64:67]
    s_add_u32 s20, s55, s11
    s_add_u32 s11, s11, 2048
    s_cmp_ge_u32 s11, 24576
    s_cselect_b32 s11, 0, s11
    buffer_load_dwordx4 v[164:167], v0, s[32:35], s20 offen sc1
    v_mfma_f32_16x16x32_bf16 v[84:87], v[108:111], v[116:119], v[84:87]
    s_add_u32 s20, s52, s11
    buffer_load_dwordx4 v[112:115], v0, s[32:35], s20 offen sc1
    s_waitcnt vmcnt(28) lgkmcnt(4)
    v_mfma_f32_16x16x32_bf16 v[8:11], v[96:99], v[120:123], v[8:11]
    s_add_u32 s20, s53, s11
    buffer_load_dwordx4 v[116:119], v0, s[32:35], s20 offen sc1
    s_waitcnt vmcnt(28)
    v_mfma_f32_16x16x32_bf16 v[28:31], v[96:99], v[124:127], v[28:31]
    ds_read_b64_tr_b16 v[108:109], v2 offset:20576
    ds_read_b64_tr_b16 v[110:111], v2 offset:21856
    s_waitcnt vmcnt(22)
    v_mfma_f32_16x16x32_bf16 v[48:51], v[96:99], v[128:131], v[48:51]
    s_waitcnt vmcnt(21)
    v_mfma_f32_16x16x32_bf16 v[68:71], v[96:99], v[132:135], v[68:71]
    s_waitcnt lgkmcnt(4)
    v_mfma_f32_16x16x32_bf16 v[12:15], v[100:103], v[120:123], v[12:15]
    v_mfma_f32_16x16x32_bf16 v[32:35], v[100:103], v[124:127], v[32:35]
    ds_read_b64_tr_b16 v[96:97], v2 offset:20608
    ds_read_b64_tr_b16 v[98:99], v2 offset:21888
    v_mfma_f32_16x16x32_bf16 v[52:55], v[100:103], v[128:131], v[52:55]
    v_mfma_f32_16x16x32_bf16 v[72:75], v[100:103], v[132:135], v[72:75]
    s_waitcnt lgkmcnt(4)
    v_mfma_f32_16x16x32_bf16 v[16:19], v[104:107], v[120:123], v[16:19]
    v_mfma_f32_16x16x32_bf16 v[36:39], v[104:107], v[124:127], v[36:39]
    ds_read_b64_tr_b16 v[100:101], v2 offset:0
    ds_read_b64_tr_b16 v[102:103], v2 offset:1280
    v_mfma_f32_16x16x32_bf16 v[56:59], v[104:107], v[128:131], v[56:59]
    v_mfma_f32_16x16x32_bf16 v[76:79], v[104:107], v[132:135], v[76:79]
    s_waitcnt lgkmcnt(4)
    v_mfma_f32_16x16x32_bf16 v[20:23], v[108:111], v[120:123], v[20:23]
    v_mfma_f32_16x16x32_bf16 v[40:43], v[108:111], v[124:127], v[40:43]
    ds_read_b64_tr_b16 v[104:105], v2 offset:32
    ds_read_b64_tr_b16 v[106:107], v2 offset:1312
    v_mfma_f32_16x16x32_bf16 v[60:63], v[108:111], v[128:131], v[60:63]
    v_mfma_f32_16x16x32_bf16 v[80:83], v[108:111], v[132:135], v[80:83]
    s_waitcnt lgkmcnt(4)
    v_mfma_f32_16x16x32_bf16 v[24:27], v[96:99], v[120:123], v[24:27]
    s_add_u32 s20, s56, s18
    s_add_u32 s18, s18, 40960
    s_cmp_ge_u32 s18, 491520
    s_cselect_b32 s18, 0, s18
    s_add_u32 m0, s98, 20480
    s_nop 0
    buffer_load_dwordx4 v91, s[36:39], s20 offen offset:0 lds
    buffer_load_dwordx4 v92, s[36:39], s20 offen offset:1024 lds
    buffer_load_dwordx4 v93, s[36:39], s20 offen offset:2048 lds
    buffer_load_dwordx4 v94, s[36:39], s20 offen offset:3072 lds
    s_add_u32 m0, s98, 24576
    s_nop 0
    buffer_load_dwordx4 v95, s[36:39], s20 offen offset:0 lds
    v_mfma_f32_16x16x32_bf16 v[44:47], v[96:99], v[124:127], v[44:47]
    ds_read_b64_tr_b16 v[108:109], v2 offset:64
    ds_read_b64_tr_b16 v[110:111], v2 offset:1344
    s_add_u32 s20, s54, s11
    buffer_load_dwordx4 v[120:123], v0, s[32:35], s20 offen sc1
    v_mfma_f32_16x16x32_bf16 v[64:67], v[96:99], v[128:131], v[64:67]
    s_add_u32 s20, s55, s11
    s_add_u32 s11, s11, 2048
    s_cmp_ge_u32 s11, 24576
    s_cselect_b32 s11, 0, s11
    buffer_load_dwordx4 v[124:127], v0, s[32:35], s20 offen sc1
    v_mfma_f32_16x16x32_bf16 v[84:87], v[96:99], v[132:135], v[84:87]
    s_add_u32 s20, s52, s11
    buffer_load_dwordx4 v[128:131], v0, s[32:35], s20 offen sc1
    s_waitcnt vmcnt(28) lgkmcnt(4)
    v_mfma_f32_16x16x32_bf16 v[8:11], v[100:103], v[136:139], v[8:11]
    s_add_u32 s20, s53, s11
    buffer_load_dwordx4 v[132:135], v0, s[32:35], s20 offen sc1
    s_waitcnt vmcnt(27)
    v_mfma_f32_16x16x32_bf16 v[28:31], v[100:103], v[140:143], v[28:31]
    ds_read_b64_tr_b16 v[96:97], v2 offset:96
    ds_read_b64_tr_b16 v[98:99], v2 offset:1376
    s_waitcnt vmcnt(21)
    v_mfma_f32_16x16x32_bf16 v[48:51], v[100:103], v[144:147], v[48:51]
    s_waitcnt vmcnt(20)
    v_mfma_f32_16x16x32_bf16 v[68:71], v[100:103], v[148:151], v[68:71]
    s_waitcnt lgkmcnt(4)
    v_mfma_f32_16x16x32_bf16 v[12:15], v[104:107], v[136:139], v[12:15]
    v_mfma_f32_16x16x32_bf16 v[32:35], v[104:107], v[140:143], v[32:35]
    ds_read_b64_tr_b16 v[100:101], v2 offset:128
    ds_read_b64_tr_b16 v[102:103], v2 offset:1408
    v_mfma_f32_16x16x32_bf16 v[52:55], v[104:107], v[144:147], v[52:55]
    v_mfma_f32_16x16x32_bf16 v[72:75], v[104:107], v[148:151], v[72:75]
    s_waitcnt lgkmcnt(4)
    v_mfma_f32_16x16x32_bf16 v[16:19], v[108:111], v[136:139], v[16:19]
    v_mfma_f32_16x16x32_bf16 v[36:39], v[108:111], v[140:143], v[36:39]
    ds_read_b64_tr_b16 v[104:105], v2 offset:5120
    ds_read_b64_tr_b16 v[106:107], v2 offset:6400
L_k2_tw:
    v_cmp_eq_u32 vcc, 0, v7
    s_nop 0
    s_cbranch_vccz L_k2_twx
    s_sleep 8
    buffer_load_dword v7, v3, s[32:35], 0 offen sc1
    s_memrealtime s[50:51]
    s_waitcnt vmcnt(0) lgkmcnt(0)
    s_sub_u32 s50, s50, s14
    s_cmp_ge_i32 s50, 0
    s_cbranch_scc0 L_k2_tw
L_k2_twx:
    v_mfma_f32_16x16x32_bf16 v[56:59], v[108:111], v[144:147], v[56:59]
    v_mfma_f32_16x16x32_bf16 v[76:79], v[108:111], v[148:151], v[76:79]
    s_waitcnt lgkmcnt(4)
    v_mfma_f32_16x16x32_bf16 v[20:23], v[96:99], v[136:139], v[20:23]
    v_mfma_f32_16x16x32_bf16 v[40:43], v[96:99], v[140:143], v[40:43]
    ds_read_b64_tr_b16 v[108:109], v2 offset:5152
    ds_read_b64_tr_b16 v[110:111], v2 offset:6432
    v_mfma_f32_16x16x32_bf16 v[60:63], v[96:99], v[144:147], v[60:63]
    v_mfma_f32_16x16x32_bf16 v[80:83], v[96:99], v[148:151], v[80:83]
    s_waitcnt lgkmcnt(4)
    v_mfma_f32_16x16x32_bf16 v[24:27], v[100:103], v[136:139], v[24:27]
    s_add_u32 s20, s56, s18
    s_add_u32 s18, s18, 40960
    s_cmp_ge_u32 s18, 491520
    s_cselect_b32 s18, 0, s18
    s_add_u32 m0, s98, 0
    s_nop 0
    buffer_load_dwordx4 v91, s[36:39], s20 offen offset:0 lds
    buffer_load_dwordx4 v92, s[36:39], s20 offen offset:1024 lds
    buffer_load_dwordx4 v93, s[36:39], s20 offen offset:2048 lds
    buffer_load_dwordx4 v94, s[36:39], s20 offen offset:3072 lds
    s_add_u32 m0, s98, 4096
    s_nop 0
    buffer_load_dwordx4 v95, s[36:39], s20 offen offset:0 lds
    v_mfma_f32_16x16x32_bf16 v[44:47], v[100:103], v[140:143], v[44:47]
    ds_read_b64_tr_b16 v[96:97], v2 offset:5184
    ds_read_b64_tr_b16 v[98:99], v2 offset:6464
    s_add_u32 s20, s54, s11
    buffer_load_dwordx4 v[136:139], v0, s[32:35], s20 offen sc1
    v_mfma_f32_16x16x32_bf16 v[64:67], v[100:103], v[144:147], v[64:67]
    s_add_u32 s20, s55, s11
    s_add_u32 s11, s11, 2048
    s_cmp_ge_u32 s11, 24576
    s_cselect_b32 s11, 0, s11
    buffer_load_dwordx4 v[140:143], v0, s[32:35], s20 offen sc1
    v_mfma_f32_16x16x32_bf16 v[84:87], v[100:103], v[148:151], v[84:87]
    s_add_u32 s20, s52, s11
    buffer_load_dwordx4 v[144:147], v0, s[32:35], s20 offen sc1
    s_waitcnt vmcnt(27) lgkmcnt(4)
    v_mfma_f32_16x16x32_bf16 v[8:11], v[104:107], v[152:155], v[8:11]
    s_add_u32 s20, s53, s11
    buffer_load_dwordx4 v[148:151], v0, s[32:35], s20 offen sc1
    s_waitcnt vmcnt(27)
    v_mfma_f32_16x16x32_bf16 v[28:31], v[104:107], v[156:159], v[28:31]
    ds_read_b64_tr_b16 v[100:101], v2 offset:5216
    ds_read_b64_tr_b16 v[102:103], v2 offset:6496
    s_waitcnt vmcnt(21)
    v_mfma_f32_16x16x32_bf16 v[48:51], v[104:107], v[160:163], v[48:51]
    s_waitcnt vmcnt(20)
    v_mfma_f32_16x16x32_bf16 v[68:71], v[104:107], v[164:167], v[68:71]
    s_waitcnt lgkmcnt(4)
    v_mfma_f32_16x16x32_bf16 v[12:15], v[108:111], v[152:155], v[12:15]
    v_mfma_f32_16x16x32_bf16 v[32:35], v[108:111], v[156:159], v[32:35]
    ds_read_b64_tr_b16 v[104:105], v2 offset:5248
    ds_read_b64_tr_b16 v[106:107], v2 offset:6528
    v_mfma_f32_16x16x32_bf16 v[52:55], v[108:111], v[160:163], v[52:55]
    v_mfma_f32_16x16x32_bf16 v[72:75], v[108:111], v[164:167], v[72:75]
    s_waitcnt lgkmcnt(4)
    v_mfma_f32_16x16x32_bf16 v[16:19], v[96:99], v[152:155], v[16:19]
    v_mfma_f32_16x16x32_bf16 v[36:39], v[96:99], v[156:159], v[36:39]
    ds_read_b64_tr_b16 v[108:109], v2 offset:10240
    ds_read_b64_tr_b16 v[110:111], v2 offset:11520
    v_mfma_f32_16x16x32_bf16 v[56:59], v[96:99], v[160:163], v[56:59]
    v_mfma_f32_16x16x32_bf16 v[76:79], v[96:99], v[164:167], v[76:79]
    s_waitcnt lgkmcnt(4)
    v_mfma_f32_16x16x32_bf16 v[20:23], v[100:103], v[152:155], v[20:23]
    v_mfma_f32_16x16x32_bf16 v[40:43], v[100:103], v[156:159], v[40:43]
    ds_read_b64_tr_b16 v[96:97], v2 offset:10272
    ds_read_b64_tr_b16 v[98:99], v2 offset:11552
    v_mfma_f32_16x16x32_bf16 v[60:63], v[100:103], v[160:163], v[60:63]
    v_mfma_f32_16x16x32_bf16 v[80:83], v[100:103], v[164:167], v[80:83]
    s_waitcnt lgkmcnt(4)
    v_mfma_f32_16x16x32_bf16 v[24:27], v[104:107], v[152:155], v[24:27]
    s_add_u32 s20, s56, s18
    s_add_u32 s18, s18, 40960
    s_cmp_ge_u32 s18, 491520
    s_cselect_b32 s18, 0, s18
    s_add_u32 m0, s98, 5120
    s_nop 0
    buffer_load_dwordx4 v91, s[36:39], s20 offen offset:0 lds
    buffer_load_dwordx4 v92, s[36:39], s20 offen offset:1024 lds
    buffer_load_dwordx4 v93, s[36:39], s20 offen offset:2048 lds
    buffer_load_dwordx4 v94, s[36:39], s20 offen offset:3072 lds
    s_add_u32 m0, s98, 9216
    s_nop 0
    buffer_load_dwordx4 v95, s[36:39], s20 offen offset:0 lds
    v_mfma_f32_16x16x32_bf16 v[44:47], v[104:107], v[156:159], v[44:47]
    ds_read_b64_tr_b16 v[100:101], v2 offset:10304
    ds_read_b64_tr_b16 v[102:103], v2 offset:11584
    s_add_u32 s20, s54, s11
    buffer_load_dwordx4 v[152:155], v0, s[32:35], s20 offen sc1
    v_mfma_f32_16x16x32_bf16 v[64:67], v[104:107], v[160:163], v[64:67]
    s_add_u32 s20, s55, s11
    s_add_u32 s11, s11, 2048
    s_cmp_ge_u32 s11, 24576
    s_cselect_b32 s11, 0, s11
    buffer_load_dwordx4 v[156:159], v0, s[32:35], s20 offen sc1
    v_mfma_f32_16x16x32_bf16 v[84:87], v[104:107], v[164:167], v[84:87]
    s_add_u32 s20, s52, s11
    buffer_load_dwordx4 v[160:163], v0, s[32:35], s20 offen sc1
    s_waitcnt vmcnt(27) lgkmcnt(4)
    v_mfma_f32_16x16x32_bf16 v[8:11], v[108:111], v[112:115], v[8:11]
    s_add_u32 s20, s53, s11
    buffer_load_dwordx4 v[164:167], v0, s[32:35], s20 offen sc1
    s_waitcnt vmcnt(27)
    v_mfma_f32_16x16x32_bf16 v[28:31], v[108:111], v[116:119], v[28:31]
    ds_read_b64_tr_b16 v[104:105], v2 offset:10336
    ds_read_b64_tr_b16 v[106:107], v2 offset:11616
    s_waitcnt vmcnt(21)
    v_mfma_f32_16x16x32_bf16 v[48:51], v[108:111], v[120:123], v[48:51]
    s_waitcnt vmcnt(20)
    v_mfma_f32_16x16x32_bf16 v[68:71], v[108:111], v[124:127], v[68:71]
    s_waitcnt lgkmcnt(4)
    v_mfma_f32_16x16x32_bf16 v[12:15], v[96:99], v[112:115], v[12:15]
    v_mfma_f32_16x16x32_bf16 v[32:35], v[96:99], v[116:119], v[32:35]
    ds_read_b64_tr_b16 v[108:109], v2 offset:10368
    ds_read_b64_tr_b16 v[110:111], v2 offset:11648
    v_mfma_f32_16x16x32_bf16 v[52:55], v[96:99], v[120:123], v[52:55]
    v_mfma_f32_16x16x32_bf16 v[72:75], v[96:99], v[124:127], v[72:75]
    s_waitcnt lgkmcnt(4)
    v_mfma_f32_16x16x32_bf16 v[16:19], v[100:103], v[112:115], v[16:19]
    v_mfma_f32_16x16x32_bf16 v[36:39], v[100:103], v[116:119], v[36:39]
    ds_read_b64_tr_b16 v[96:97], v2 offset:15360
    ds_read_b64_tr_b16 v[98:99], v2 offset:16640
    v_mfma_f32_16x16x32_bf16 v[56:59], v[100:103], v[120:123], v[56:59]
    v_mfma_f32_16x16x32_bf16 v[76:79], v[100:103], v[124:127], v[76:79]
    s_waitcnt lgkmcnt(4)
    v_mfma_f32_16x16x32_bf16 v[20:23], v[104:107], v[112:115], v[20:23]
    v_mfma_f32_16x16x32_bf16 v[40:43], v[104:107], v[116:119], v[40:43]
    ds_read_b64_tr_b16 v[100:101], v2 offset:15392
    ds_read_b64_tr_b16 v[102:103], v2 offset:16672
    v_mfma_f32_16x16x32_bf16 v[60:63], v[104:107], v[120:123], v[60:63]
    v_mfma_f32_16x16x32_bf16 v[80:83], v[104:107], v[124:127], v[80:83]
    s_waitcnt lgkmcnt(4)
    v_mfma_f32_16x16x32_bf16 v[24:27], v[108:111], v[112:115], v[24:27]
    v_mfma_f32_16x16x32_bf16 v[44:47], v[108:111], v[116:119], v[44:47]
    ds_read_b64_tr_b16 v[104:105], v2 offset:15424
    ds_read_b64_tr_b16 v[106:107], v2 offset:16704
    s_add_u32 s20, s54, s11
    buffer_load_dwordx4 v[112:115], v0, s[32:35], s20 offen sc1
    v_mfma_f32_16x16x32_bf16 v[64:67], v[108:111], v[120:123], v[64:67]
    s_add_u32 s20, s55, s11
    s_add_u32 s11, s11, 2048
    s_cmp_ge_u32 s11, 24576
    s_cselect_b32 s11, 0, s11
    buffer_load_dwordx4 v[116:119], v0, s[32:35], s20 offen sc1
    v_mfma_f32_16x16x32_bf16 v[84:87], v[108:111], v[124:127], v[84:87]
    s_add_u32 s20, s52, s11
    buffer_load_dwordx4 v[120:123], v0, s[32:35], s20 offen sc1
    s_waitcnt vmcnt(22) lgkmcnt(4)
    v_mfma_f32_16x16x32_bf16 v[8:11], v[96:99], v[128:131], v[8:11]
    s_add_u32 s20, s53, s11
    buffer_load_dwordx4 v[124:127], v0, s[32:35], s20 offen sc1
    s_waitcnt vmcnt(22)
    v_mfma_f32_16x16x32_bf16 v[28:31], v[96:99], v[132:135], v[28:31]
    ds_read_b64_tr_b16 v[108:109], v2 offset:15456
    ds_read_b64_tr_b16 v[110:111], v2 offset:16736
    s_waitcnt vmcnt(16)
    v_mfma_f32_16x16x32_bf16 v[48:51], v[96:99], v[136:139], v[48:51]
    s_waitcnt vmcnt(15)
    v_mfma_f32_16x16x32_bf16 v[68:71], v[96:99], v[140:143], v[68:71]
    s_waitcnt lgkmcnt(4)
    v_mfma_f32_16x16x32_bf16 v[12:15], v[100:103], v[128:131], v[12:15]
    v_mfma_f32_16x16x32_bf16 v[32:35], v[100:103], v[132:135], v[32:35]
    ds_read_b64_tr_b16 v[96:97], v2 offset:15488
    ds_read_b64_tr_b16 v[98:99], v2 offset:16768
    v_mfma_f32_16x16x32_bf16 v[52:55], v[100:103], v[136:139], v[52:55]
    v_mfma_f32_16x16x32_bf16 v[72:75], v[100:103], v[140:143], v[72:75]
    s_waitcnt lgkmcnt(4)
    v_mfma_f32_16x16x32_bf16 v[16:19], v[104:107], v[128:131], v[16:19]
    v_mfma_f32_16x16x32_bf16 v[36:39], v[104:107], v[132:135], v[36:39]
    ds_read_b64_tr_b16 v[100:101], v2 offset:20480
    ds_read_b64_tr_b16 v[102:103], v2 offset:21760
    v_mfma_f32_16x16x32_bf16 v[56:59], v[104:107], v[136:139], v[56:59]
    v_mfma_f32_16x16x32_bf16 v[76:79], v[104:107], v[140:143], v[76:79]
    s_waitcnt lgkmcnt(4)
    v_mfma_f32_16x16x32_bf16 v[20:23], v[108:111], v[128:131], v[20:23]
    v_mfma_f32_16x16x32_bf16 v[40:43], v[108:111], v[132:135], v[40:43]
    ds_read_b64_tr_b16 v[104:105], v2 offset:20512
    ds_read_b64_tr_b16 v[106:107], v2 offset:21792
    v_mfma_f32_16x16x32_bf16 v[60:63], v[108:111], v[136:139], v[60:63]
    v_mfma_f32_16x16x32_bf16 v[80:83], v[108:111], v[140:143], v[80:83]
    s_waitcnt lgkmcnt(4)
    v_mfma_f32_16x16x32_bf16 v[24:27], v[96:99], v[128:131], v[24:27]
    v_mfma_f32_16x16x32_bf16 v[44:47], v[96:99], v[132:135], v[44:47]
    ds_read_b64_tr_b16 v[108:109], v2 offset:20544
    ds_read_b64_tr_b16 v[110:111], v2 offset:21824
    s_add_u32 s20, s54, s11
    buffer_load_dwordx4 v[128:131], v0, s[32:35], s20 offen sc1
    v_mfma_f32_16x16x32_bf16 v[64:67], v[96:99], v[136:139], v[64:67]
    s_add_u32 s20, s55, s11
    s_add_u32 s11, s11, 2048
    s_cmp_ge_u32 s11, 24576
    s_cselect_b32 s11, 0, s11
    buffer_load_dwordx4 v[132:135], v0, s[32:35], s20 offen sc1
    v_mfma_f32_16x16x32_bf16 v[84:87], v[96:99], v[140:143], v[84:87]
    s_waitcnt vmcnt(16) lgkmcnt(4)
    v_mfma_f32_16x16x32_bf16 v[8:11], v[100:103], v[144:147], v[8:11]
    s_waitcnt vmcnt(15)
    v_mfma_f32_16x16x32_bf16 v[28:31], v[100:103], v[148:151], v[28:31]
    ds_read_b64_tr_b16 v[96:97], v2 offset:20576
    ds_read_b64_tr_b16 v[98:99], v2 offset:21856
    s_waitcnt vmcnt(9)
    v_mfma_f32_16x16x32_bf16 v[48:51], v[100:103], v[152:155], v[48:51]
    s_waitcnt vmcnt(8)
    v_mfma_f32_16x16x32_bf16 v[68:71], v[100:103], v[156:159], v[68:71]
    s_waitcnt lgkmcnt(4)
    v_mfma_f32_16x16x32_bf16 v[12:15], v[104:107], v[144:147], v[12:15]
    v_mfma_f32_16x16x32_bf16 v[32:35], v[104:107], v[148:151], v[32:35]
    ds_read_b64_tr_b16 v[100:101], v2 offset:20608
    ds_read_b64_tr_b16 v[102:103], v2 offset:21888
    v_mfma_f32_16x16x32_bf16 v[52:55], v[104:107], v[152:155], v[52:55]
    v_mfma_f32_16x16x32_bf16 v[72:75], v[104:107], v[156:159], v[72:75]
    s_waitcnt lgkmcnt(4)
    v_mfma_f32_16x16x32_bf16 v[16:19], v[108:111], v[144:147], v[16:19]
    v_mfma_f32_16x16x32_bf16 v[36:39], v[108:111], v[148:151], v[36:39]
    ds_read_b64_tr_b16 v[104:105], v2 offset:0
    ds_read_b64_tr_b16 v[106:107], v2 offset:1280
    v_mfma_f32_16x16x32_bf16 v[56:59], v[108:111], v[152:155], v[56:59]
    v_mfma_f32_16x16x32_bf16 v[76:79], v[108:111], v[156:159], v[76:79]
    s_waitcnt lgkmcnt(4)
    v_mfma_f32_16x16x32_bf16 v[20:23], v[96:99], v[144:147], v[20:23]
    v_mfma_f32_16x16x32_bf16 v[40:43], v[96:99], v[148:151], v[40:43]
    ds_read_b64_tr_b16 v[108:109], v2 offset:32
    ds_read_b64_tr_b16 v[110:111], v2 offset:1312
    v_mfma_f32_16x16x32_bf16 v[60:63], v[96:99], v[152:155], v[60:63]
    v_mfma_f32_16x16x32_bf16 v[80:83], v[96:99], v[156:159], v[80:83]
    s_waitcnt lgkmcnt(4)
    v_mfma_f32_16x16x32_bf16 v[24:27], v[100:103], v[144:147], v[24:27]
    ds_write_b32 v88, v88 offset:576
    v_mfma_f32_16x16x32_bf16 v[44:47], v[100:103], v[148:151], v[44:47]
    ds_read_b64_tr_b16 v[96:97], v2 offset:64
    ds_read_b64_tr_b16 v[98:99], v2 offset:1344
    v_mfma_f32_16x16x32_bf16 v[64:67], v[100:103], v[152:155], v[64:67]
    v_mfma_f32_16x16x32_bf16 v[84:87], v[100:103], v[156:159], v[84:87]
    s_waitcnt vmcnt(7) lgkmcnt(5)
    v_mfma_f32_16x16x32_bf16 v[8:11], v[104:107], v[160:163], v[8:11]
    s_waitcnt vmcnt(6)
    v_mfma_f32_16x16x32_bf16 v[28:31], v[104:107], v[164:167], v[28:31]
    ds_read_b64_tr_b16 v[100:101], v2 offset:96
    ds_read_b64_tr_b16 v[102:103], v2 offset:1376
    s_waitcnt vmcnt(5)
    v_mfma_f32_16x16x32_bf16 v[48:51], v[104:107], v[112:115], v[48:51]
    s_waitcnt vmcnt(4)
    v_mfma_f32_16x16x32_bf16 v[68:71], v[104:107], v[116:119], v[68:71]
    s_waitcnt lgkmcnt(5)
    v_mfma_f32_16x16x32_bf16 v[12:15], v[108:111], v[160:163], v[12:15]
    v_mfma_f32_16x16x32_bf16 v[32:35], v[108:111], v[164:167], v[32:35]
    ds_read_b64_tr_b16 v[104:105], v2 offset:128
    ds_read_b64_tr_b16 v[106:107], v2 offset:1408
    v_mfma_f32_16x16x32_bf16 v[52:55], v[108:111], v[112:115], v[52:55]
    v_mfma_f32_16x16x32_bf16 v[72:75], v[108:111], v[116:119], v[72:75]
    s_waitcnt lgkmcnt(4)
    v_mfma_f32_16x16x32_bf16 v[16:19], v[96:99], v[160:163], v[16:19]
    v_mfma_f32_16x16x32_bf16 v[36:39], v[96:99], v[164:167], v[36:39]
    ds_read_b64_tr_b16 v[108:109], v2 offset:5120
    ds_read_b64_tr_b16 v[110:111], v2 offset:6400
    v_mfma_f32_16x16x32_bf16 v[56:59], v[96:99], v[112:115], v[56:59]
    v_mfma_f32_16x16x32_bf16 v[76:79], v[96:99], v[116:119], v[76:79]
    s_waitcnt lgkmcnt(4)
    v_mfma_f32_16x16x32_bf16 v[20:23], v[100:103], v[160:163], v[20:23]
    v_mfma_f32_16x16x32_bf16 v[40:43], v[100:103], v[164:167], v[40:43]
    ds_read_b64_tr_b16 v[96:97], v2 offset:5152
    ds_read_b64_tr_b16 v[98:99], v2 offset:6432
    v_mfma_f32_16x16x32_bf16 v[60:63], v[100:103], v[112:115], v[60:63]
    v_mfma_f32_16x16x32_bf16 v[80:83], v[100:103], v[116:119], v[80:83]
    s_waitcnt lgkmcnt(4)
    v_mfma_f32_16x16x32_bf16 v[24:27], v[104:107], v[160:163], v[24:27]
    s_add_u32 m0, s98, 0
    s_add_u32 s20, s57, 0
    buffer_load_dwordx4 v1, s[40:43], s20 offen offset:0 sc1 lds
    buffer_load_dwordx4 v1, s[40:43], s20 offen offset:1024 sc1 lds
    buffer_load_dwordx4 v1, s[40:43], s20 offen offset:2048 sc1 lds
    buffer_load_dwordx4 v1, s[40:43], s20 offen offset:3072 sc1 lds
    s_add_u32 m0, s98, 4096
    s_add_u32 s20, s57, 4096
    buffer_load_dwordx4 v1, s[40:43], s20 offen offset:0 sc1 lds
    v_mfma_f32_16x16x32_bf16 v[44:47], v[104:107], v[164:167], v[44:47]
    ds_read_b64_tr_b16 v[100:101], v2 offset:5184
    ds_read_b64_tr_b16 v[102:103], v2 offset:6464
    v_mfma_f32_16x16x32_bf16 v[64:67], v[104:107], v[112:115], v[64:67]
    v_mfma_f32_16x16x32_bf16 v[84:87], v[104:107], v[116:119], v[84:87]
    v_bfe_u32 v89, v1, 2, 6
    v_add_u32 v89, 162816, v89
    v_add_u32 v92, s6, v1
    v_add_u32 v93, s7, v1
    v_add_u32 v94, s12, v1
L_k2_fr:
    ds_read_b32 v90, v89 offset:576
    s_waitcnt lgkmcnt(0)
    v_cmp_eq_u32 vcc, 0, v90
    s_nop 0
    s_and_b32 vcc_lo, vcc_lo, 15
    s_cbranch_scc0 L_k2_frx
    s_sleep 1
    s_branch L_k2_fr
L_k2_frx:
    s_waitcnt vmcnt(8)
    v_mfma_f32_16x16x32_bf16 v[8:11], v[108:111], v[120:123], v[8:11]
    s_waitcnt vmcnt(7)
    v_mfma_f32_16x16x32_bf16 v[28:31], v[108:111], v[124:127], v[28:31]
    ds_read_b64_tr_b16 v[104:105], v2 offset:5216
    ds_read_b64_tr_b16 v[106:107], v2 offset:6496
    s_waitcnt vmcnt(6)
    v_mfma_f32_16x16x32_bf16 v[48:51], v[108:111], v[128:131], v[48:51]
    s_waitcnt vmcnt(5)
    v_mfma_f32_16x16x32_bf16 v[68:71], v[108:111], v[132:135], v[68:71]
    v_mfma_f32_16x16x32_bf16 v[12:15], v[96:99], v[120:123], v[12:15]
    v_mfma_f32_16x16x32_bf16 v[32:35], v[96:99], v[124:127], v[32:35]
    ds_read_b64_tr_b16 v[108:109], v2 offset:5248
    ds_read_b64_tr_b16 v[110:111], v2 offset:6528
    ds_write_b128 v92, v[28:31] offset:10240
    s_sleep 1
    v_mfma_f32_16x16x32_bf16 v[52:55], v[96:99], v[128:131], v[52:55]
    ds_write_b128 v93, v[48:51] offset:15360
    s_sleep 1
    v_mfma_f32_16x16x32_bf16 v[72:75], v[96:99], v[132:135], v[72:75]
    ds_write_b128 v94, v[68:71] offset:20480
    s_sleep 1
    v_mfma_f32_16x16x32_bf16 v[16:19], v[100:103], v[120:123], v[16:19]
    v_mfma_f32_16x16x32_bf16 v[36:39], v[100:103], v[124:127], v[36:39]
    ds_write_b128 v92, v[32:35] offset:11264
    s_sleep 1
    v_mfma_f32_16x16x32_bf16 v[56:59], v[100:103], v[128:131], v[56:59]
    ds_write_b128 v93, v[52:55] offset:16384
    s_sleep 1
    v_mfma_f32_16x16x32_bf16 v[76:79], v[100:103], v[132:135], v[76:79]
    ds_write_b128 v94, v[72:75] offset:21504
    s_sleep 1
    s_waitcnt lgkmcnt(8)
    v_mfma_f32_16x16x32_bf16 v[20:23], v[104:107], v[120:123], v[20:23]
    v_mfma_f32_16x16x32_bf16 v[40:43], v[104:107], v[124:127], v[40:43]
    ds_write_b128 v92, v[36:39] offset:12288
    s_sleep 1
    v_mfma_f32_16x16x32_bf16 v[60:63], v[104:107], v[128:131], v[60:63]
    ds_write_b128 v93, v[56:59] offset:17408
    s_sleep 1
    v_mfma_f32_16x16x32_bf16 v[80:83], v[104:107], v[132:135], v[80:83]
    ds_write_b128 v94, v[76:79] offset:22528
    s_sleep 1
    s_waitcnt lgkmcnt(9)
    v_mfma_f32_16x16x32_bf16 v[24:27], v[108:111], v[120:123], v[24:27]
    s_add_u32 m0, s98, 5120
    s_add_u32 s20, s57, 5120
    buffer_load_dwordx4 v1, s[40:43], s20 offen offset:0 sc1 lds
    buffer_load_dwordx4 v1, s[40:43], s20 offen offset:1024 sc1 lds
    buffer_load_dwordx4 v1, s[40:43], s20 offen offset:2048 sc1 lds
    buffer_load_dwordx4 v1, s[40:43], s20 offen offset:3072 sc1 lds
    s_add_u32 m0, s98, 9216
    s_add_u32 s20, s57, 9216
    buffer_load_dwordx4 v1, s[40:43], s20 offen offset:0 sc1 lds
    v_mfma_f32_16x16x32_bf16 v[44:47], v[108:111], v[124:127], v[44:47]
    ds_write_b128 v92, v[40:43] offset:13312
    s_sleep 1
    v_mfma_f32_16x16x32_bf16 v[64:67], v[108:111], v[128:131], v[64:67]
    ds_write_b128 v93, v[60:63] offset:18432
    s_sleep 1
    v_mfma_f32_16x16x32_bf16 v[84:87], v[108:111], v[132:135], v[84:87]
    ds_write_b128 v94, v[80:83] offset:23552
    s_sleep 1
    s_setprio 3
    buffer_load_dword v5, v4, s[32:35], s99 offen sc1
    ds_write_b128 v92, v[44:47] offset:14336
    s_sleep 1
    ds_write_b128 v93, v[64:67] offset:19456
    s_sleep 1
    ds_write_b128 v94, v[84:87] offset:24576
    v_add_u32 v2, 32, v88
    ds_write_b32 v2, v2 offset:16
    v_add_u32 v7, s98, v1
    v_mov_b32 v3, v89
L_k2_px:
    ds_read_b32 v90, v89 offset:0
    s_waitcnt lgkmcnt(0)
    v_cmp_eq_u32 vcc, 0, v90
    s_nop 0
    s_and_b32 vcc_lo, vcc_lo, 61440
    s_cbranch_scc0 L_k2_pxx
    s_sleep 1
    s_branch L_k2_px
L_k2_pxx:
    ds_read_b128 v[28:31], v7 offset:10240
    ds_read_b128 v[32:35], v7 offset:11264
    ds_read_b128 v[36:39], v7 offset:12288
    ds_read_b128 v[40:43], v7 offset:13312
    ds_read_b128 v[44:47], v7 offset:14336
    ds_read_b128 v[48:51], v7 offset:15360
    ds_read_b128 v[52:55], v7 offset:16384
    ds_read_b128 v[56:59], v7 offset:17408
    ds_read_b128 v[60:63], v7 offset:18432
    ds_read_b128 v[64:67], v7 offset:19456
    ds_read_b128 v[68:71], v7 offset:20480
    ds_read_b128 v[72:75], v7 offset:21504
    ds_read_b128 v[76:79], v7 offset:22528
    ds_read_b128 v[80:83], v7 offset:23552
    ds_read_b128 v[84:87], v7 offset:24576
    s_waitcnt lgkmcnt(10)
    s_add_u32 m0, s98, 10240
    s_add_u32 s20, s57, 10240
    buffer_load_dwordx4 v1, s[40:43], s20 offen offset:0 sc1 lds
    buffer_load_dwordx4 v1, s[40:43], s20 offen offset:1024 sc1 lds
    buffer_load_dwordx4 v1, s[40:43], s20 offen offset:2048 sc1 lds
    buffer_load_dwordx4 v1, s[40:43], s20 offen offset:3072 sc1 lds
    s_add_u32 m0, s98, 14336
    s_add_u32 s20, s57, 14336
    buffer_load_dwordx4 v1, s[40:43], s20 offen offset:0 sc1 lds
    s_waitcnt lgkmcnt(5)
    s_add_u32 m0, s98, 15360
    s_add_u32 s20, s57, 15360
    buffer_load_dwordx4 v1, s[40:43], s20 offen offset:0 sc1 lds
    buffer_load_dwordx4 v1, s[40:43], s20 offen offset:1024 sc1 lds
    buffer_load_dwordx4 v1, s[40:43], s20 offen offset:2048 sc1 lds
    buffer_load_dwordx4 v1, s[40:43], s20 offen offset:3072 sc1 lds
    s_add_u32 m0, s98, 19456
    s_add_u32 s20, s57, 19456
    buffer_load_dwordx4 v1, s[40:43], s20 offen offset:0 sc1 lds
    s_waitcnt lgkmcnt(0)
    s_add_u32 m0, s98, 20480
    s_add_u32 s20, s57, 20480
    buffer_load_dwordx4 v1, s[40:43], s20 offen offset:0 sc1 lds
    buffer_load_dwordx4 v1, s[40:43], s20 offen offset:1024 sc1 lds
    buffer_load_dwordx4 v1, s[40:43], s20 offen offset:2048 sc1 lds
    buffer_load_dwordx4 v1, s[40:43], s20 offen offset:3072 sc1 lds
    s_add_u32 m0, s98, 24576
    s_add_u32 s20, s57, 24576
    buffer_load_dwordx4 v1, s[40:43], s20 offen offset:0 sc1 lds
    s_waitcnt vmcnt(15)
    v_cmp_eq_u32 vcc, 0, v5
    s_nop 0
    s_cbranch_vccz L_k2_pgx
L_k2_pg:
    buffer_load_dword v7, v4, s[32:35], s99 offen sc1
    s_memrealtime s[50:51]
    s_waitcnt vmcnt(0) lgkmcnt(0)
    v_cmp_eq_u32 vcc, 0, v7
    s_nop 0
    s_and_b64 s[28:29], vcc, -1
    s_cbranch_scc0 L_k2_pgx
    s_sub_u32 s50, s50, s14
    s_cmp_ge_i32 s50, 0
    s_cbranch_scc1 L_k2_pgx
    s_sleep 8
    s_branch L_k2_pg
L_k2_pgx:
    s_mov_b64 s[28:29], 0
    buffer_load_dword v4, v4, s[32:35], s59 offen sc1
    s_setprio 3
    s_add_u32 s36, s32, s58
    s_addc_u32 s37, s33, 0
    s_mov_b32 s38, 40960
    s_mov_b32 s39, 0x00020000
    s_movk_i32 s24, 0x7c
    v_mul_u32_u24 v100, 52480, v1
    v_add_u32 v101, 826368, v100
    v_and_b32_sdwa v100, v100, s24 dst_sel:DWORD dst_unused:UNUSED_PAD src0_sel:WORD_1 src1_sel:DWORD
    v_and_b32_sdwa v101, v101, s24 dst_sel:DWORD dst_unused:UNUSED_PAD src0_sel:WORD_1 src1_sel:DWORD
    s_lshl_b32 s57, s2, 8
    s_add_u32 s57, s57, 22347776
    v_mov_b32 v108, 10240
    v_pk_add_f32 v[8:9], v[8:9], v[28:29]
    v_pk_add_f32 v[10:11], v[10:11], v[30:31]
    v_pk_add_f32 v[12:13], v[12:13], v[32:33]
    v_pk_add_f32 v[14:15], v[14:15], v[34:35]
    v_pk_add_f32 v[16:17], v[16:17], v[36:37]
    v_pk_add_f32 v[18:19], v[18:19], v[38:39]
    v_pk_add_f32 v[20:21], v[20:21], v[40:41]
    v_pk_add_f32 v[22:23], v[22:23], v[42:43]
    v_pk_add_f32 v[24:25], v[24:25], v[44:45]
    v_pk_add_f32 v[26:27], v[26:27], v[46:47]
    v_pk_add_f32 v[8:9], v[8:9], v[48:49]
    v_pk_add_f32 v[10:11], v[10:11], v[50:51]
    v_pk_add_f32 v[12:13], v[12:13], v[52:53]
    v_pk_add_f32 v[14:15], v[14:15], v[54:55]
    v_pk_add_f32 v[16:17], v[16:17], v[56:57]
    v_pk_add_f32 v[18:19], v[18:19], v[58:59]
    v_pk_add_f32 v[20:21], v[20:21], v[60:61]
    v_pk_add_f32 v[22:23], v[22:23], v[62:63]
    v_pk_add_f32 v[24:25], v[24:25], v[64:65]
    v_pk_add_f32 v[26:27], v[26:27], v[66:67]
    v_pk_add_f32 v[8:9], v[8:9], v[68:69] neg_lo:[1,1] neg_hi:[1,1]
    v_pk_add_f32 v[10:11], v[10:11], v[70:71] neg_lo:[1,1] neg_hi:[1,1]
    v_pk_add_f32 v[12:13], v[12:13], v[72:73] neg_lo:[1,1] neg_hi:[1,1]
    v_pk_add_f32 v[14:15], v[14:15], v[74:75] neg_lo:[1,1] neg_hi:[1,1]
    v_pk_add_f32 v[16:17], v[16:17], v[76:77] neg_lo:[1,1] neg_hi:[1,1]
    v_pk_add_f32 v[18:19], v[18:19], v[78:79] neg_lo:[1,1] neg_hi:[1,1]
    v_pk_add_f32 v[20:21], v[20:21], v[80:81] neg_lo:[1,1] neg_hi:[1,1]
    v_pk_add_f32 v[22:23], v[22:23], v[82:83] neg_lo:[1,1] neg_hi:[1,1]
    v_pk_add_f32 v[24:25], v[24:25], v[84:85] neg_lo:[1,1] neg_hi:[1,1]
    v_pk_add_f32 v[26:27], v[26:27], v[86:87] neg_lo:[1,1] neg_hi:[1,1]
    s_lshl_b32 s24, s19, 11
    s_add_u32 s24, s24, 102400
    v_bfe_u32 v144, v1, 4, 4
    v_add_u32 v145, -12, v144
    v_min_u32 v144, v144, v145
    v_mul_u32_u24 v144, 160, v144
    v_lshrrev_b32 v145, 8, v1
    v_lshlrev_b32 v145, 3, v145
    v_add3_u32 v144, v144, v145, s24
    v_add_u32 v145, s24, v1
    v_mul_u32_u24 v146, 410, v1
    v_lshrrev_b32 v146, 16, v146
    v_mul_u32_u24 v146, 1120, v146
    v_add_u32 v146, v146, v1
    s_mov_b32 s53, 0
    s_mov_b32 s43, -1
    s_lshl_b32 s49, 17, s19
    s_waitcnt vmcnt(0)
    ds_write_b32 v2, v2
    s_sleep 2
L_k2_go:
    s_mov_b64 s[40:41], 0
    s_mov_b32 s42, 1023
    s_mov_b32 s52, 4
    s_sub_u32 s24, s40, 1
    s_cbranch_scc1 L_s0
L_i0:
    s_ff1_i32_b32 s3, s40
    s_and_b32 s40, s40, s24
    s_lshl_b32 s25, s3, 12
    buffer_load_dwordx4 v[112:115], v0, s[36:39], s25 offen offset:0 sc1
    buffer_load_dwordx4 v[116:119], v0, s[36:39], s25 offen offset:2048 sc1
    s_sub_u32 s24, s40, 1
    s_cbranch_scc1 L_s1
L_i1:
    s_ff1_i32_b32 s4, s40
    s_and_b32 s40, s40, s24
    s_lshl_b32 s25, s4, 12
    buffer_load_dwordx4 v[120:123], v0, s[36:39], s25 offen offset:0 sc1
    buffer_load_dwordx4 v[124:127], v0, s[36:39], s25 offen offset:2048 sc1
    s_sub_u32 s24, s40, 1
    s_cbranch_scc1 L_s2
L_i2:
    s_ff1_i32_b32 s5, s40
    s_and_b32 s40, s40, s24
    s_lshl_b32 s25, s5, 12
    buffer_load_dwordx4 v[128:131], v0, s[36:39], s25 offen offset:0 sc1
    buffer_load_dwordx4 v[132:135], v0, s[36:39], s25 offen offset:2048 sc1
    s_setprio 0
L_k2_w4:
    ds_read_b32 v111, v3 offset:0
    s_waitcnt lgkmcnt(0)
    v_cmp_eq_u32 vcc, 0, v111
    s_nop 0
    s_and_b32 vcc_lo, vcc_lo, 3840
    s_cbranch_scc1 L_k2_w4
    v_mad_u32_u24 v7, s3, v108, v1
    ds_read_b128 v[48:51], v7 offset:0
    ds_read_b128 v[52:55], v7 offset:1024
    ds_read_b128 v[56:59], v7 offset:2048
    ds_read_b128 v[60:63], v7 offset:3072
    ds_read_b128 v[64:67], v7 offset:4096
    ds_read_b128 v[68:71], v7 offset:5120
    ds_read_b128 v[72:75], v7 offset:6144
    ds_read_b128 v[76:79], v7 offset:7168
    ds_read_b128 v[80:83], v7 offset:8192
    ds_read_b128 v[84:87], v7 offset:9216
    v_mad_u32_u24 v7, s4, v108, v1
    ds_read_b128 v[88:91], v7 offset:0
    ds_read_b128 v[92:95], v7 offset:1024
    s_mov_b32 s48, 0
    s_branch L_k2_wb
L_k2_wa:
    s_sleep 1
    s_or_b32 s24, s42, s41
    s_cbranch_scc0 L_k2_wb
    s_call_b64 s[30:31], L_k2_rg
L_k2_wb:
    ds_read_b32 v111, v3 offset:0
    s_waitcnt lgkmcnt(0)
    v_cmp_eq_u32 vcc, 0, v111
    s_nop 0
    s_and_b32 vcc_lo, vcc_lo, s49
    s_cbranch_scc1 L_k2_wa
    s_waitcnt vmcnt(4)
    v_bitop3_b32 v110, v112, v114, 1 bitop3:0x80
    v_bitop3_b32 v110, v116, v118, v110 bitop3:0x80
    v_cmp_eq_u32 vcc, 0, v110
    s_waitcnt lgkmcnt(7)
    s_cbranch_vccnz L_f0
L_p0:
    v_mfma_f32_16x16x32_bf16 v[28:31], v[48:51], v[112:115], v[8:11]
    s_sub_u32 s24, s40, 1
    ds_read_b128 v[96:99], v7 offset:2048
    v_mfma_f32_16x16x32_bf16 v[32:35], v[52:55], v[112:115], v[12:15]
    s_cbranch_scc1 L_s3
L_i3:
    s_ff1_i32_b32 s6, s40
    ds_read_b128 v[48:51], v7 offset:3072
    v_mfma_f32_16x16x32_bf16 v[36:39], v[56:59], v[112:115], v[16:19]
    ds_read_b128 v[52:55], v7 offset:4096
    s_and_b32 s40, s40, s24
    s_lshl_b32 s25, s6, 12
    v_mfma_f32_16x16x32_bf16 v[40:43], v[60:63], v[112:115], v[20:23]
    ds_read_b128 v[56:59], v7 offset:5120
    buffer_load_dwordx4 v[136:139], v0, s[36:39], s25 offen offset:0 sc1
    v_mfma_f32_16x16x32_bf16 v[44:47], v[64:67], v[112:115], v[24:27]
    ds_read_b128 v[60:63], v7 offset:6144
    buffer_load_dwordx4 v[140:143], v0, s[36:39], s25 offen offset:2048 sc1
    s_waitcnt lgkmcnt(7)
    v_mfma_f32_16x16x32_bf16 v[28:31], v[68:71], v[116:119], v[28:31]
    ds_read_b128 v[64:67], v7 offset:7168
    v_mfma_f32_16x16x32_bf16 v[32:35], v[72:75], v[116:119], v[32:35]
    ds_read_b128 v[68:71], v7 offset:8192
    s_waitcnt vmcnt(4)
    v_bitop3_b32 v110, v120, v122, 1 bitop3:0x80
    v_bitop3_b32 v110, v124, v126, v110 bitop3:0x80
    v_mfma_f32_16x16x32_bf16 v[36:39], v[76:79], v[116:119], v[36:39]
    ds_read_b128 v[72:75], v7 offset:9216
    v_cmp_eq_u32 vcc, 0, v110
    v_mfma_f32_16x16x32_bf16 v[40:43], v[80:83], v[116:119], v[40:43]
    v_mad_u32_u24 v7, s5, v108, v1
    ds_read_b128 v[76:79], v7 offset:0
    v_mfma_f32_16x16x32_bf16 v[44:47], v[84:87], v[116:119], v[44:47]
    ds_read_b128 v[80:83], v7 offset:1024
    s_waitcnt lgkmcnt(7)
    s_cbranch_vccnz L_f1
L_p1:
    v_mfma_f32_16x16x32_bf16 v[28:31], v[88:91], v[120:123], v[28:31]
    s_sub_u32 s24, s40, 1
    ds_read_b128 v[84:87], v7 offset:2048
    v_mfma_f32_16x16x32_bf16 v[32:35], v[92:95], v[120:123], v[32:35]
    s_cbranch_scc1 L_s4
L_i4:
    s_ff1_i32_b32 s7, s40
    ds_read_b128 v[88:91], v7 offset:3072
    v_mfma_f32_16x16x32_bf16 v[36:39], v[96:99], v[120:123], v[36:39]
    ds_read_b128 v[92:95], v7 offset:4096
    s_and_b32 s40, s40, s24
    s_lshl_b32 s25, s7, 12
    v_mfma_f32_16x16x32_bf16 v[40:43], v[48:51], v[120:123], v[40:43]
    ds_read_b128 v[96:99], v7 offset:5120
    buffer_load_dwordx4 v[112:115], v0, s[36:39], s25 offen offset:0 sc1
    v_mfma_f32_16x16x32_bf16 v[44:47], v[52:55], v[120:123], v[44:47]
    ds_read_b128 v[48:51], v7 offset:6144
    buffer_load_dwordx4 v[116:119], v0, s[36:39], s25 offen offset:2048 sc1
    s_waitcnt lgkmcnt(7)
    v_mfma_f32_16x16x32_bf16 v[28:31], v[56:59], v[124:127], v[28:31]
    ds_read_b128 v[52:55], v7 offset:7168
    v_mfma_f32_16x16x32_bf16 v[32:35], v[60:63], v[124:127], v[32:35]
    ds_read_b128 v[56:59], v7 offset:8192
    s_waitcnt vmcnt(4)
    v_bitop3_b32 v110, v128, v130, 1 bitop3:0x80
    v_bitop3_b32 v110, v132, v134, v110 bitop3:0x80
    v_mfma_f32_16x16x32_bf16 v[36:39], v[64:67], v[124:127], v[36:39]
    ds_read_b128 v[60:63], v7 offset:9216
    v_cmp_eq_u32 vcc, 0, v110
    v_mfma_f32_16x16x32_bf16 v[40:43], v[68:71], v[124:127], v[40:43]
    v_mad_u32_u24 v7, s6, v108, v1
    ds_read_b128 v[64:67], v7 offset:0
    v_mfma_f32_16x16x32_bf16 v[44:47], v[72:75], v[124:127], v[44:47]
    ds_read_b128 v[68:71], v7 offset:1024
    s_waitcnt lgkmcnt(7)
    s_cbranch_vccnz L_f2
L_p2:
    v_mfma_f32_16x16x32_bf16 v[28:31], v[76:79], v[128:131], v[28:31]
    s_sub_u32 s24, s40, 1
    ds_read_b128 v[72:75], v7 offset:2048
    v_mfma_f32_16x16x32_bf16 v[32:35], v[80:83], v[128:131], v[32:35]
    s_cbranch_scc1 L_s5
L_i5:
    s_ff1_i32_b32 s8, s40
    ds_read_b128 v[76:79], v7 offset:3072
    v_mfma_f32_16x16x32_bf16 v[36:39], v[84:87], v[128:131], v[36:39]
    ds_read_b128 v[80:83], v7 offset:4096
    s_and_b32 s40, s40, s24
    s_lshl_b32 s25, s8, 12
    v_mfma_f32_16x16x32_bf16 v[40:43], v[88:91], v[128:131], v[40:43]
    ds_read_b128 v[84:87], v7 offset:5120
    buffer_load_dwordx4 v[120:123], v0, s[36:39], s25 offen offset:0 sc1
    v_mfma_f32_16x16x32_bf16 v[44:47], v[92:95], v[128:131], v[44:47]
    ds_read_b128 v[88:91], v7 offset:6144
    buffer_load_dwordx4 v[124:127], v0, s[36:39], s25 offen offset:2048 sc1
    s_waitcnt lgkmcnt(7)
    v_mfma_f32_16x16x32_bf16 v[28:31], v[96:99], v[132:135], v[28:31]
    ds_read_b128 v[92:95], v7 offset:7168
    v_mfma_f32_16x16x32_bf16 v[32:35], v[48:51], v[132:135], v[32:35]
    ds_read_b128 v[96:99], v7 offset:8192
    s_waitcnt vmcnt(4)
    v_bitop3_b32 v110, v136, v138, 1 bitop3:0x80
    v_bitop3_b32 v110, v140, v142, v110 bitop3:0x80
    v_mfma_f32_16x16x32_bf16 v[36:39], v[52:55], v[132:135], v[36:39]
    ds_read_b128 v[48:51], v7 offset:9216
    v_cmp_eq_u32 vcc, 0, v110
    v_mfma_f32_16x16x32_bf16 v[40:43], v[56:59], v[132:135], v[40:43]
    v_mad_u32_u24 v7, s7, v108, v1
    ds_read_b128 v[52:55], v7 offset:0
    v_mfma_f32_16x16x32_bf16 v[44:47], v[60:63], v[132:135], v[44:47]
    ds_read_b128 v[56:59], v7 offset:1024
    s_waitcnt lgkmcnt(7)
    s_cbranch_vccnz L_f3
L_p3:
    v_mfma_f32_16x16x32_bf16 v[28:31], v[64:67], v[136:139], v[28:31]
    s_sub_u32 s24, s40, 1
    ds_read_b128 v[60:63], v7 offset:2048
    v_mfma_f32_16x16x32_bf16 v[32:35], v[68:71], v[136:139], v[32:35]
    s_cbranch_scc1 L_s6
L_i6:
    s_ff1_i32_b32 s9, s40
    ds_read_b128 v[64:67], v7 offset:3072
    v_mfma_f32_16x16x32_bf16 v[36:39], v[72:75], v[136:139], v[36:39]
    ds_read_b128 v[68:71], v7 offset:4096
    s_and_b32 s40, s40, s24
    s_lshl_b32 s25, s9, 12
    v_mfma_f32_16x16x32_bf16 v[40:43], v[76:79], v[136:139], v[40:43]
    ds_read_b128 v[72:75], v7 offset:5120
    buffer_load_dwordx4 v[128:131], v0, s[36:39], s25 offen offset:0 sc1
    v_mfma_f32_16x16x32_bf16 v[44:47], v[80:83], v[136:139], v[44:47]
    ds_read_b128 v[76:79], v7 offset:6144
    buffer_load_dwordx4 v[132:135], v0, s[36:39], s25 offen offset:2048 sc1
    s_waitcnt lgkmcnt(7)
    v_mfma_f32_16x16x32_bf16 v[28:31], v[84:87], v[140:143], v[28:31]
    ds_read_b128 v[80:83], v7 offset:7168
    v_mfma_f32_16x16x32_bf16 v[32:35], v[88:91], v[140:143], v[32:35]
    ds_read_b128 v[84:87], v7 offset:8192
    s_waitcnt vmcnt(4)
    v_bitop3_b32 v110, v112, v114, 1 bitop3:0x80
    v_bitop3_b32 v110, v116, v118, v110 bitop3:0x80
    v_mfma_f32_16x16x32_bf16 v[36:39], v[92:95], v[140:143], v[36:39]
    ds_read_b128 v[88:91], v7 offset:9216
    v_cmp_eq_u32 vcc, 0, v110
    v_mfma_f32_16x16x32_bf16 v[40:43], v[96:99], v[140:143], v[40:43]
    v_mad_u32_u24 v7, s8, v108, v1
    ds_read_b128 v[92:95], v7 offset:0
    v_mfma_f32_16x16x32_bf16 v[44:47], v[48:51], v[140:143], v[44:47]
    ds_read_b128 v[96:99], v7 offset:1024
    s_waitcnt lgkmcnt(7)
    s_cbranch_vccnz L_f4
L_p4:
    v_mfma_f32_16x16x32_bf16 v[28:31], v[52:55], v[112:115], v[28:31]
    s_sub_u32 s24, s40, 1
    ds_read_b128 v[48:51], v7 offset:2048
    v_mfma_f32_16x16x32_bf16 v[32:35], v[56:59], v[112:115], v[32:35]
    s_cbranch_scc1 L_s7
L_i7:
    s_ff1_i32_b32 s10, s40
    ds_read_b128 v[52:55], v7 offset:3072
    v_mfma_f32_16x16x32_bf16 v[36:39], v[60:63], v[112:115], v[36:39]
    ds_read_b128 v[56:59], v7 offset:4096
    s_and_b32 s40, s40, s24
    s_lshl_b32 s25, s10, 12
    v_mfma_f32_16x16x32_bf16 v[40:43], v[64:67], v[112:115], v[40:43]
    ds_read_b128 v[60:63], v7 offset:5120
    buffer_load_dwordx4 v[136:139], v0, s[36:39], s25 offen offset:0 sc1
    v_mfma_f32_16x16x32_bf16 v[44:47], v[68:71], v[112:115], v[44:47]
    ds_read_b128 v[64:67], v7 offset:6144
    buffer_load_dwordx4 v[140:143], v0, s[36:39], s25 offen offset:2048 sc1
    s_waitcnt lgkmcnt(7)
    v_mfma_f32_16x16x32_bf16 v[28:31], v[72:75], v[116:119], v[28:31]
    ds_read_b128 v[68:71], v7 offset:7168
    v_mfma_f32_16x16x32_bf16 v[32:35], v[76:79], v[116:119], v[32:35]
    ds_read_b128 v[72:75], v7 offset:8192
    s_waitcnt vmcnt(4)
    v_bitop3_b32 v110, v120, v122, 1 bitop3:0x80
    v_bitop3_b32 v110, v124, v126, v110 bitop3:0x80
    v_mfma_f32_16x16x32_bf16 v[36:39], v[80:83], v[116:119], v[36:39]
    ds_read_b128 v[76:79], v7 offset:9216
    v_cmp_eq_u32 vcc, 0, v110
    v_mfma_f32_16x16x32_bf16 v[40:43], v[84:87], v[116:119], v[40:43]
    v_mad_u32_u24 v7, s9, v108, v1
    ds_read_b128 v[80:83], v7 offset:0
    v_mfma_f32_16x16x32_bf16 v[44:47], v[88:91], v[116:119], v[44:47]
    ds_read_b128 v[84:87], v7 offset:1024
    s_waitcnt lgkmcnt(7)
    s_cbranch_vccnz L_f5
L_p5:
    v_mfma_f32_16x16x32_bf16 v[28:31], v[92:95], v[120:123], v[28:31]
    s_sub_u32 s24, s40, 1
    ds_read_b128 v[88:91], v7 offset:2048
    v_mfma_f32_16x16x32_bf16 v[32:35], v[96:99], v[120:123], v[32:35]
    s_cbranch_scc1 L_s8
L_i8:
    s_ff1_i32_b32 s11, s40
    ds_read_b128 v[92:95], v7 offset:3072
    v_mfma_f32_16x16x32_bf16 v[36:39], v[48:51], v[120:123], v[36:39]
    ds_read_b128 v[96:99], v7 offset:4096
    s_and_b32 s40, s40, s24
    s_lshl_b32 s25, s11, 12
    v_mfma_f32_16x16x32_bf16 v[40:43], v[52:55], v[120:123], v[40:43]
    ds_read_b128 v[48:51], v7 offset:5120
    buffer_load_dwordx4 v[112:115], v0, s[36:39], s25 offen offset:0 sc1
    v_mfma_f32_16x16x32_bf16 v[44:47], v[56:59], v[120:123], v[44:47]
    ds_read_b128 v[52:55], v7 offset:6144
    buffer_load_dwordx4 v[116:119], v0, s[36:39], s25 offen offset:2048 sc1
    s_waitcnt lgkmcnt(7)
    v_mfma_f32_16x16x32_bf16 v[28:31], v[60:63], v[124:127], v[28:31]
    ds_read_b128 v[56:59], v7 offset:7168
    v_mfma_f32_16x16x32_bf16 v[32:35], v[64:67], v[124:127], v[32:35]
    ds_read_b128 v[60:63], v7 offset:8192
    s_waitcnt vmcnt(4)
    v_bitop3_b32 v110, v128, v130, 1 bitop3:0x80
    v_bitop3_b32 v110, v132, v134, v110 bitop3:0x80
    v_mfma_f32_16x16x32_bf16 v[36:39], v[68:71], v[124:127], v[36:39]
    ds_read_b128 v[64:67], v7 offset:9216
    v_cmp_eq_u32 vcc, 0, v110
    v_mfma_f32_16x16x32_bf16 v[40:43], v[72:75], v[124:127], v[40:43]
    v_mad_u32_u24 v7, s10, v108, v1
    ds_read_b128 v[68:71], v7 offset:0
    v_mfma_f32_16x16x32_bf16 v[44:47], v[76:79], v[124:127], v[44:47]
    ds_read_b128 v[72:75], v7 offset:1024
    s_waitcnt lgkmcnt(7)
    s_cbranch_vccnz L_f6
L_p6:
    v_mfma_f32_16x16x32_bf16 v[28:31], v[80:83], v[128:131], v[28:31]
    s_sub_u32 s24, s40, 1
    ds_read_b128 v[76:79], v7 offset:2048
    v_mfma_f32_16x16x32_bf16 v[32:35], v[84:87], v[128:131], v[32:35]
    s_cbranch_scc1 L_s9
L_i9:
    s_ff1_i32_b32 s12, s40
    ds_read_b128 v[80:83], v7 offset:3072
    v_mfma_f32_16x16x32_bf16 v[36:39], v[88:91], v[128:131], v[36:39]
    ds_read_b128 v[84:87], v7 offset:4096
    s_and_b32 s40, s40, s24
    s_lshl_b32 s25, s12, 12
    v_mfma_f32_16x16x32_bf16 v[40:43], v[92:95], v[128:131], v[40:43]
    ds_read_b128 v[88:91], v7 offset:5120
    buffer_load_dwordx4 v[120:123], v0, s[36:39], s25 offen offset:0 sc1
    v_mfma_f32_16x16x32_bf16 v[44:47], v[96:99], v[128:131], v[44:47]
    ds_read_b128 v[92:95], v7 offset:6144
    buffer_load_dwordx4 v[124:127], v0, s[36:39], s25 offen offset:2048 sc1
    s_waitcnt lgkmcnt(7)
    v_mfma_f32_16x16x32_bf16 v[28:31], v[48:51], v[132:135], v[28:31]
    ds_read_b128 v[96:99], v7 offset:7168
    v_mfma_f32_16x16x32_bf16 v[32:35], v[52:55], v[132:135], v[32:35]
    ds_read_b128 v[48:51], v7 offset:8192
    s_waitcnt vmcnt(4)
    v_bitop3_b32 v110, v136, v138, 1 bitop3:0x80
    v_bitop3_b32 v110, v140, v142, v110 bitop3:0x80
    v_mfma_f32_16x16x32_bf16 v[36:39], v[56:59], v[132:135], v[36:39]
    ds_read_b128 v[52:55], v7 offset:9216
    v_cmp_eq_u32 vcc, 0, v110
    v_mfma_f32_16x16x32_bf16 v[40:43], v[60:63], v[132:135], v[40:43]
    v_mad_u32_u24 v7, s11, v108, v1
    ds_read_b128 v[56:59], v7 offset:0
    v_mfma_f32_16x16x32_bf16 v[44:47], v[64:67], v[132:135], v[44:47]
    ds_read_b128 v[60:63], v7 offset:1024
    s_waitcnt lgkmcnt(7)
    s_cbranch_vccnz L_f7
L_p7:
    v_mfma_f32_16x16x32_bf16 v[28:31], v[68:71], v[136:139], v[28:31]
    ds_read_b128 v[64:67], v7 offset:2048
    v_mfma_f32_16x16x32_bf16 v[32:35], v[72:75], v[136:139], v[32:35]
    ds_read_b128 v[68:71], v7 offset:3072
    v_mfma_f32_16x16x32_bf16 v[36:39], v[76:79], v[136:139], v[36:39]
    ds_read_b128 v[72:75], v7 offset:4096
    v_mfma_f32_16x16x32_bf16 v[40:43], v[80:83], v[136:139], v[40:43]
    ds_read_b128 v[76:79], v7 offset:5120
    v_mfma_f32_16x16x32_bf16 v[44:47], v[84:87], v[136:139], v[44:47]
    ds_read_b128 v[80:83], v7 offset:6144
    s_waitcnt lgkmcnt(7)
    v_mfma_f32_16x16x32_bf16 v[28:31], v[88:91], v[140:143], v[28:31]
    ds_read_b128 v[84:87], v7 offset:7168
    v_mfma_f32_16x16x32_bf16 v[32:35], v[92:95], v[140:143], v[32:35]
    ds_read_b128 v[88:91], v7 offset:8192
    s_waitcnt vmcnt(2)
    v_bitop3_b32 v110, v112, v114, 1 bitop3:0x80
    v_bitop3_b32 v110, v116, v118, v110 bitop3:0x80
    v_mfma_f32_16x16x32_bf16 v[36:39], v[96:99], v[140:143], v[36:39]
    ds_read_b128 v[92:95], v7 offset:9216
    v_cmp_eq_u32 vcc, 0, v110
    v_mfma_f32_16x16x32_bf16 v[40:43], v[48:51], v[140:143], v[40:43]
    v_mad_u32_u24 v7, s12, v108, v1
    ds_read_b128 v[96:99], v7 offset:0
    v_mfma_f32_16x16x32_bf16 v[44:47], v[52:55], v[140:143], v[44:47]
    ds_read_b128 v[48:51], v7 offset:1024
    s_waitcnt lgkmcnt(7)
    s_cbranch_vccnz L_f8
L_p8:
    v_mfma_f32_16x16x32_bf16 v[28:31], v[56:59], v[112:115], v[28:31]
    ds_read_b128 v[52:55], v7 offset:2048
    v_mfma_f32_16x16x32_bf16 v[32:35], v[60:63], v[112:115], v[32:35]
    ds_read_b128 v[56:59], v7 offset:3072
    v_mfma_f32_16x16x32_bf16 v[36:39], v[64:67], v[112:115], v[36:39]
    ds_read_b128 v[60:63], v7 offset:4096
    v_mfma_f32_16x16x32_bf16 v[40:43], v[68:71], v[112:115], v[40:43]
    ds_read_b128 v[64:67], v7 offset:5120
    v_mfma_f32_16x16x32_bf16 v[44:47], v[72:75], v[112:115], v[44:47]
    ds_read_b128 v[68:71], v7 offset:6144
    s_waitcnt lgkmcnt(7)
    v_mfma_f32_16x16x32_bf16 v[28:31], v[76:79], v[116:119], v[28:31]
    ds_read_b128 v[72:75], v7 offset:7168
    v_mfma_f32_16x16x32_bf16 v[32:35], v[80:83], v[116:119], v[32:35]
    ds_read_b128 v[76:79], v7 offset:8192
    s_waitcnt vmcnt(0)
    v_bitop3_b32 v110, v120, v122, 1 bitop3:0x80
    v_bitop3_b32 v110, v124, v126, v110 bitop3:0x80
    v_mfma_f32_16x16x32_bf16 v[36:39], v[84:87], v[116:119], v[36:39]
    ds_read_b128 v[80:83], v7 offset:9216
    v_cmp_eq_u32 vcc, 0, v110
    v_mfma_f32_16x16x32_bf16 v[40:43], v[88:91], v[116:119], v[40:43]
    v_mfma_f32_16x16x32_bf16 v[44:47], v[92:95], v[116:119], v[44:47]
    s_waitcnt lgkmcnt(5)
    s_cbranch_vccnz L_f9
L_p9:
    v_mfma_f32_16x16x32_bf16 v[28:31], v[96:99], v[120:123], v[28:31]
    v_mfma_f32_16x16x32_bf16 v[32:35], v[48:51], v[120:123], v[32:35]
    v_mfma_f32_16x16x32_bf16 v[36:39], v[52:55], v[120:123], v[36:39]
    v_mfma_f32_16x16x32_bf16 v[40:43], v[56:59], v[120:123], v[40:43]
    v_mfma_f32_16x16x32_bf16 v[44:47], v[60:63], v[120:123], v[44:47]
    s_waitcnt lgkmcnt(0)
    v_mfma_f32_16x16x32_bf16 v[28:31], v[64:67], v[124:127], v[28:31]
    v_mfma_f32_16x16x32_bf16 v[32:35], v[68:71], v[124:127], v[32:35]
    v_mfma_f32_16x16x32_bf16 v[36:39], v[72:75], v[124:127], v[36:39]
    v_mfma_f32_16x16x32_bf16 v[40:43], v[76:79], v[124:127], v[40:43]
    v_mfma_f32_16x16x32_bf16 v[44:47], v[80:83], v[124:127], v[44:47]
L_k2_out:
    s_nop 3
    v_pk_fma_f32 v[28:29], v[28:29], v[4:5], v[8:9] op_sel_hi:[1,0,1] neg_lo:[0,0,1] neg_hi:[0,0,1]
    v_pk_fma_f32 v[30:31], v[30:31], v[4:5], v[10:11] op_sel_hi:[1,0,1] neg_lo:[0,0,1] neg_hi:[0,0,1]
    v_cvt_pk_bf16_f32 v28, v28, v29
    v_cvt_pk_bf16_f32 v29, v30, v31
    v_pk_fma_f32 v[32:33], v[32:33], v[4:5], v[12:13] op_sel_hi:[1,0,1] neg_lo:[0,0,1] neg_hi:[0,0,1]
    v_pk_fma_f32 v[34:35], v[34:35], v[4:5], v[14:15] op_sel_hi:[1,0,1] neg_lo:[0,0,1] neg_hi:[0,0,1]
    v_cvt_pk_bf16_f32 v32, v32, v33
    v_cvt_pk_bf16_f32 v33, v34, v35
    v_pk_fma_f32 v[36:37], v[36:37], v[4:5], v[16:17] op_sel_hi:[1,0,1] neg_lo:[0,0,1] neg_hi:[0,0,1]
    v_pk_fma_f32 v[38:39], v[38:39], v[4:5], v[18:19] op_sel_hi:[1,0,1] neg_lo:[0,0,1] neg_hi:[0,0,1]
    v_cvt_pk_bf16_f32 v36, v36, v37
    v_cvt_pk_bf16_f32 v37, v38, v39
    v_pk_fma_f32 v[40:41], v[40:41], v[4:5], v[20:21] op_sel_hi:[1,0,1] neg_lo:[0,0,1] neg_hi:[0,0,1]
    v_pk_fma_f32 v[42:43], v[42:43], v[4:5], v[22:23] op_sel_hi:[1,0,1] neg_lo:[0,0,1] neg_hi:[0,0,1]
    v_cvt_pk_bf16_f32 v40, v40, v41
    v_cvt_pk_bf16_f32 v41, v42, v43
    v_pk_fma_f32 v[44:45], v[44:45], v[4:5], v[24:25] op_sel_hi:[1,0,1] neg_lo:[0,0,1] neg_hi:[0,0,1]
    v_pk_fma_f32 v[46:47], v[46:47], v[4:5], v[26:27] op_sel_hi:[1,0,1] neg_lo:[0,0,1] neg_hi:[0,0,1]
    v_cvt_pk_bf16_f32 v44, v44, v45
    v_cvt_pk_bf16_f32 v45, v46, v47
    s_mov_b32 exec_lo, 268374015
    s_mov_b32 exec_hi, 268374015
    ds_write_b64 v144, v[28:29] offset:0
    ds_write_b64 v144, v[32:33] offset:32
    ds_write_b64 v144, v[36:37] offset:64
    ds_write_b64 v144, v[40:41] offset:96
    ds_write_b64 v144, v[44:45] offset:128
    s_mov_b64 exec, -1
    ds_read_b128 v[148:151], v145 offset:0
    ds_read_b128 v[152:155], v145 offset:960
    s_mov_b32 exec_lo, 4026593280
    s_mov_b32 exec_hi, 4026593280
    ds_write_b64 v144, v[28:29] offset:0
    ds_write_b64 v144, v[32:33] offset:32
    ds_write_b64 v144, v[36:37] offset:64
    ds_write_b64 v144, v[40:41] offset:96
    ds_write_b64 v144, v[44:45] offset:128
    s_mov_b64 exec, -1
    ds_read_b128 v[156:159], v145 offset:0
    s_add_u32 s24, s97, 7680
    s_add_u32 s25, s97, 15360
    s_mov_b32 exec_hi, 268435455
    s_waitcnt lgkmcnt(7)
    buffer_store_dwordx4 v[148:151], v146, s[44:47], s97 offen
    s_waitcnt lgkmcnt(6)
    buffer_store_dwordx4 v[152:155], v146, s[44:47], s24 offen
    s_mov_b32 exec_hi, 255
    s_waitcnt lgkmcnt(0)
    buffer_store_dwordx4 v[156:159], v146, s[44:47], s25 offen
    s_mov_b64 exec, -1
    s_bitset1_b32 s53, 1
L_k2_nx:
    s_bitcmp1_b32 s53, 0
    s_cbranch_scc1 L_k2_gm
L_k2_vd:
    ds_read_b32 v111, v3 offset:0
    s_waitcnt lgkmcnt(0)
    v_cmp_eq_u32 vcc, 0, v111
    s_nop 0
    s_and_b32 vcc_lo, vcc_lo, 255
    s_cbranch_scc1 L_k2_vs
    s_bitset1_b32 s53, 0
    v_cmp_eq_u32 vcc, 2, v111
    s_nop 0
    s_cbranch_vccnz L_k2_gf
L_k2_gm:
    s_bitcmp1_b32 s53, 1
    s_cbranch_scc0 L_k2_rt
    s_endpgm
L_k2_vs:
    s_sleep 2
    s_branch L_k2_vd
L_k2_rt:
    s_memrealtime s[50:51]
    s_sleep 0
    s_waitcnt vmcnt(0) lgkmcnt(0)
    s_sub_u32 s24, s50, s14
    s_cmp_ge_i32 s24, 0
    s_cbranch_scc1 L_k2_out
    s_branch L_k2_go
L_f0:
    s_sub_u32 s52, s52, 1
    s_cbranch_scc1 L_k2_nx
    s_lshl_b32 s25, s3, 12
    buffer_load_dwordx4 v[112:115], v0, s[36:39], s25 offen offset:0 sc1
    buffer_load_dwordx4 v[116:119], v0, s[36:39], s25 offen offset:2048 sc1
    s_waitcnt vmcnt(0)
    v_bitop3_b32 v110, v112, v114, 1 bitop3:0x80
    v_bitop3_b32 v110, v116, v118, v110 bitop3:0x80
    v_cmp_eq_u32 vcc, 0, v110
    s_nop 0
    s_cbranch_vccz L_p0
    s_branch L_f0
L_f1:
    s_sub_u32 s52, s52, 1
    s_cbranch_scc1 L_k2_nx
    s_lshl_b32 s25, s4, 12
    buffer_load_dwordx4 v[120:123], v0, s[36:39], s25 offen offset:0 sc1
    buffer_load_dwordx4 v[124:127], v0, s[36:39], s25 offen offset:2048 sc1
    s_waitcnt vmcnt(0)
    v_bitop3_b32 v110, v120, v122, 1 bitop3:0x80
    v_bitop3_b32 v110, v124, v126, v110 bitop3:0x80
    v_cmp_eq_u32 vcc, 0, v110
    s_nop 0
    s_cbranch_vccz L_p1
    s_branch L_f1
L_f2:
    s_sub_u32 s52, s52, 1
    s_cbranch_scc1 L_k2_nx
    s_lshl_b32 s25, s5, 12
    buffer_load_dwordx4 v[128:131], v0, s[36:39], s25 offen offset:0 sc1
    buffer_load_dwordx4 v[132:135], v0, s[36:39], s25 offen offset:2048 sc1
    s_waitcnt vmcnt(0)
    v_bitop3_b32 v110, v128, v130, 1 bitop3:0x80
    v_bitop3_b32 v110, v132, v134, v110 bitop3:0x80
    v_cmp_eq_u32 vcc, 0, v110
    s_nop 0
    s_cbranch_vccz L_p2
    s_branch L_f2
L_f3:
    s_sub_u32 s52, s52, 1
    s_cbranch_scc1 L_k2_nx
    s_lshl_b32 s25, s6, 12
    buffer_load_dwordx4 v[136:139], v0, s[36:39], s25 offen offset:0 sc1
    buffer_load_dwordx4 v[140:143], v0, s[36:39], s25 offen offset:2048 sc1
    s_waitcnt vmcnt(0)
    v_bitop3_b32 v110, v136, v138, 1 bitop3:0x80
    v_bitop3_b32 v110, v140, v142, v110 bitop3:0x80
    v_cmp_eq_u32 vcc, 0, v110
    s_nop 0
    s_cbranch_vccz L_p3
    s_branch L_f3
L_f4:
    s_sub_u32 s52, s52, 1
    s_cbranch_scc1 L_k2_nx
    s_lshl_b32 s25, s7, 12
    buffer_load_dwordx4 v[112:115], v0, s[36:39], s25 offen offset:0 sc1
    buffer_load_dwordx4 v[116:119], v0, s[36:39], s25 offen offset:2048 sc1
    s_waitcnt vmcnt(0)
    v_bitop3_b32 v110, v112, v114, 1 bitop3:0x80
    v_bitop3_b32 v110, v116, v118, v110 bitop3:0x80
    v_cmp_eq_u32 vcc, 0, v110
    s_nop 0
    s_cbranch_vccz L_p4
    s_branch L_f4
L_f5:
    s_sub_u32 s52, s52, 1
    s_cbranch_scc1 L_k2_nx
    s_lshl_b32 s25, s8, 12
    buffer_load_dwordx4 v[120:123], v0, s[36:39], s25 offen offset:0 sc1
    buffer_load_dwordx4 v[124:127], v0, s[36:39], s25 offen offset:2048 sc1
    s_waitcnt vmcnt(0)
    v_bitop3_b32 v110, v120, v122, 1 bitop3:0x80
    v_bitop3_b32 v110, v124, v126, v110 bitop3:0x80
    v_cmp_eq_u32 vcc, 0, v110
    s_nop 0
    s_cbranch_vccz L_p5
    s_branch L_f5
L_f6:
    s_sub_u32 s52, s52, 1
    s_cbranch_scc1 L_k2_nx
    s_lshl_b32 s25, s9, 12
    buffer_load_dwordx4 v[128:131], v0, s[36:39], s25 offen offset:0 sc1
    buffer_load_dwordx4 v[132:135], v0, s[36:39], s25 offen offset:2048 sc1
    s_waitcnt vmcnt(0)
    v_bitop3_b32 v110, v128, v130, 1 bitop3:0x80
    v_bitop3_b32 v110, v132, v134, v110 bitop3:0x80
    v_cmp_eq_u32 vcc, 0, v110
    s_nop 0
    s_cbranch_vccz L_p6
    s_branch L_f6
L_f7:
    s_sub_u32 s52, s52, 1
    s_cbranch_scc1 L_k2_nx
    s_lshl_b32 s25, s10, 12
    buffer_load_dwordx4 v[136:139], v0, s[36:39], s25 offen offset:0 sc1
    buffer_load_dwordx4 v[140:143], v0, s[36:39], s25 offen offset:2048 sc1
    s_waitcnt vmcnt(0)
    v_bitop3_b32 v110, v136, v138, 1 bitop3:0x80
    v_bitop3_b32 v110, v140, v142, v110 bitop3:0x80
    v_cmp_eq_u32 vcc, 0, v110
    s_nop 0
    s_cbranch_vccz L_p7
    s_branch L_f7
L_f8:
    s_sub_u32 s52, s52, 1
    s_cbranch_scc1 L_k2_nx
    s_lshl_b32 s25, s11, 12
    buffer_load_dwordx4 v[112:115], v0, s[36:39], s25 offen offset:0 sc1
    buffer_load_dwordx4 v[116:119], v0, s[36:39], s25 offen offset:2048 sc1
    s_waitcnt vmcnt(0)
    v_bitop3_b32 v110, v112, v114, 1 bitop3:0x80
    v_bitop3_b32 v110, v116, v118, v110 bitop3:0x80
    v_cmp_eq_u32 vcc, 0, v110
    s_nop 0
    s_cbranch_vccz L_p8
    s_branch L_f8
L_f9:
    s_sub_u32 s52, s52, 1
    s_cbranch_scc1 L_k2_nx
    s_lshl_b32 s25, s12, 12
    buffer_load_dwordx4 v[120:123], v0, s[36:39], s25 offen offset:0 sc1
    buffer_load_dwordx4 v[124:127], v0, s[36:39], s25 offen offset:2048 sc1
    s_waitcnt vmcnt(0)
    v_bitop3_b32 v110, v120, v122, 1 bitop3:0x80
    v_bitop3_b32 v110, v124, v126, v110 bitop3:0x80
    v_cmp_eq_u32 vcc, 0, v110
    s_nop 0
    s_cbranch_vccz L_p9
    s_branch L_f9
L_s0:
    s_mov_b32 s48, 3
    s_call_b64 s[30:31], L_k2_rf
    s_sub_u32 s24, s40, 1
    s_cbranch_scc0 L_i0
    s_branch L_s0
L_s1:
    s_mov_b32 s48, 2
    s_call_b64 s[30:31], L_k2_rf
    s_sub_u32 s24, s40, 1
    s_cbranch_scc0 L_i1
    s_branch L_s1
L_s2:
    s_mov_b32 s48, 1
    s_call_b64 s[30:31], L_k2_rf
    s_sub_u32 s24, s40, 1
    s_cbranch_scc0 L_i2
    s_branch L_s2
L_s3:
    s_call_b64 s[30:31], L_k2_rf
    s_sub_u32 s24, s40, 1
    s_cbranch_scc0 L_i3
    s_branch L_s3
L_s4:
    s_call_b64 s[30:31], L_k2_rf
    s_sub_u32 s24, s40, 1
    s_cbranch_scc0 L_i4
    s_branch L_s4
L_s5:
    s_call_b64 s[30:31], L_k2_rf
    s_sub_u32 s24, s40, 1
    s_cbranch_scc0 L_i5
    s_branch L_s5
L_s6:
    s_call_b64 s[30:31], L_k2_rf
    s_sub_u32 s24, s40, 1
    s_cbranch_scc0 L_i6
    s_branch L_s6
L_s7:
    s_call_b64 s[30:31], L_k2_rf
    s_sub_u32 s24, s40, 1
    s_cbranch_scc0 L_i7
    s_branch L_s7
L_s8:
    s_call_b64 s[30:31], L_k2_rf
    s_sub_u32 s24, s40, 1
    s_cbranch_scc0 L_i8
    s_branch L_s8
L_s9:
    s_call_b64 s[30:31], L_k2_rf
    s_sub_u32 s24, s40, 1
    s_cbranch_scc0 L_i9
    s_branch L_s9
L_k2_rf:
    s_mov_b32 s40, s41
    s_cmp_lg_u32 s41, 0
    s_mov_b32 s41, 0
    s_cbranch_scc1 L_k2_rx
L_k2_rg:
    s_cmp_eq_u32 s43, 0
    s_cbranch_scc1 L_k2_rk
    buffer_load_dwordx4 v[102:105], v100, s[32:35], s57 offen sc1
    buffer_load_dword v106, v101, s[32:35], s57 offen sc1
    s_waitcnt vmcnt(0)
    v_min3_u32 v107, v102, v103, v106
    v_min3_u32 v107, v104, v105, v107
    v_cmp_ne_u32 vcc, 0, v107
    v_max3_u32 v107, v102, v103, v106
    v_max3_u32 v107, v104, v105, v107
    v_subrev_u32 v107, s14, v107
    v_min_i32 v107, 0, v107
    v_cndmask_b32 v107, 0, v107, vcc
    s_andn2_b32 s43, 1023, vcc_lo
    v_mov_b32 v102, v107
    s_nop 1
    v_min_i32_dpp v102, v102, v102 row_shr:1 row_mask:0xf bank_mask:0xf
    s_nop 1
    v_min_i32_dpp v102, v102, v102 row_shr:2 row_mask:0xf bank_mask:0xf
    s_nop 1
    v_min_i32_dpp v102, v102, v102 row_shr:4 row_mask:0xf bank_mask:0xf
    s_nop 1
    v_min_i32_dpp v102, v102, v102 row_shr:8 row_mask:0xf bank_mask:0xf
    s_nop 0
    v_readlane_b32 s54, v102, 9
L_k2_rk:
    s_memrealtime s[50:51]
    s_or_b32 s42, s42, s41
    s_sub_u32 s24, 0, s14
    s_waitcnt lgkmcnt(0)
    s_add_u32 s24, s24, s50
    s_sub_u32 s25, s24, s54
    s_mul_i32 s25, s25, 48
    s_ashr_i32 s25, s25, 8
    s_add_u32 s24, s24, s25
    v_cmp_ge_i32 vcc, s24, v107
    s_nop 0
    s_and_b32 s25, vcc_lo, s42
    s_or_b32 s40, s40, s25
    s_andn2_b32 s42, s42, s25
    s_bcnt1_i32_b32 s25, s40
    s_cbranch_scc0 L_k2_rz
    s_sub_i32 s25, s25, s48
    s_max_i32 s25, s25, 0
    s_mul_i32 s25, s25, 8
    s_add_u32 s24, s24, s25
    v_cmp_ge_i32 vcc, s24, v107
    s_nop 0
    s_and_b32 s41, vcc_lo, s42
    s_andn2_b32 s42, s42, s41
L_k2_rx:
    s_setpc_b64 s[30:31]
L_k2_rz:
    s_mov_b32 s41, 0
    s_sleep 1
    s_cmp_eq_u32 s48, 0
    s_cbranch_scc1 L_k2_rx
    s_sleep 8
    s_setpc_b64 s[30:31]
L_k2_gf:
    s_mov_b32 s24, 0
L_k2_gl:
    s_barrier
    s_add_u32 s24, s24, 1
    s_cmp_lt_u32 s24, 35
    s_cbranch_scc1 L_k2_gl
    s_branch L_k2_gm
L_end:
    s_endpgm
L_comp:
    s_and_b32 s28, s96, 3
    s_lshr_b32 s29, s96, 2
    v_and_b32 v76, 31, v0
    v_bfe_u32 v77, v0, 5, 1
    v_lshlrev_b32 v8, 4, v1
    s_lshl_b32 s24, s29, 13
    s_add_u32 s24, s24, 53248
    v_and_b32 v2, 15, v1
    v_lshlrev_b32 v2, 7, v2
    v_lshrrev_b32 v4, 4, v1
    v_bfe_u32 v3, v1, 1, 3
    v_xor_b32 v3, v3, v4
    v_lshlrev_b32 v3, 4, v3
    v_add3_u32 v32, v2, v3, s24
    v_xor_b32 v33, 64, v32
    v_bfe_u32 v2, v1, 2, 2
    v_lshl_add_u32 v2, v4, 3, v2
    v_bfe_u32 v3, v1, 3, 1
    v_and_b32 v4, 1, v4
    v_lshl_add_u32 v3, v3, 1, v4
    v_xor_b32 v3, s28, v3
    v_and_b32 v4, 3, v1
    v_lshl_add_u32 v3, v3, 2, v4
    v_lshlrev_b32 v3, 3, v3
    v_lshl_add_u32 v30, v2, 7, v3
    v_add_u32 v31, 98304, v30
    v_add_u32 v34, 123392, v8
    v_add_u32 v35, 98816, v8
    v_mov_b32 v28, 0xc0135761
    s_mov_b32 s44, 0xbdd2d3e8
    s_mov_b32 s48, 0x39000000
    s_mov_b32 s49, 0x477de800
    s_mul_i32 s24, s23, 384
    s_lshl_b32 s25, s23, 9
    s_add_u32 s26, s24, 256
    s_add_u32 s27, s24, 128
    s_add_u32 s38, s25, 128
    s_add_u32 s39, s25, 256
    s_add_u32 s40, s25, 384
    s_bitcmp1_b32 s22, 0
    s_cselect_b32 s36, s26, s24
    s_cselect_b32 s38, s38, s27
    s_cselect_b32 s39, s39, s27
    s_cselect_b32 s40, s40, s25
    s_cmp_lt_u32 s38, 1280
    s_cselect_b32 s41, 0x3ba52c01, 1.0
    s_cselect_b32 s45, -2, -1
    s_cmp_ge_u32 s38, 2560
    s_cselect_b32 s41, 0, s41
    s_cmp_lt_u32 s39, 1280
    s_cselect_b32 s42, 0x3ba52c01, 1.0
    s_cselect_b32 s46, -2, -1
    s_cmp_ge_u32 s39, 2560
    s_cselect_b32 s42, 0, s42
    s_cmp_lt_u32 s40, 1280
    s_cselect_b32 s43, 0x3ba52c01, 1.0
    s_cselect_b32 s47, -2, -1
    s_cmp_ge_u32 s40, 2560
    s_cselect_b32 s43, 0, s43
    s_lshl_b32 s36, s36, 5
    s_lshl_b32 s38, s38, 5
    s_lshl_b32 s39, s39, 5
    s_lshl_b32 s40, s40, 5
    s_lshl1_add_u32 s24, s21, s29
    s_lshl_b32 s27, s28, 10
    s_mul_i32 s25, s24, 246784
    s_add_u32 s25, s25, s27
    s_mul_i32 s26, s24, 197632
    s_add_u32 s26, s26, s27
    s_add_u32 s26, s26, 8388608
    s_add_u32 s36, s36, s26
    s_bitcmp1_b32 s22, 0
    s_cselect_b32 s26, s25, s26
    s_add_u32 s38, s38, s26
    s_add_u32 s39, s39, s25
    s_add_u32 s40, s40, s25
    s_cmp_eq_u32 s22, 15
    s_cselect_b32 s39, 1073741824, s39
    s_cselect_b32 s40, 1073741824, s40
    s_waitcnt lgkmcnt(0)
    s_mov_b32 s32, s18
    s_and_b32 s33, s19, 0xffff
    s_mov_b32 s34, 31457280
    s_mov_b32 s35, 0x00020000
    s_and_b32 s24, s2, 7
    s_lshl_b32 s24, s24, 2
    s_lshr_b32 s25, s2, 6
    s_add_u32 s16, s24, s25
    s_bfe_u32 s17, s2, 0x30003
    s_and_b32 s13, s16, 1
    s_lshr_b32 s26, s16, 1
    s_mul_i32 s26, s26, 5
    s_lshl_b32 s27, s13, 1
    s_add_u32 s26, s26, s27
    s_lshl_b32 s10, s26, 9
    s_lshl_b32 s24, s17, 3
    s_lshl_b32 s25, s28, 1
    s_add_u32 s24, s24, s25
    s_add_u32 s11, s24, s29
    s_mul_i32 s6, s11, 123392
    s_add_u32 s6, s6, s10
    s_lshl_b32 s24, s13, 9
    s_add_u32 s7, s6, s24
    v_add_u32 v21, s24, v8
    s_cmp_eq_u32 s13, 1
    s_cselect_b32 s25, 8, 1024
    v_lshlrev_b32 v2, 4, v76
    v_add_u32 v15, s25, v2
    v_cmp_eq_u32 s[14:15], 1, v77
    v_mov_b32 v3, 138776
    s_and_b32 s24, s11, 7
    s_xor_b32 s24, s24, 1
    s_mul_i32 s24, s24, 1536
    v_add_u32 v22, s24, v21
    v_add_u32 v23, s24, v15
    v_cndmask_b32 v23, v23, v3, s[14:15]
    s_and_b32 s24, s11, 7
    s_mul_i32 s24, s24, 1536
    v_add_u32 v24, s24, v21
    v_add_u32 v25, s24, v15
    v_cndmask_b32 v25, v25, v3, s[14:15]
    s_mul_i32 s4, s96, 3136
    s_add_u32 s4, s4, 135680
    s_mov_b32 s5, 0
    s_mov_b32 s8, 0x82008200
    s_mov_b32 s9, 0xb9a4b9a4
    s_mul_i32 s27, s29, 12544
    s_add_u32 s27, s27, 110592
    v_add_u32 v9, s27, v21
    v_mov_b32 v3, 3072
    v_cndmask_b32 v10, v15, v3, s[14:15]
    v_add_u32 v10, s27, v10
    v_and_b32 v2, 1, v1
    v_add_u32 v2, s13, v2
    v_bfe_u32 v3, v1, 1, 1
    v_bfe_u32 v4, v1, 4, 1
    v_cmp_eq_u32 vcc, 1, v4
    s_lshl_b32 s24, s13, 1
    s_sub_u32 s24, 2, s24
    v_mov_b32 v5, s24
    v_cndmask_b32 v2, v2, v5, vcc
    v_mov_b32 v5, s13
    v_cndmask_b32 v3, v3, v5, vcc
    v_bfe_u32 v5, v1, 2, 2
    v_lshl_add_u32 v5, v77, 2, v5
    v_lshlrev_b32 v6, 2, v2
    v_xor_b32 v5, v5, v6
    v_lshlrev_b32 v5, 4, v5
    v_lshl_add_u32 v5, v3, 3, v5
    v_lshl_add_u32 v5, v2, 9, v5
    v_and_b32 v6, 19, v1
    v_cmp_lt_u32 vcc, 16, v6
    v_and_b32 v7, 2, v1
    v_mad_i32_i24 v7, v7, -4, v4
    v_add_u32 v7, 1551, v7
    s_add_u32 s24, s27, 1536
    v_xor_b32 v6, 0, v5
    v_cndmask_b32 v6, v6, v7, vcc
    v_add_u32 v11, s24, v6
    v_xor_b32 v6, 128, v5
    v_cndmask_b32 v6, v6, v7, vcc
    v_add_u32 v12, s24, v6
    v_xor_b32 v6, 256, v5
    v_cndmask_b32 v6, v6, v7, vcc
    v_add_u32 v13, s24, v6
    v_xor_b32 v6, 384, v5
    v_cndmask_b32 v6, v6, v7, vcc
    v_add_u32 v14, s24, v6
    v_add_u32 v16, s4, v8
    s_mul_i32 s24, s29, -25088
    s_add_u32 s24, s24, 12544
    v_add_u32 v17, s24, v16
    s_lshl_b32 s24, s96, 8
    s_add_u32 s24, s24, 160768
    v_lshl_add_u32 v18, v1, 2, s24
    s_mul_i32 s24, s29, -2048
    s_add_u32 s24, s24, 1024
    v_add_u32 v19, s24, v18
    s_lshl_b32 s25, s96, 2
    s_add_u32 s25, s25, 162816
    v_mov_b32 v20, s25
    v_and_b32 v21, 7, v1
    v_lshlrev_b32 v21, 2, v21
    v_add_u32 v21, 162816, v21
    s_lshl1_add_u32 s25, s28, s29
    s_mul_i32 s24, s25, 123392
    s_add_u32 s24, s24, s10
    v_add_u32 v5, s24, v8
    v_and_b32 v2, 511, v8
    v_lshrrev_b32 v4, 9, v8
    v_mul_u32_u24 v3, 39936, v4
    v_add3_u32 v6, v2, v3, s24
    v_lshlrev_b32 v3, 6, v4
    v_add_u32 v3, 64, v3
    v_xor_b32 v3, v3, v8
    s_add_u32 s24, s24, 39424
    v_add_u32 v7, s24, v3
    s_lshl_b32 s24, s29, 2
    s_lshl_b32 s19, 15, s24
    s_lshl_b32 s20, 17, s28
    s_or_b32 s20, s20, s19
    s_barrier
    ds_read_b64_tr_b16 v[36:37], v31 offset:53248
    ds_read_b64_tr_b16 v[38:39], v31 offset:53760
    ds_read_b128 v[40:43], v32 offset:49152
    ds_read_b128 v[44:47], v32 offset:51200
    ds_read_b128 v[48:51], v32 offset:53248
    ds_read_b128 v[52:55], v32 offset:55296
    ds_read_b64_tr_b16 v[56:57], v31 offset:61440
    ds_read_b64_tr_b16 v[58:59], v31 offset:61952
    ds_read_b64_tr_b16 v[60:61], v31 offset:57344
    ds_read_b64_tr_b16 v[62:63], v31 offset:57856
    s_waitcnt lgkmcnt(7)
    v_mfma_f32_16x16x32_bf16 v[120:123], v[36:39], v[40:43], 0
    s_barrier
    ds_read_b64_tr_b16 v[64:65], v31 offset:40960
    ds_read_b64_tr_b16 v[66:67], v31 offset:41472
    s_waitcnt lgkmcnt(8)
    v_mfma_f32_16x16x32_bf16 v[124:127], v[36:39], v[44:47], 0
    ds_read_b128 v[68:71], v33 offset:49152
    ds_read_b128 v[72:75], v33 offset:51200
    s_waitcnt lgkmcnt(9)
    v_mfma_f32_16x16x32_bf16 v[128:131], v[36:39], v[48:51], 0
    ds_read_b128 v[76:79], v33 offset:53248
    ds_read_b128 v[80:83], v33 offset:55296
    s_waitcnt lgkmcnt(10)
    v_mfma_f32_16x16x32_bf16 v[132:135], v[36:39], v[52:55], 0
    ds_read_b64_tr_b16 v[84:85], v31 offset:49152
    ds_read_b64_tr_b16 v[86:87], v31 offset:49664
    s_waitcnt lgkmcnt(10)
    v_mfma_f32_16x16x32_bf16 v[136:139], v[56:59], v[40:43], 0
    ds_read_b64_tr_b16 v[36:37], v31 offset:45056
    ds_read_b64_tr_b16 v[38:39], v31 offset:45568
    v_mfma_f32_16x16x32_bf16 v[140:143], v[56:59], v[44:47], 0
    v_mfma_f32_16x16x32_bf16 v[144:147], v[56:59], v[48:51], 0
    v_mfma_f32_16x16x32_bf16 v[148:151], v[56:59], v[52:55], 0
    s_waitcnt lgkmcnt(4)
    v_mfma_f32_16x16x32_bf16 v[152:155], v[60:63], v[40:43], 0
    v_mfma_f32_16x16x32_bf16 v[156:159], v[60:63], v[44:47], 0
    v_mfma_f32_16x16x32_bf16 v[160:163], v[60:63], v[48:51], 0
    v_mfma_f32_16x16x32_bf16 v[164:167], v[60:63], v[52:55], 0
    v_mfma_f32_16x16x32_bf16 v[120:123], v[64:67], v[68:71], v[120:123]
    s_barrier
    ds_read_b64_tr_b16 v[56:57], v30 offset:4096
    ds_read_b64_tr_b16 v[58:59], v30 offset:4608
    v_mfma_f32_16x16x32_bf16 v[124:127], v[64:67], v[72:75], v[124:127]
    ds_read_b128 v[40:43], v32 offset:32768
    ds_read_b128 v[44:47], v32 offset:34816
    v_mfma_f32_16x16x32_bf16 v[128:131], v[64:67], v[76:79], v[128:131]
    ds_read_b128 v[48:51], v32 offset:36864
    ds_read_b128 v[52:55], v32 offset:38912
    v_mfma_f32_16x16x32_bf16 v[132:135], v[64:67], v[80:83], v[132:135]
    ds_read_b64_tr_b16 v[60:61], v31 offset:36864
    ds_read_b64_tr_b16 v[62:63], v31 offset:37376
    s_waitcnt lgkmcnt(8)
    v_mfma_f32_16x16x32_bf16 v[136:139], v[84:87], v[68:71], v[136:139]
    ds_read_b64_tr_b16 v[64:65], v30 offset:8192
    ds_read_b64_tr_b16 v[66:67], v30 offset:8704
    v_mfma_f32_16x16x32_bf16 v[140:143], v[84:87], v[72:75], v[140:143]
    v_mfma_f32_16x16x32_bf16 v[144:147], v[84:87], v[76:79], v[144:147]
    v_mfma_f32_16x16x32_bf16 v[148:151], v[84:87], v[80:83], v[148:151]
    v_mfma_f32_16x16x32_bf16 v[152:155], v[36:39], v[68:71], v[152:155]
    v_mfma_f32_16x16x32_bf16 v[156:159], v[36:39], v[72:75], v[156:159]
    v_mfma_f32_16x16x32_bf16 v[160:163], v[36:39], v[76:79], v[160:163]
    v_mfma_f32_16x16x32_bf16 v[164:167], v[36:39], v[80:83], v[164:167]
    s_waitcnt lgkmcnt(0)
    v_mfma_f32_16x16x32_bf16 v[120:123], v[56:59], v[40:43], v[120:123]
    s_barrier
    ds_read_b64_tr_b16 v[84:85], v31 offset:28672
    ds_read_b64_tr_b16 v[86:87], v31 offset:29184
    v_mfma_f32_16x16x32_bf16 v[124:127], v[56:59], v[44:47], v[124:127]
    ds_read_b128 v[68:71], v33 offset:32768
    ds_read_b128 v[72:75], v33 offset:34816
    v_mfma_f32_16x16x32_bf16 v[128:131], v[56:59], v[48:51], v[128:131]
    ds_read_b128 v[76:79], v33 offset:36864
    ds_read_b128 v[36:39], v33 offset:38912
    v_mfma_f32_16x16x32_bf16 v[132:135], v[56:59], v[52:55], v[132:135]
    ds_read_b64_tr_b16 v[80:81], v30 offset:0
    ds_read_b64_tr_b16 v[82:83], v30 offset:512
    v_mfma_f32_16x16x32_bf16 v[136:139], v[60:63], v[40:43], v[136:139]
    ds_read_b64_tr_b16 v[56:57], v31 offset:32768
    ds_read_b64_tr_b16 v[58:59], v31 offset:33280
    v_mfma_f32_16x16x32_bf16 v[140:143], v[60:63], v[44:47], v[140:143]
    v_mfma_f32_16x16x32_bf16 v[144:147], v[60:63], v[48:51], v[144:147]
    v_mfma_f32_16x16x32_bf16 v[148:151], v[60:63], v[52:55], v[148:151]
    v_mfma_f32_16x16x32_bf16 v[152:155], v[64:67], v[40:43], v[152:155]
    v_mfma_f32_16x16x32_bf16 v[156:159], v[64:67], v[44:47], v[156:159]
    v_mfma_f32_16x16x32_bf16 v[160:163], v[64:67], v[48:51], v[160:163]
    v_mfma_f32_16x16x32_bf16 v[164:167], v[64:67], v[52:55], v[164:167]
    s_waitcnt lgkmcnt(0)
    v_mfma_f32_16x16x32_bf16 v[120:123], v[84:87], v[68:71], v[120:123]
    s_barrier
    ds_read_b64_tr_b16 v[60:61], v30 offset:49152
    ds_read_b64_tr_b16 v[62:63], v30 offset:49664
    v_mfma_f32_16x16x32_bf16 v[124:127], v[84:87], v[72:75], v[124:127]
    ds_read_b128 v[40:43], v32 offset:16384
    ds_read_b128 v[44:47], v32 offset:18432
    v_mfma_f32_16x16x32_bf16 v[128:131], v[84:87], v[76:79], v[128:131]
    ds_read_b128 v[48:51], v32 offset:20480
    ds_read_b128 v[52:55], v32 offset:22528
    v_mfma_f32_16x16x32_bf16 v[132:135], v[84:87], v[36:39], v[132:135]
    ds_read_b64_tr_b16 v[64:65], v31 offset:24576
    ds_read_b64_tr_b16 v[66:67], v31 offset:25088
    v_mfma_f32_16x16x32_bf16 v[136:139], v[80:83], v[68:71], v[136:139]
    ds_read_b64_tr_b16 v[84:85], v31 offset:20480
    ds_read_b64_tr_b16 v[86:87], v31 offset:20992
    v_mfma_f32_16x16x32_bf16 v[140:143], v[80:83], v[72:75], v[140:143]
    v_mfma_f32_16x16x32_bf16 v[144:147], v[80:83], v[76:79], v[144:147]
    v_mfma_f32_16x16x32_bf16 v[148:151], v[80:83], v[36:39], v[148:151]
    v_mfma_f32_16x16x32_bf16 v[152:155], v[56:59], v[68:71], v[152:155]
    v_mfma_f32_16x16x32_bf16 v[156:159], v[56:59], v[72:75], v[156:159]
    v_mfma_f32_16x16x32_bf16 v[160:163], v[56:59], v[76:79], v[160:163]
    v_mfma_f32_16x16x32_bf16 v[164:167], v[56:59], v[36:39], v[164:167]
    s_waitcnt lgkmcnt(0)
    v_mfma_f32_16x16x32_bf16 v[120:123], v[60:63], v[40:43], v[120:123]
    s_barrier
    ds_read_b64_tr_b16 v[80:81], v31 offset:53248
    ds_read_b64_tr_b16 v[82:83], v31 offset:53760
    v_mfma_f32_16x16x32_bf16 v[124:127], v[60:63], v[44:47], v[124:127]
    ds_read_b128 v[68:71], v33 offset:16384
    ds_read_b128 v[72:75], v33 offset:18432
    v_mfma_f32_16x16x32_bf16 v[128:131], v[60:63], v[48:51], v[128:131]
    ds_read_b128 v[76:79], v33 offset:20480
    ds_read_b128 v[36:39], v33 offset:22528
    v_mfma_f32_16x16x32_bf16 v[132:135], v[60:63], v[52:55], v[132:135]
    ds_read_b64_tr_b16 v[56:57], v31 offset:61440
    ds_read_b64_tr_b16 v[58:59], v31 offset:61952
    v_mfma_f32_16x16x32_bf16 v[136:139], v[64:67], v[40:43], v[136:139]
    ds_read_b64_tr_b16 v[60:61], v31 offset:57344
    ds_read_b64_tr_b16 v[62:63], v31 offset:57856
    v_mfma_f32_16x16x32_bf16 v[140:143], v[64:67], v[44:47], v[140:143]
    v_mfma_f32_16x16x32_bf16 v[144:147], v[64:67], v[48:51], v[144:147]
    v_mfma_f32_16x16x32_bf16 v[148:151], v[64:67], v[52:55], v[148:151]
    v_mfma_f32_16x16x32_bf16 v[152:155], v[84:87], v[40:43], v[152:155]
    v_mfma_f32_16x16x32_bf16 v[156:159], v[84:87], v[44:47], v[156:159]
    v_mfma_f32_16x16x32_bf16 v[160:163], v[84:87], v[48:51], v[160:163]
    v_mfma_f32_16x16x32_bf16 v[164:167], v[84:87], v[52:55], v[164:167]
    s_waitcnt lgkmcnt(0)
    v_mfma_f32_16x16x32_bf16 v[120:123], v[80:83], v[68:71], v[120:123]
    s_barrier
    ds_read_b64_tr_b16 v[64:65], v31 offset:40960
    ds_read_b64_tr_b16 v[66:67], v31 offset:41472
    v_mfma_f32_16x16x32_bf16 v[124:127], v[80:83], v[72:75], v[124:127]
    ds_read_b128 v[40:43], v32 offset:49152
    ds_read_b128 v[44:47], v32 offset:51200
    v_mfma_f32_16x16x32_bf16 v[128:131], v[80:83], v[76:79], v[128:131]
    ds_read_b128 v[48:51], v32 offset:53248
    ds_read_b128 v[52:55], v32 offset:55296
    v_mfma_f32_16x16x32_bf16 v[132:135], v[80:83], v[36:39], v[132:135]
    ds_read_b64_tr_b16 v[84:85], v31 offset:49152
    ds_read_b64_tr_b16 v[86:87], v31 offset:49664
    v_mfma_f32_16x16x32_bf16 v[136:139], v[56:59], v[68:71], v[136:139]
    ds_read_b64_tr_b16 v[80:81], v31 offset:45056
    ds_read_b64_tr_b16 v[82:83], v31 offset:45568
    v_mfma_f32_16x16x32_bf16 v[140:143], v[56:59], v[72:75], v[140:143]
    v_mfma_f32_16x16x32_bf16 v[144:147], v[56:59], v[76:79], v[144:147]
    v_mfma_f32_16x16x32_bf16 v[148:151], v[56:59], v[36:39], v[148:151]
    v_mfma_f32_16x16x32_bf16 v[152:155], v[60:63], v[68:71], v[152:155]
    v_mfma_f32_16x16x32_bf16 v[156:159], v[60:63], v[72:75], v[156:159]
    v_mfma_f32_16x16x32_bf16 v[160:163], v[60:63], v[76:79], v[160:163]
    v_mfma_f32_16x16x32_bf16 v[164:167], v[60:63], v[36:39], v[164:167]
    s_waitcnt lgkmcnt(0)
    v_mfma_f32_16x16x32_bf16 v[120:123], v[64:67], v[40:43], v[120:123]
    s_barrier
    ds_read_b64_tr_b16 v[56:57], v30 offset:36864
    ds_read_b64_tr_b16 v[58:59], v30 offset:37376
    v_mfma_f32_16x16x32_bf16 v[124:127], v[64:67], v[44:47], v[124:127]
    ds_read_b128 v[68:71], v33 offset:49152
    ds_read_b128 v[72:75], v33 offset:51200
    v_mfma_f32_16x16x32_bf16 v[128:131], v[64:67], v[48:51], v[128:131]
    ds_read_b128 v[76:79], v33 offset:53248
    ds_read_b128 v[36:39], v33 offset:55296
    v_mfma_f32_16x16x32_bf16 v[132:135], v[64:67], v[52:55], v[132:135]
    ds_read_b64_tr_b16 v[60:61], v30 offset:45056
    ds_read_b64_tr_b16 v[62:63], v30 offset:45568
    v_mfma_f32_16x16x32_bf16 v[136:139], v[84:87], v[40:43], v[136:139]
    ds_read_b64_tr_b16 v[64:65], v30 offset:40960
    ds_read_b64_tr_b16 v[66:67], v30 offset:41472
    v_mfma_f32_16x16x32_bf16 v[140:143], v[84:87], v[44:47], v[140:143]
    v_mfma_f32_16x16x32_bf16 v[144:147], v[84:87], v[48:51], v[144:147]
    v_mfma_f32_16x16x32_bf16 v[148:151], v[84:87], v[52:55], v[148:151]
    v_mfma_f32_16x16x32_bf16 v[152:155], v[80:83], v[40:43], v[152:155]
    v_mfma_f32_16x16x32_bf16 v[156:159], v[80:83], v[44:47], v[156:159]
    v_mfma_f32_16x16x32_bf16 v[160:163], v[80:83], v[48:51], v[160:163]
    v_mfma_f32_16x16x32_bf16 v[164:167], v[80:83], v[52:55], v[164:167]
    s_waitcnt lgkmcnt(0)
    v_mfma_f32_16x16x32_bf16 v[120:123], v[56:59], v[68:71], v[120:123]
    s_barrier
    ds_read_b64_tr_b16 v[84:85], v30 offset:4096
    ds_read_b64_tr_b16 v[86:87], v30 offset:4608
    v_mfma_f32_16x16x32_bf16 v[124:127], v[56:59], v[72:75], v[124:127]
    ds_read_b128 v[40:43], v32 offset:32768
    ds_read_b128 v[44:47], v32 offset:34816
    v_mfma_f32_16x16x32_bf16 v[128:131], v[56:59], v[76:79], v[128:131]
    ds_read_b128 v[48:51], v32 offset:36864
    ds_read_b128 v[52:55], v32 offset:38912
    v_mfma_f32_16x16x32_bf16 v[132:135], v[56:59], v[36:39], v[132:135]
    ds_read_b64_tr_b16 v[80:81], v31 offset:36864
    ds_read_b64_tr_b16 v[82:83], v31 offset:37376
    v_mfma_f32_16x16x32_bf16 v[136:139], v[60:63], v[68:71], v[136:139]
    ds_read_b64_tr_b16 v[56:57], v30 offset:8192
    ds_read_b64_tr_b16 v[58:59], v30 offset:8704
    v_mfma_f32_16x16x32_bf16 v[140:143], v[60:63], v[72:75], v[140:143]
    v_mfma_f32_16x16x32_bf16 v[144:147], v[60:63], v[76:79], v[144:147]
    v_mfma_f32_16x16x32_bf16 v[148:151], v[60:63], v[36:39], v[148:151]
    v_mfma_f32_16x16x32_bf16 v[152:155], v[64:67], v[68:71], v[152:155]
    v_mfma_f32_16x16x32_bf16 v[156:159], v[64:67], v[72:75], v[156:159]
    v_mfma_f32_16x16x32_bf16 v[160:163], v[64:67], v[76:79], v[160:163]
    v_mfma_f32_16x16x32_bf16 v[164:167], v[64:67], v[36:39], v[164:167]
    s_waitcnt lgkmcnt(0)
    v_mfma_f32_16x16x32_bf16 v[120:123], v[84:87], v[40:43], v[120:123]
    s_barrier
    ds_read_b64_tr_b16 v[60:61], v31 offset:28672
    ds_read_b64_tr_b16 v[62:63], v31 offset:29184
    v_mfma_f32_16x16x32_bf16 v[124:127], v[84:87], v[44:47], v[124:127]
    ds_read_b128 v[68:71], v33 offset:32768
    ds_read_b128 v[72:75], v33 offset:34816
    v_mfma_f32_16x16x32_bf16 v[128:131], v[84:87], v[48:51], v[128:131]
    ds_read_b128 v[76:79], v33 offset:36864
    ds_read_b128 v[36:39], v33 offset:38912
    v_mfma_f32_16x16x32_bf16 v[132:135], v[84:87], v[52:55], v[132:135]
    ds_read_b64_tr_b16 v[64:65], v30 offset:0
    ds_read_b64_tr_b16 v[66:67], v30 offset:512
    v_mfma_f32_16x16x32_bf16 v[136:139], v[80:83], v[40:43], v[136:139]
    ds_read_b64_tr_b16 v[84:85], v31 offset:32768
    ds_read_b64_tr_b16 v[86:87], v31 offset:33280
    v_mfma_f32_16x16x32_bf16 v[140:143], v[80:83], v[44:47], v[140:143]
    v_mfma_f32_16x16x32_bf16 v[144:147], v[80:83], v[48:51], v[144:147]
    v_mfma_f32_16x16x32_bf16 v[148:151], v[80:83], v[52:55], v[148:151]
    v_mfma_f32_16x16x32_bf16 v[152:155], v[56:59], v[40:43], v[152:155]
    v_mfma_f32_16x16x32_bf16 v[156:159], v[56:59], v[44:47], v[156:159]
    v_mfma_f32_16x16x32_bf16 v[160:163], v[56:59], v[48:51], v[160:163]
    v_mfma_f32_16x16x32_bf16 v[164:167], v[56:59], v[52:55], v[164:167]
    s_waitcnt lgkmcnt(0)
    v_mfma_f32_16x16x32_bf16 v[120:123], v[60:63], v[68:71], v[120:123]
    s_barrier
    ds_read_b64_tr_b16 v[80:81], v31 offset:53248
    ds_read_b64_tr_b16 v[82:83], v31 offset:53760
    v_mfma_f32_16x16x32_bf16 v[124:127], v[60:63], v[72:75], v[124:127]
    ds_read_b128 v[40:43], v32 offset:16384
    ds_read_b128 v[44:47], v32 offset:18432
    v_mfma_f32_16x16x32_bf16 v[128:131], v[60:63], v[76:79], v[128:131]
    ds_read_b128 v[48:51], v32 offset:20480
    ds_read_b128 v[52:55], v32 offset:22528
    v_mfma_f32_16x16x32_bf16 v[132:135], v[60:63], v[36:39], v[132:135]
    ds_read_b64_tr_b16 v[56:57], v31 offset:61440
    ds_read_b64_tr_b16 v[58:59], v31 offset:61952
    v_mfma_f32_16x16x32_bf16 v[136:139], v[64:67], v[68:71], v[136:139]
    ds_read_b64_tr_b16 v[60:61], v31 offset:57344
    ds_read_b64_tr_b16 v[62:63], v31 offset:57856
    v_mfma_f32_16x16x32_bf16 v[140:143], v[64:67], v[72:75], v[140:143]
    v_mfma_f32_16x16x32_bf16 v[144:147], v[64:67], v[76:79], v[144:147]
    v_mfma_f32_16x16x32_bf16 v[148:151], v[64:67], v[36:39], v[148:151]
    v_mfma_f32_16x16x32_bf16 v[152:155], v[84:87], v[68:71], v[152:155]
    v_mfma_f32_16x16x32_bf16 v[156:159], v[84:87], v[72:75], v[156:159]
    v_mfma_f32_16x16x32_bf16 v[160:163], v[84:87], v[76:79], v[160:163]
    v_mfma_f32_16x16x32_bf16 v[164:167], v[84:87], v[36:39], v[164:167]
    s_waitcnt lgkmcnt(0)
    v_mfma_f32_16x16x32_bf16 v[120:123], v[80:83], v[40:43], v[120:123]
    s_barrier
    ds_read_b64_tr_b16 v[64:65], v31 offset:40960
    ds_read_b64_tr_b16 v[66:67], v31 offset:41472
    v_mfma_f32_16x16x32_bf16 v[124:127], v[80:83], v[44:47], v[124:127]
    ds_read_b128 v[68:71], v33 offset:16384
    ds_read_b128 v[72:75], v33 offset:18432
    v_mfma_f32_16x16x32_bf16 v[128:131], v[80:83], v[48:51], v[128:131]
    ds_read_b128 v[76:79], v33 offset:20480
    ds_read_b128 v[36:39], v33 offset:22528
    v_mfma_f32_16x16x32_bf16 v[132:135], v[80:83], v[52:55], v[132:135]
    ds_read_b64_tr_b16 v[84:85], v31 offset:49152
    ds_read_b64_tr_b16 v[86:87], v31 offset:49664
    v_mfma_f32_16x16x32_bf16 v[136:139], v[56:59], v[40:43], v[136:139]
    ds_read_b64_tr_b16 v[80:81], v31 offset:45056
    ds_read_b64_tr_b16 v[82:83], v31 offset:45568
    v_mfma_f32_16x16x32_bf16 v[140:143], v[56:59], v[44:47], v[140:143]
    v_mfma_f32_16x16x32_bf16 v[144:147], v[56:59], v[48:51], v[144:147]
    v_mfma_f32_16x16x32_bf16 v[148:151], v[56:59], v[52:55], v[148:151]
    v_mfma_f32_16x16x32_bf16 v[152:155], v[60:63], v[40:43], v[152:155]
    v_mfma_f32_16x16x32_bf16 v[156:159], v[60:63], v[44:47], v[156:159]
    v_mfma_f32_16x16x32_bf16 v[160:163], v[60:63], v[48:51], v[160:163]
    v_mfma_f32_16x16x32_bf16 v[164:167], v[60:63], v[52:55], v[164:167]
    s_waitcnt lgkmcnt(0)
    v_mfma_f32_16x16x32_bf16 v[120:123], v[64:67], v[68:71], v[120:123]
    s_barrier
    ds_read_b64_tr_b16 v[56:57], v31 offset:16384
    ds_read_b64_tr_b16 v[58:59], v31 offset:16896
    v_mfma_f32_16x16x32_bf16 v[124:127], v[64:67], v[72:75], v[124:127]
    ds_read_b128 v[40:43], v32 offset:0
    ds_read_b128 v[44:47], v32 offset:2048
    v_mfma_f32_16x16x32_bf16 v[128:131], v[64:67], v[76:79], v[128:131]
    ds_read_b128 v[48:51], v32 offset:4096
    ds_read_b128 v[52:55], v32 offset:6144
    v_mfma_f32_16x16x32_bf16 v[132:135], v[64:67], v[36:39], v[132:135]
    ds_read_b64_tr_b16 v[60:61], v31 offset:12288
    ds_read_b64_tr_b16 v[62:63], v31 offset:12800
    v_mfma_f32_16x16x32_bf16 v[136:139], v[84:87], v[68:71], v[136:139]
    ds_read_b64_tr_b16 v[64:65], v31 offset:24576
    ds_read_b64_tr_b16 v[66:67], v31 offset:25088
    v_mfma_f32_16x16x32_bf16 v[140:143], v[84:87], v[72:75], v[140:143]
    v_mfma_f32_16x16x32_bf16 v[144:147], v[84:87], v[76:79], v[144:147]
    v_mfma_f32_16x16x32_bf16 v[148:151], v[84:87], v[36:39], v[148:151]
    v_mfma_f32_16x16x32_bf16 v[152:155], v[80:83], v[68:71], v[152:155]
    ds_read_b64_tr_b16 v[84:85], v31 offset:8192
    ds_read_b64_tr_b16 v[86:87], v31 offset:8704
    v_mfma_f32_16x16x32_bf16 v[156:159], v[80:83], v[72:75], v[156:159]
    ds_read_b64_tr_b16 v[68:69], v31 offset:4096
    ds_read_b64_tr_b16 v[70:71], v31 offset:4608
    v_mfma_f32_16x16x32_bf16 v[160:163], v[80:83], v[76:79], v[160:163]
    v_mfma_f32_16x16x32_bf16 v[164:167], v[80:83], v[36:39], v[164:167]
    s_waitcnt lgkmcnt(4)
    v_mfma_f32_16x16x32_bf16 v[88:91], v[56:59], v[40:43], 0
    s_barrier
    ds_read_b64_tr_b16 v[72:73], v31 offset:20480
    ds_read_b64_tr_b16 v[74:75], v31 offset:20992
    v_mfma_f32_16x16x32_bf16 v[92:95], v[56:59], v[44:47], 0
    ds_read_b128 v[76:79], v33 offset:0
    ds_read_b128 v[36:39], v33 offset:2048
    v_mfma_f32_16x16x32_bf16 v[96:99], v[56:59], v[48:51], 0
    ds_read_b128 v[80:83], v33 offset:4096
    v_mfma_f32_16x16x32_bf16 v[100:103], v[56:59], v[52:55], 0
    v_mfma_f32_16x16x32_bf16 v[104:107], v[60:63], v[40:43], 0
    ds_read_b128 v[56:59], v33 offset:6144
    v_mfma_f32_16x16x32_bf16 v[108:111], v[60:63], v[44:47], 0
    v_mfma_f32_16x16x32_bf16 v[112:115], v[60:63], v[48:51], 0
    v_mfma_f32_16x16x32_bf16 v[116:119], v[60:63], v[52:55], 0
    v_mfma_f32_16x16x32_bf16 v[120:123], v[64:67], v[40:43], v[120:123]
    ds_read_b64_tr_b16 v[60:61], v30 offset:49152
    ds_read_b64_tr_b16 v[62:63], v30 offset:49664
    v_mfma_f32_16x16x32_bf16 v[124:127], v[64:67], v[44:47], v[124:127]
    v_mfma_f32_16x16x32_bf16 v[128:131], v[64:67], v[48:51], v[128:131]
    v_mfma_f32_16x16x32_bf16 v[132:135], v[64:67], v[52:55], v[132:135]
    s_waitcnt lgkmcnt(2)
    v_mfma_f32_16x16x32_bf16 v[136:139], v[84:87], v[40:43], v[136:139]
    ds_read_b64_tr_b16 v[64:65], v30 offset:4096
    ds_read_b64_tr_b16 v[66:67], v30 offset:4608
    v_mfma_f32_16x16x32_bf16 v[140:143], v[84:87], v[44:47], v[140:143]
    v_mfma_f32_16x16x32_bf16 v[144:147], v[84:87], v[48:51], v[144:147]
    v_mfma_f32_16x16x32_bf16 v[148:151], v[84:87], v[52:55], v[148:151]
    v_mfma_f32_16x16x32_bf16 v[152:155], v[68:71], v[40:43], v[152:155]
    ds_read_b64_tr_b16 v[84:85], v31 offset:36864
    ds_read_b64_tr_b16 v[86:87], v31 offset:37376
    v_mfma_f32_16x16x32_bf16 v[156:159], v[68:71], v[44:47], v[156:159]
    ds_read_b64_tr_b16 v[40:41], v30 offset:8192
    ds_read_b64_tr_b16 v[42:43], v30 offset:8704
    v_mfma_f32_16x16x32_bf16 v[160:163], v[68:71], v[48:51], v[160:163]
    v_mfma_f32_16x16x32_bf16 v[164:167], v[68:71], v[52:55], v[164:167]
    v_mfma_f32_16x16x32_bf16 v[88:91], v[72:75], v[76:79], v[88:91]
    s_barrier
    ds_read_b64_tr_b16 v[44:45], v31 offset:61440
    ds_read_b64_tr_b16 v[46:47], v31 offset:61952
    v_mfma_f32_16x16x32_bf16 v[92:95], v[72:75], v[36:39], v[92:95]
    ds_read_b128 v[48:51], v32 offset:32768
    ds_read_b128 v[52:55], v32 offset:34816
    v_mfma_f32_16x16x32_bf16 v[96:99], v[72:75], v[80:83], v[96:99]
    ds_read_b128 v[68:71], v32 offset:36864
    v_mfma_f32_16x16x32_bf16 v[100:103], v[72:75], v[56:59], v[100:103]
    s_waitcnt lgkmcnt(5)
    v_mfma_f32_16x16x32_bf16 v[104:107], v[60:63], v[76:79], v[104:107]
    ds_read_b128 v[72:75], v32 offset:38912
    v_mfma_f32_16x16x32_bf16 v[108:111], v[60:63], v[36:39], v[108:111]
    v_mfma_f32_16x16x32_bf16 v[112:115], v[60:63], v[80:83], v[112:115]
    v_mfma_f32_16x16x32_bf16 v[116:119], v[60:63], v[56:59], v[116:119]
    v_mfma_f32_16x16x32_bf16 v[120:123], v[64:67], v[76:79], v[120:123]
    ds_read_b64_tr_b16 v[60:61], v31 offset:57344
    ds_read_b64_tr_b16 v[62:63], v31 offset:57856
    v_mfma_f32_16x16x32_bf16 v[124:127], v[64:67], v[36:39], v[124:127]
    v_mfma_f32_16x16x32_bf16 v[128:131], v[64:67], v[80:83], v[128:131]
    v_mfma_f32_16x16x32_bf16 v[132:135], v[64:67], v[56:59], v[132:135]
    v_mfma_f32_16x16x32_bf16 v[136:139], v[84:87], v[76:79], v[136:139]
    ds_read_b64_tr_b16 v[64:65], v31 offset:32768
    ds_read_b64_tr_b16 v[66:67], v31 offset:33280
    v_mfma_f32_16x16x32_bf16 v[140:143], v[84:87], v[36:39], v[140:143]
    v_mfma_f32_16x16x32_bf16 v[144:147], v[84:87], v[80:83], v[144:147]
    v_mfma_f32_16x16x32_bf16 v[148:151], v[84:87], v[56:59], v[148:151]
    v_mfma_f32_16x16x32_bf16 v[152:155], v[40:43], v[76:79], v[152:155]
    ds_read_b64_tr_b16 v[84:85], v31 offset:53248
    ds_read_b64_tr_b16 v[86:87], v31 offset:53760
    v_mfma_f32_16x16x32_bf16 v[156:159], v[40:43], v[36:39], v[156:159]
    ds_read_b64_tr_b16 v[76:77], v30 offset:0
    ds_read_b64_tr_b16 v[78:79], v30 offset:512
    v_mfma_f32_16x16x32_bf16 v[160:163], v[40:43], v[80:83], v[160:163]
    v_mfma_f32_16x16x32_bf16 v[164:167], v[40:43], v[56:59], v[164:167]
    s_waitcnt lgkmcnt(4)
    v_mfma_f32_16x16x32_bf16 v[88:91], v[44:47], v[48:51], v[88:91]
    s_barrier
    ds_read_b64_tr_b16 v[36:37], v31 offset:49152
    ds_read_b64_tr_b16 v[38:39], v31 offset:49664
    v_mfma_f32_16x16x32_bf16 v[92:95], v[44:47], v[52:55], v[92:95]
    ds_read_b128 v[80:83], v33 offset:32768
    ds_read_b128 v[40:43], v33 offset:34816
    v_mfma_f32_16x16x32_bf16 v[96:99], v[44:47], v[68:71], v[96:99]
    ds_read_b128 v[56:59], v33 offset:36864
    v_mfma_f32_16x16x32_bf16 v[100:103], v[44:47], v[72:75], v[100:103]
    v_mfma_f32_16x16x32_bf16 v[104:107], v[60:63], v[48:51], v[104:107]
    ds_read_b128 v[44:47], v33 offset:38912
    v_mfma_f32_16x16x32_bf16 v[108:111], v[60:63], v[52:55], v[108:111]
    v_mfma_f32_16x16x32_bf16 v[112:115], v[60:63], v[68:71], v[112:115]
    v_mfma_f32_16x16x32_bf16 v[116:119], v[60:63], v[72:75], v[116:119]
    v_mfma_f32_16x16x32_bf16 v[120:123], v[64:67], v[48:51], v[120:123]
    ds_read_b64_tr_b16 v[60:61], v31 offset:45056
    ds_read_b64_tr_b16 v[62:63], v31 offset:45568
    v_mfma_f32_16x16x32_bf16 v[124:127], v[64:67], v[52:55], v[124:127]
    v_mfma_f32_16x16x32_bf16 v[128:131], v[64:67], v[68:71], v[128:131]
    v_mfma_f32_16x16x32_bf16 v[132:135], v[64:67], v[72:75], v[132:135]
    s_waitcnt lgkmcnt(2)
    v_mfma_f32_16x16x32_bf16 v[136:139], v[84:87], v[48:51], v[136:139]
    ds_read_b64_tr_b16 v[64:65], v30 offset:45056
    ds_read_b64_tr_b16 v[66:67], v30 offset:45568
    v_mfma_f32_16x16x32_bf16 v[140:143], v[84:87], v[52:55], v[140:143]
    v_mfma_f32_16x16x32_bf16 v[144:147], v[84:87], v[68:71], v[144:147]
    v_mfma_f32_16x16x32_bf16 v[148:151], v[84:87], v[72:75], v[148:151]
    v_mfma_f32_16x16x32_bf16 v[152:155], v[76:79], v[48:51], v[152:155]
    ds_read_b64_tr_b16 v[84:85], v31 offset:40960
    ds_read_b64_tr_b16 v[86:87], v31 offset:41472
    v_mfma_f32_16x16x32_bf16 v[156:159], v[76:79], v[52:55], v[156:159]
    ds_read_b64_tr_b16 v[48:49], v31 offset:28672
    ds_read_b64_tr_b16 v[50:51], v31 offset:29184
    v_mfma_f32_16x16x32_bf16 v[160:163], v[76:79], v[68:71], v[160:163]
    v_mfma_f32_16x16x32_bf16 v[164:167], v[76:79], v[72:75], v[164:167]
    v_mfma_f32_16x16x32_bf16 v[88:91], v[36:39], v[80:83], v[88:91]
    s_barrier
    ds_read_b64_tr_b16 v[52:53], v30 offset:40960
    ds_read_b64_tr_b16 v[54:55], v30 offset:41472
    v_mfma_f32_16x16x32_bf16 v[92:95], v[36:39], v[40:43], v[92:95]
    ds_read_b128 v[68:71], v32 offset:16384
    ds_read_b128 v[72:75], v32 offset:18432
    v_mfma_f32_16x16x32_bf16 v[96:99], v[36:39], v[56:59], v[96:99]
    ds_read_b128 v[76:79], v32 offset:20480
    v_mfma_f32_16x16x32_bf16 v[100:103], v[36:39], v[44:47], v[100:103]
    s_waitcnt lgkmcnt(5)
    v_mfma_f32_16x16x32_bf16 v[104:107], v[60:63], v[80:83], v[104:107]
    ds_read_b128 v[36:39], v32 offset:22528
    v_mfma_f32_16x16x32_bf16 v[108:111], v[60:63], v[40:43], v[108:111]
    v_mfma_f32_16x16x32_bf16 v[112:115], v[60:63], v[56:59], v[112:115]
    v_mfma_f32_16x16x32_bf16 v[116:119], v[60:63], v[44:47], v[116:119]
    v_mfma_f32_16x16x32_bf16 v[120:123], v[64:67], v[80:83], v[120:123]
    ds_read_b64_tr_b16 v[60:61], v30 offset:36864
    ds_read_b64_tr_b16 v[62:63], v30 offset:37376
    v_mfma_f32_16x16x32_bf16 v[124:127], v[64:67], v[40:43], v[124:127]
    v_mfma_f32_16x16x32_bf16 v[128:131], v[64:67], v[56:59], v[128:131]
    v_mfma_f32_16x16x32_bf16 v[132:135], v[64:67], v[44:47], v[132:135]
    v_mfma_f32_16x16x32_bf16 v[136:139], v[84:87], v[80:83], v[136:139]
    ds_read_b64_tr_b16 v[64:65], v31 offset:8192
    ds_read_b64_tr_b16 v[66:67], v31 offset:8704
    v_mfma_f32_16x16x32_bf16 v[140:143], v[84:87], v[40:43], v[140:143]
    v_mfma_f32_16x16x32_bf16 v[144:147], v[84:87], v[56:59], v[144:147]
    v_mfma_f32_16x16x32_bf16 v[148:151], v[84:87], v[44:47], v[148:151]
    v_mfma_f32_16x16x32_bf16 v[152:155], v[48:51], v[80:83], v[152:155]
    ds_read_b64_tr_b16 v[84:85], v31 offset:16384
    ds_read_b64_tr_b16 v[86:87], v31 offset:16896
    v_mfma_f32_16x16x32_bf16 v[156:159], v[48:51], v[40:43], v[156:159]
    ds_read_b64_tr_b16 v[80:81], v31 offset:12288
    ds_read_b64_tr_b16 v[82:83], v31 offset:12800
    v_mfma_f32_16x16x32_bf16 v[160:163], v[48:51], v[56:59], v[160:163]
    v_mfma_f32_16x16x32_bf16 v[164:167], v[48:51], v[44:47], v[164:167]
    s_waitcnt lgkmcnt(4)
    v_mfma_f32_16x16x32_bf16 v[88:91], v[52:55], v[68:71], v[88:91]
    s_barrier
    ds_read_b64_tr_b16 v[40:41], v31 offset:4096
    ds_read_b64_tr_b16 v[42:43], v31 offset:4608
    v_mfma_f32_16x16x32_bf16 v[92:95], v[52:55], v[72:75], v[92:95]
    ds_read_b128 v[56:59], v33 offset:16384
    ds_read_b128 v[44:47], v33 offset:18432
    v_mfma_f32_16x16x32_bf16 v[96:99], v[52:55], v[76:79], v[96:99]
    ds_read_b128 v[48:51], v33 offset:20480
    v_mfma_f32_16x16x32_bf16 v[100:103], v[52:55], v[36:39], v[100:103]
    v_mfma_f32_16x16x32_bf16 v[104:107], v[60:63], v[68:71], v[104:107]
    ds_read_b128 v[52:55], v33 offset:22528
    v_mfma_f32_16x16x32_bf16 v[108:111], v[60:63], v[72:75], v[108:111]
    v_mfma_f32_16x16x32_bf16 v[112:115], v[60:63], v[76:79], v[112:115]
    v_mfma_f32_16x16x32_bf16 v[116:119], v[60:63], v[36:39], v[116:119]
    v_mfma_f32_16x16x32_bf16 v[120:123], v[64:67], v[68:71], v[120:123]
    ds_read_b64_tr_b16 v[60:61], v31 offset:24576
    ds_read_b64_tr_b16 v[62:63], v31 offset:25088
    v_mfma_f32_16x16x32_bf16 v[124:127], v[64:67], v[72:75], v[124:127]
    v_mfma_f32_16x16x32_bf16 v[128:131], v[64:67], v[76:79], v[128:131]
    v_mfma_f32_16x16x32_bf16 v[132:135], v[64:67], v[36:39], v[132:135]
    s_waitcnt lgkmcnt(2)
    v_mfma_f32_16x16x32_bf16 v[136:139], v[84:87], v[68:71], v[136:139]
    ds_read_b64_tr_b16 v[64:65], v30 offset:24576
    ds_read_b64_tr_b16 v[66:67], v30 offset:25088
    v_mfma_f32_16x16x32_bf16 v[140:143], v[84:87], v[72:75], v[140:143]
    v_mfma_f32_16x16x32_bf16 v[144:147], v[84:87], v[76:79], v[144:147]
    v_mfma_f32_16x16x32_bf16 v[148:151], v[84:87], v[36:39], v[148:151]
    v_mfma_f32_16x16x32_bf16 v[152:155], v[80:83], v[68:71], v[152:155]
    ds_read_b64_tr_b16 v[84:85], v30 offset:32768
    ds_read_b64_tr_b16 v[86:87], v30 offset:33280
    v_mfma_f32_16x16x32_bf16 v[156:159], v[80:83], v[72:75], v[156:159]
    ds_read_b64_tr_b16 v[68:69], v30 offset:28672
    ds_read_b64_tr_b16 v[70:71], v30 offset:29184
    v_mfma_f32_16x16x32_bf16 v[160:163], v[80:83], v[76:79], v[160:163]
    v_mfma_f32_16x16x32_bf16 v[164:167], v[80:83], v[36:39], v[164:167]
    v_mfma_f32_16x16x32_bf16 v[88:91], v[40:43], v[56:59], v[88:91]
    s_barrier
    ds_read_b64_tr_b16 v[72:73], v31 offset:36864
    ds_read_b64_tr_b16 v[74:75], v31 offset:37376
    v_mfma_f32_16x16x32_bf16 v[92:95], v[40:43], v[44:47], v[92:95]
    ds_read_b128 v[76:79], v32 offset:0
    ds_read_b128 v[36:39], v32 offset:2048
    v_mfma_f32_16x16x32_bf16 v[96:99], v[40:43], v[48:51], v[96:99]
    ds_read_b128 v[80:83], v32 offset:4096
    v_mfma_f32_16x16x32_bf16 v[100:103], v[40:43], v[52:55], v[100:103]
    s_waitcnt lgkmcnt(5)
    v_mfma_f32_16x16x32_bf16 v[104:107], v[60:63], v[56:59], v[104:107]
    ds_read_b128 v[40:43], v32 offset:6144
    v_mfma_f32_16x16x32_bf16 v[108:111], v[60:63], v[44:47], v[108:111]
    v_mfma_f32_16x16x32_bf16 v[112:115], v[60:63], v[48:51], v[112:115]
    v_mfma_f32_16x16x32_bf16 v[116:119], v[60:63], v[52:55], v[116:119]
    v_mfma_f32_16x16x32_bf16 v[120:123], v[64:67], v[56:59], v[120:123]
    ds_read_b64_tr_b16 v[60:61], v30 offset:8192
    ds_read_b64_tr_b16 v[62:63], v30 offset:8704
    v_mfma_f32_16x16x32_bf16 v[124:127], v[64:67], v[44:47], v[124:127]
    v_mfma_f32_16x16x32_bf16 v[128:131], v[64:67], v[48:51], v[128:131]
    v_mfma_f32_16x16x32_bf16 v[132:135], v[64:67], v[52:55], v[132:135]
    v_mfma_f32_16x16x32_bf16 v[136:139], v[84:87], v[56:59], v[136:139]
    ds_read_b64_tr_b16 v[64:65], v30 offset:49152
    ds_read_b64_tr_b16 v[66:67], v30 offset:49664
    v_mfma_f32_16x16x32_bf16 v[140:143], v[84:87], v[44:47], v[140:143]
    v_mfma_f32_16x16x32_bf16 v[144:147], v[84:87], v[48:51], v[144:147]
    v_mfma_f32_16x16x32_bf16 v[148:151], v[84:87], v[52:55], v[148:151]
    v_mfma_f32_16x16x32_bf16 v[152:155], v[68:71], v[56:59], v[152:155]
    ds_read_b64_tr_b16 v[84:85], v30 offset:4096
    ds_read_b64_tr_b16 v[86:87], v30 offset:4608
    v_mfma_f32_16x16x32_bf16 v[156:159], v[68:71], v[44:47], v[156:159]
    ds_read_b64_tr_b16 v[56:57], v31 offset:20480
    ds_read_b64_tr_b16 v[58:59], v31 offset:20992
    v_mfma_f32_16x16x32_bf16 v[160:163], v[68:71], v[48:51], v[160:163]
    v_mfma_f32_16x16x32_bf16 v[164:167], v[68:71], v[52:55], v[164:167]
    s_waitcnt lgkmcnt(4)
    v_mfma_f32_16x16x32_bf16 v[88:91], v[72:75], v[76:79], v[88:91]
    s_barrier
    ds_read_b64_tr_b16 v[44:45], v31 offset:61440
    ds_read_b64_tr_b16 v[46:47], v31 offset:61952
    v_mfma_f32_16x16x32_bf16 v[92:95], v[72:75], v[36:39], v[92:95]
    ds_read_b128 v[48:51], v33 offset:0
    ds_read_b128 v[52:55], v33 offset:2048
    v_mfma_f32_16x16x32_bf16 v[96:99], v[72:75], v[80:83], v[96:99]
    ds_read_b128 v[68:71], v33 offset:4096
    v_mfma_f32_16x16x32_bf16 v[100:103], v[72:75], v[40:43], v[100:103]
    v_mfma_f32_16x16x32_bf16 v[104:107], v[60:63], v[76:79], v[104:107]
    ds_read_b128 v[72:75], v33 offset:6144
    v_mfma_f32_16x16x32_bf16 v[108:111], v[60:63], v[36:39], v[108:111]
    v_mfma_f32_16x16x32_bf16 v[112:115], v[60:63], v[80:83], v[112:115]
    v_mfma_f32_16x16x32_bf16 v[116:119], v[60:63], v[40:43], v[116:119]
    v_mfma_f32_16x16x32_bf16 v[120:123], v[64:67], v[76:79], v[120:123]
    ds_read_b64_tr_b16 v[60:61], v31 offset:57344
    ds_read_b64_tr_b16 v[62:63], v31 offset:57856
    v_mfma_f32_16x16x32_bf16 v[124:127], v[64:67], v[36:39], v[124:127]
    v_mfma_f32_16x16x32_bf16 v[128:131], v[64:67], v[80:83], v[128:131]
    v_mfma_f32_16x16x32_bf16 v[132:135], v[64:67], v[40:43], v[132:135]
    s_waitcnt lgkmcnt(2)
    v_mfma_f32_16x16x32_bf16 v[136:139], v[84:87], v[76:79], v[136:139]
    ds_read_b64_tr_b16 v[64:65], v31 offset:32768
    ds_read_b64_tr_b16 v[66:67], v31 offset:33280
    v_mfma_f32_16x16x32_bf16 v[140:143], v[84:87], v[36:39], v[140:143]
    v_mfma_f32_16x16x32_bf16 v[144:147], v[84:87], v[80:83], v[144:147]
    v_mfma_f32_16x16x32_bf16 v[148:151], v[84:87], v[40:43], v[148:151]
    v_mfma_f32_16x16x32_bf16 v[152:155], v[56:59], v[76:79], v[152:155]
    ds_read_b64_tr_b16 v[84:85], v31 offset:53248
    ds_read_b64_tr_b16 v[86:87], v31 offset:53760
    v_mfma_f32_16x16x32_bf16 v[156:159], v[56:59], v[36:39], v[156:159]
    ds_read_b64_tr_b16 v[76:77], v30 offset:0
    ds_read_b64_tr_b16 v[78:79], v30 offset:512
    v_mfma_f32_16x16x32_bf16 v[160:163], v[56:59], v[80:83], v[160:163]
    v_mfma_f32_16x16x32_bf16 v[164:167], v[56:59], v[40:43], v[164:167]
    v_mfma_f32_16x16x32_bf16 v[88:91], v[44:47], v[48:51], v[88:91]
    s_barrier
    ds_read_b64_tr_b16 v[36:37], v31 offset:49152
    ds_read_b64_tr_b16 v[38:39], v31 offset:49664
    v_mfma_f32_16x16x32_bf16 v[92:95], v[44:47], v[52:55], v[92:95]
    ds_read_b128 v[40:43], v32 offset:32768
    ds_read_b128 v[56:59], v32 offset:34816
    v_mfma_f32_16x16x32_bf16 v[96:99], v[44:47], v[68:71], v[96:99]
    v_mfma_f32_16x16x32_bf16 v[100:103], v[44:47], v[72:75], v[100:103]
    s_waitcnt lgkmcnt(4)
    v_mfma_f32_16x16x32_bf16 v[104:107], v[60:63], v[48:51], v[104:107]
    ds_read_b128 v[44:47], v32 offset:36864
    v_mfma_f32_16x16x32_bf16 v[108:111], v[60:63], v[52:55], v[108:111]
    v_mfma_f32_16x16x32_bf16 v[112:115], v[60:63], v[68:71], v[112:115]
    v_mfma_f32_16x16x32_bf16 v[116:119], v[60:63], v[72:75], v[116:119]
    v_mfma_f32_16x16x32_bf16 v[120:123], v[64:67], v[48:51], v[120:123]
    ds_read_b128 v[60:63], v32 offset:38912
    v_mfma_f32_16x16x32_bf16 v[124:127], v[64:67], v[52:55], v[124:127]
    v_mfma_f32_16x16x32_bf16 v[128:131], v[64:67], v[68:71], v[128:131]
    v_mfma_f32_16x16x32_bf16 v[132:135], v[64:67], v[72:75], v[132:135]
    v_mfma_f32_16x16x32_bf16 v[136:139], v[84:87], v[48:51], v[136:139]
    ds_read_b64_tr_b16 v[64:65], v31 offset:45056
    ds_read_b64_tr_b16 v[66:67], v31 offset:45568
    v_mfma_f32_16x16x32_bf16 v[140:143], v[84:87], v[52:55], v[140:143]
    v_mfma_f32_16x16x32_bf16 v[144:147], v[84:87], v[68:71], v[144:147]
    v_mfma_f32_16x16x32_bf16 v[148:151], v[84:87], v[72:75], v[148:151]
    v_mfma_f32_16x16x32_bf16 v[152:155], v[76:79], v[48:51], v[152:155]
    v_mfma_f32_16x16x32_bf16 v[156:159], v[76:79], v[52:55], v[156:159]
    v_mfma_f32_16x16x32_bf16 v[160:163], v[76:79], v[68:71], v[160:163]
    v_mfma_f32_16x16x32_bf16 v[164:167], v[76:79], v[72:75], v[164:167]
    s_bitcmp1_b32 s22, 0
    s_cbranch_scc1 L_k1_odd
    s_waitcnt lgkmcnt(0)
    v_mfma_f32_16x16x32_bf16 v[88:91], v[36:39], v[40:43], v[88:91]
    s_barrier
    ds_read_b64_tr_b16 v[48:49], v31 offset:40960
    ds_read_b64_tr_b16 v[50:51], v31 offset:41472
    v_mfma_f32_16x16x32_bf16 v[92:95], v[36:39], v[56:59], v[92:95]
    ds_read_b128 v[52:55], v33 offset:32768
    ds_read_b128 v[68:71], v33 offset:34816
    v_mfma_f32_16x16x32_bf16 v[96:99], v[36:39], v[44:47], v[96:99]
    s_cmp_eq_u32 s43, 0
    s_cbranch_scc1 L_k1_ve
    v_mul_f32 v152, s43, v152
    v_mul_f32 v153, s43, v153
    v_mul_f32 v154, s43, v154
    v_mul_f32 v155, s43, v155
    v_mul_f32 v156, s43, v156
    v_mul_f32 v157, s43, v157
    v_mul_f32 v158, s43, v158
    v_mul_f32 v159, s43, v159
    v_mul_f32 v160, s43, v160
    v_mul_f32 v161, s43, v161
    v_mul_f32 v162, s43, v162
    v_mul_f32 v163, s43, v163
    v_mul_f32 v164, s43, v164
    v_mul_f32 v165, s43, v165
    v_mul_f32 v166, s43, v166
    v_mul_f32 v167, s43, v167
    v_cvt_pk_bf16_f32 v152, v152, v153
    v_cvt_pk_bf16_f32 v153, v154, v155
    v_cvt_pk_bf16_f32 v154, v156, v157
    v_cvt_pk_bf16_f32 v155, v158, v159
    v_cvt_pk_bf16_f32 v160, v160, v161
    v_cvt_pk_bf16_f32 v161, v162, v163
    v_cvt_pk_bf16_f32 v162, v164, v165
    v_cvt_pk_bf16_f32 v163, v166, v167
    v_permlane16_swap_b32 v152, v154
    v_permlane16_swap_b32 v153, v155
    v_and_b32 v152, s47, v152
    v_and_b32 v154, s47, v154
    buffer_store_dwordx4 v[152:155], v8, s[32:35], s40 offen sc1
    v_permlane16_swap_b32 v160, v162
    v_permlane16_swap_b32 v161, v163
    v_and_b32 v160, s47, v160
    v_and_b32 v162, s47, v162
    buffer_store_dwordx4 v[160:163], v34, s[32:35], s40 offen sc1
    s_branch L_k1_we
L_k1_ve:
    s_add_u32 s43, s40, 22986752
    v_cvt_pk_f16_f32 v72, v152, v153
    v_cvt_pk_f16_f32 v73, v154, v155
    v_cvt_pk_f16_f32 v74, v156, v157
    v_cvt_pk_f16_f32 v75, v158, v159
    v_cvt_pk_f16_f32 v76, v160, v161
    v_cvt_pk_f16_f32 v77, v162, v163
    v_cvt_pk_f16_f32 v78, v164, v165
    v_cvt_pk_f16_f32 v79, v166, v167
    v_permlane16_swap_b32 v72, v74
    v_permlane16_swap_b32 v73, v75
    buffer_store_dwordx4 v[72:75], v8, s[32:35], s40 offen sc1
    v_permlane16_swap_b32 v76, v78
    v_permlane16_swap_b32 v77, v79
    buffer_store_dwordx4 v[76:79], v34, s[32:35], s40 offen sc1
    v_minimum3_f32 v2, |v152|, |v153|, |v153|
    v_maximum3_f32 v3, |v152|, |v153|, |v153|
    v_minimum3_f32 v2, |v154|, |v155|, v2
    v_maximum3_f32 v3, |v154|, |v155|, v3
    v_minimum3_f32 v2, |v156|, |v157|, v2
    v_maximum3_f32 v3, |v156|, |v157|, v3
    v_minimum3_f32 v2, |v158|, |v159|, v2
    v_maximum3_f32 v3, |v158|, |v159|, v3
    v_minimum3_f32 v2, |v160|, |v161|, v2
    v_maximum3_f32 v3, |v160|, |v161|, v3
    v_minimum3_f32 v2, |v162|, |v163|, v2
    v_maximum3_f32 v3, |v162|, |v163|, v3
    v_minimum3_f32 v2, |v164|, |v165|, v2
    v_maximum3_f32 v3, |v164|, |v165|, v3
    v_minimum3_f32 v2, |v166|, |v167|, v2
    v_maximum3_f32 v3, |v166|, |v167|, v3
    v_cmp_nge_f32 vcc, v2, s48
    v_cmp_nle_f32 s[50:51], v3, s49
    s_nop 0
    s_or_b64 vcc, vcc, s[50:51]
    s_cbranch_scc0 L_k1_we
    v_cvt_pk_bf16_f32 v152, v152, v153
    v_cvt_pk_bf16_f32 v153, v154, v155
    v_cvt_pk_bf16_f32 v154, v156, v157
    v_cvt_pk_bf16_f32 v155, v158, v159
    v_cvt_pk_bf16_f32 v156, v160, v161
    v_cvt_pk_bf16_f32 v157, v162, v163
    v_cvt_pk_bf16_f32 v158, v164, v165
    v_cvt_pk_bf16_f32 v159, v166, v167
    v_permlane16_swap_b32 v152, v154
    v_permlane16_swap_b32 v153, v155
    buffer_store_dwordx4 v[152:155], v8, s[32:35], s43 offen sc1
    v_permlane16_swap_b32 v156, v158
    v_permlane16_swap_b32 v157, v159
    buffer_store_dwordx4 v[156:159], v34, s[32:35], s43 offen sc1
L_k1_we:
    v_mfma_f32_16x16x32_bf16 v[100:103], v[36:39], v[60:63], v[100:103]
    v_mfma_f32_16x16x32_bf16 v[104:107], v[64:67], v[40:43], v[104:107]
    ds_read_b128 v[36:39], v33 offset:36864
    v_mfma_f32_16x16x32_bf16 v[108:111], v[64:67], v[56:59], v[108:111]
    ds_read_b128 v[40:43], v33 offset:38912
    v_mfma_f32_16x16x32_bf16 v[112:115], v[64:67], v[44:47], v[112:115]
    ds_read_b64_tr_b16 v[56:57], v31 offset:28672
    ds_read_b64_tr_b16 v[58:59], v31 offset:29184
    v_mfma_f32_16x16x32_bf16 v[116:119], v[64:67], v[60:63], v[116:119]
    s_waitcnt lgkmcnt(4)
    v_mfma_f32_16x16x32_bf16 v[88:91], v[48:51], v[52:55], v[88:91]
    s_barrier
    ds_read_b64_tr_b16 v[44:45], v30 offset:45056
    ds_read_b64_tr_b16 v[46:47], v30 offset:45568
    v_mfma_f32_16x16x32_bf16 v[92:95], v[48:51], v[68:71], v[92:95]
    ds_read_b128 v[60:63], v32 offset:16384
    ds_read_b128 v[64:67], v32 offset:18432
    s_waitcnt lgkmcnt(7)
    v_mfma_f32_16x16x32_bf16 v[96:99], v[48:51], v[36:39], v[96:99]
    s_waitcnt lgkmcnt(6)
    v_mfma_f32_16x16x32_bf16 v[100:103], v[48:51], v[40:43], v[100:103]
    s_waitcnt lgkmcnt(4)
    v_mfma_f32_16x16x32_bf16 v[104:107], v[56:59], v[52:55], v[104:107]
    ds_read_b128 v[48:51], v32 offset:20480
    v_mfma_f32_16x16x32_bf16 v[108:111], v[56:59], v[68:71], v[108:111]
    ds_read_b128 v[52:55], v32 offset:22528
    v_mfma_f32_16x16x32_bf16 v[112:115], v[56:59], v[36:39], v[112:115]
    ds_read_b64_tr_b16 v[68:69], v30 offset:40960
    ds_read_b64_tr_b16 v[70:71], v30 offset:41472
    v_mfma_f32_16x16x32_bf16 v[116:119], v[56:59], v[40:43], v[116:119]
    s_waitcnt lgkmcnt(4)
    v_mfma_f32_16x16x32_bf16 v[88:91], v[44:47], v[60:63], v[88:91]
    s_barrier
    ds_read_b64_tr_b16 v[36:37], v30 offset:36864
    ds_read_b64_tr_b16 v[38:39], v30 offset:37376
    v_mfma_f32_16x16x32_bf16 v[92:95], v[44:47], v[64:67], v[92:95]
    ds_read_b128 v[40:43], v33 offset:16384
    ds_read_b128 v[56:59], v33 offset:18432
    s_waitcnt lgkmcnt(7)
    v_mfma_f32_16x16x32_bf16 v[96:99], v[44:47], v[48:51], v[96:99]
    s_waitcnt lgkmcnt(6)
    v_mfma_f32_16x16x32_bf16 v[100:103], v[44:47], v[52:55], v[100:103]
    s_waitcnt lgkmcnt(4)
    v_mfma_f32_16x16x32_bf16 v[104:107], v[68:71], v[60:63], v[104:107]
    ds_read_b128 v[44:47], v33 offset:20480
    v_mfma_f32_16x16x32_bf16 v[108:111], v[68:71], v[64:67], v[108:111]
    ds_read_b128 v[60:63], v33 offset:22528
    v_mfma_f32_16x16x32_bf16 v[112:115], v[68:71], v[48:51], v[112:115]
    ds_read_b64_tr_b16 v[64:65], v30 offset:20480
    ds_read_b64_tr_b16 v[66:67], v30 offset:20992
    v_mfma_f32_16x16x32_bf16 v[116:119], v[68:71], v[52:55], v[116:119]
    s_waitcnt lgkmcnt(4)
    v_mfma_f32_16x16x32_bf16 v[88:91], v[36:39], v[40:43], v[88:91]
    s_barrier
    ds_read_b64_tr_b16 v[48:49], v31 offset:36864
    ds_read_b64_tr_b16 v[50:51], v31 offset:37376
    v_mfma_f32_16x16x32_bf16 v[92:95], v[36:39], v[56:59], v[92:95]
    ds_read_b128 v[52:55], v32 offset:0
    ds_read_b128 v[68:71], v32 offset:2048
    s_waitcnt lgkmcnt(7)
    v_mfma_f32_16x16x32_bf16 v[96:99], v[36:39], v[44:47], v[96:99]
    s_waitcnt lgkmcnt(6)
    v_mfma_f32_16x16x32_bf16 v[100:103], v[36:39], v[60:63], v[100:103]
    s_waitcnt lgkmcnt(4)
    v_mfma_f32_16x16x32_bf16 v[104:107], v[64:67], v[40:43], v[104:107]
    ds_read_b128 v[36:39], v32 offset:4096
    v_mfma_f32_16x16x32_bf16 v[108:111], v[64:67], v[56:59], v[108:111]
    ds_read_b128 v[40:43], v32 offset:6144
    v_mfma_f32_16x16x32_bf16 v[112:115], v[64:67], v[44:47], v[112:115]
    ds_read_b64_tr_b16 v[56:57], v30 offset:8192
    ds_read_b64_tr_b16 v[58:59], v30 offset:8704
    v_mfma_f32_16x16x32_bf16 v[116:119], v[64:67], v[60:63], v[116:119]
    s_waitcnt lgkmcnt(4)
    v_mfma_f32_16x16x32_bf16 v[88:91], v[48:51], v[52:55], v[88:91]
    s_waitcnt vmcnt(0)
    s_barrier
    ds_read_b64_tr_b16 v[44:45], v30 offset:4096
    ds_read_b64_tr_b16 v[46:47], v30 offset:4608
    v_mfma_f32_16x16x32_bf16 v[92:95], v[48:51], v[68:71], v[92:95]
    ds_read_b128 v[60:63], v33 offset:0
    ds_read_b128 v[64:67], v33 offset:2048
    v_pk_mul_f32 v[72:73], v[120:121], v[120:121]
    v_pk_mul_f32 v[74:75], v[122:123], v[122:123]
    v_pk_fma_f32 v[72:73], v[72:73], s[44:45], v[28:29] op_sel_hi:[1,0,0]
    v_pk_fma_f32 v[74:75], v[74:75], s[44:45], v[28:29] op_sel_hi:[1,0,0]
    v_pk_mul_f32 v[72:73], v[72:73], v[120:121]
    v_pk_mul_f32 v[74:75], v[74:75], v[122:123]
    v_exp_f32 v72, v72
    v_exp_f32 v73, v73
    v_exp_f32 v74, v74
    v_exp_f32 v75, v75
    v_pk_mul_f32 v[120:121], v[120:121], v[136:137]
    v_pk_mul_f32 v[122:123], v[122:123], v[138:139]
    v_pk_add_f32 v[72:73], v[72:73], 1.0 op_sel_hi:[1,0]
    v_pk_add_f32 v[74:75], v[74:75], 1.0 op_sel_hi:[1,0]
    v_rcp_f32 v72, v72
    v_rcp_f32 v73, v73
    v_rcp_f32 v74, v74
    v_rcp_f32 v75, v75
    v_pk_mul_f32 v[120:121], v[120:121], v[72:73]
    v_pk_mul_f32 v[122:123], v[122:123], v[74:75]
    v_pk_mul_f32 v[76:77], v[124:125], v[124:125]
    v_pk_mul_f32 v[78:79], v[126:127], v[126:127]
    v_pk_fma_f32 v[76:77], v[76:77], s[44:45], v[28:29] op_sel_hi:[1,0,0]
    v_pk_fma_f32 v[78:79], v[78:79], s[44:45], v[28:29] op_sel_hi:[1,0,0]
    v_pk_mul_f32 v[76:77], v[76:77], v[124:125]
    v_pk_mul_f32 v[78:79], v[78:79], v[126:127]
    v_exp_f32 v76, v76
    v_exp_f32 v77, v77
    v_exp_f32 v78, v78
    v_exp_f32 v79, v79
    v_pk_mul_f32 v[124:125], v[124:125], v[140:141]
    v_pk_mul_f32 v[126:127], v[126:127], v[142:143]
    v_pk_add_f32 v[76:77], v[76:77], 1.0 op_sel_hi:[1,0]
    v_pk_add_f32 v[78:79], v[78:79], 1.0 op_sel_hi:[1,0]
    v_rcp_f32 v76, v76
    v_rcp_f32 v77, v77
    v_rcp_f32 v78, v78
    v_rcp_f32 v79, v79
    v_pk_mul_f32 v[124:125], v[124:125], v[76:77]
    v_pk_mul_f32 v[126:127], v[126:127], v[78:79]
    v_cvt_pk_bf16_f32 v120, v120, v121
    v_cvt_pk_bf16_f32 v121, v122, v123
    v_cvt_pk_bf16_f32 v122, v124, v125
    v_cvt_pk_bf16_f32 v123, v126, v127
    v_pk_mul_f32 v[80:81], v[128:129], v[128:129]
    v_pk_mul_f32 v[82:83], v[130:131], v[130:131]
    v_permlane16_swap_b32 v120, v122
    v_permlane16_swap_b32 v121, v123
    buffer_store_dwordx4 v[120:123], v8, s[32:35], s38 offen sc1
    v_pk_fma_f32 v[80:81], v[80:81], s[44:45], v[28:29] op_sel_hi:[1,0,0]
    v_pk_fma_f32 v[82:83], v[82:83], s[44:45], v[28:29] op_sel_hi:[1,0,0]
    v_pk_mul_f32 v[80:81], v[80:81], v[128:129]
    v_pk_mul_f32 v[82:83], v[82:83], v[130:131]
    v_exp_f32 v80, v80
    v_exp_f32 v81, v81
    v_exp_f32 v82, v82
    v_exp_f32 v83, v83
    v_pk_mul_f32 v[128:129], v[128:129], v[144:145]
    v_pk_mul_f32 v[130:131], v[130:131], v[146:147]
    v_pk_add_f32 v[80:81], v[80:81], 1.0 op_sel_hi:[1,0]
    v_pk_add_f32 v[82:83], v[82:83], 1.0 op_sel_hi:[1,0]
    v_rcp_f32 v80, v80
    v_rcp_f32 v81, v81
    v_rcp_f32 v82, v82
    v_rcp_f32 v83, v83
    v_pk_mul_f32 v[128:129], v[128:129], v[80:81]
    v_pk_mul_f32 v[130:131], v[130:131], v[82:83]
    v_pk_mul_f32 v[84:85], v[132:133], v[132:133]
    v_pk_mul_f32 v[86:87], v[134:135], v[134:135]
    v_pk_fma_f32 v[84:85], v[84:85], s[44:45], v[28:29] op_sel_hi:[1,0,0]
    v_pk_fma_f32 v[86:87], v[86:87], s[44:45], v[28:29] op_sel_hi:[1,0,0]
    v_pk_mul_f32 v[84:85], v[84:85], v[132:133]
    v_pk_mul_f32 v[86:87], v[86:87], v[134:135]
    v_exp_f32 v84, v84
    v_exp_f32 v85, v85
    v_exp_f32 v86, v86
    v_exp_f32 v87, v87
    v_pk_mul_f32 v[132:133], v[132:133], v[148:149]
    v_pk_mul_f32 v[134:135], v[134:135], v[150:151]
    v_pk_add_f32 v[84:85], v[84:85], 1.0 op_sel_hi:[1,0]
    v_pk_add_f32 v[86:87], v[86:87], 1.0 op_sel_hi:[1,0]
    v_rcp_f32 v84, v84
    v_rcp_f32 v85, v85
    v_rcp_f32 v86, v86
    v_rcp_f32 v87, v87
    v_pk_mul_f32 v[132:133], v[132:133], v[84:85]
    v_pk_mul_f32 v[134:135], v[134:135], v[86:87]
    v_cvt_pk_bf16_f32 v128, v128, v129
    v_cvt_pk_bf16_f32 v129, v130, v131
    v_cvt_pk_bf16_f32 v130, v132, v133
    v_cvt_pk_bf16_f32 v131, v134, v135
    s_nop 0
    v_permlane16_swap_b32 v128, v130
    v_permlane16_swap_b32 v129, v131
    buffer_store_dwordx4 v[128:131], v35, s[32:35], s38 offen sc1
    s_branch L_k1_j
L_k1_odd:
    s_waitcnt lgkmcnt(0)
    v_mfma_f32_16x16x32_bf16 v[88:91], v[36:39], v[40:43], v[88:91]
    s_barrier
    ds_read_b64_tr_b16 v[48:49], v31 offset:40960
    ds_read_b64_tr_b16 v[50:51], v31 offset:41472
    v_mfma_f32_16x16x32_bf16 v[92:95], v[36:39], v[56:59], v[92:95]
    ds_read_b128 v[52:55], v33 offset:32768
    ds_read_b128 v[68:71], v33 offset:34816
    v_mfma_f32_16x16x32_bf16 v[96:99], v[36:39], v[44:47], v[96:99]
    s_cmp_eq_u32 s41, 0
    s_cbranch_scc1 L_k1_vo2
    v_mul_f32 v120, s41, v120
    v_mul_f32 v121, s41, v121
    v_mul_f32 v122, s41, v122
    v_mul_f32 v123, s41, v123
    v_mul_f32 v124, s41, v124
    v_mul_f32 v125, s41, v125
    v_mul_f32 v126, s41, v126
    v_mul_f32 v127, s41, v127
    v_mul_f32 v128, s41, v128
    v_mul_f32 v129, s41, v129
    v_mul_f32 v130, s41, v130
    v_mul_f32 v131, s41, v131
    v_mul_f32 v132, s41, v132
    v_mul_f32 v133, s41, v133
    v_mul_f32 v134, s41, v134
    v_mul_f32 v135, s41, v135
    v_cvt_pk_bf16_f32 v120, v120, v121
    v_cvt_pk_bf16_f32 v121, v122, v123
    v_cvt_pk_bf16_f32 v122, v124, v125
    v_cvt_pk_bf16_f32 v123, v126, v127
    v_cvt_pk_bf16_f32 v128, v128, v129
    v_cvt_pk_bf16_f32 v129, v130, v131
    v_cvt_pk_bf16_f32 v130, v132, v133
    v_cvt_pk_bf16_f32 v131, v134, v135
    v_permlane16_swap_b32 v120, v122
    v_permlane16_swap_b32 v121, v123
    v_and_b32 v120, s45, v120
    v_and_b32 v122, s45, v122
    buffer_store_dwordx4 v[120:123], v8, s[32:35], s38 offen sc1
    v_permlane16_swap_b32 v128, v130
    v_permlane16_swap_b32 v129, v131
    v_and_b32 v128, s45, v128
    v_and_b32 v130, s45, v130
    buffer_store_dwordx4 v[128:131], v34, s[32:35], s38 offen sc1
    s_branch L_k1_wo2
L_k1_vo2:
    s_add_u32 s41, s38, 22986752
    v_cvt_pk_f16_f32 v72, v120, v121
    v_cvt_pk_f16_f32 v73, v122, v123
    v_cvt_pk_f16_f32 v74, v124, v125
    v_cvt_pk_f16_f32 v75, v126, v127
    v_cvt_pk_f16_f32 v76, v128, v129
    v_cvt_pk_f16_f32 v77, v130, v131
    v_cvt_pk_f16_f32 v78, v132, v133
    v_cvt_pk_f16_f32 v79, v134, v135
    v_permlane16_swap_b32 v72, v74
    v_permlane16_swap_b32 v73, v75
    buffer_store_dwordx4 v[72:75], v8, s[32:35], s38 offen sc1
    v_permlane16_swap_b32 v76, v78
    v_permlane16_swap_b32 v77, v79
    buffer_store_dwordx4 v[76:79], v34, s[32:35], s38 offen sc1
    v_minimum3_f32 v2, |v120|, |v121|, |v121|
    v_maximum3_f32 v3, |v120|, |v121|, |v121|
    v_minimum3_f32 v2, |v122|, |v123|, v2
    v_maximum3_f32 v3, |v122|, |v123|, v3
    v_minimum3_f32 v2, |v124|, |v125|, v2
    v_maximum3_f32 v3, |v124|, |v125|, v3
    v_minimum3_f32 v2, |v126|, |v127|, v2
    v_maximum3_f32 v3, |v126|, |v127|, v3
    v_minimum3_f32 v2, |v128|, |v129|, v2
    v_maximum3_f32 v3, |v128|, |v129|, v3
    v_minimum3_f32 v2, |v130|, |v131|, v2
    v_maximum3_f32 v3, |v130|, |v131|, v3
    v_minimum3_f32 v2, |v132|, |v133|, v2
    v_maximum3_f32 v3, |v132|, |v133|, v3
    v_minimum3_f32 v2, |v134|, |v135|, v2
    v_maximum3_f32 v3, |v134|, |v135|, v3
    v_cmp_nge_f32 vcc, v2, s48
    v_cmp_nle_f32 s[50:51], v3, s49
    s_nop 0
    s_or_b64 vcc, vcc, s[50:51]
    s_cbranch_scc0 L_k1_wo2
    v_cvt_pk_bf16_f32 v120, v120, v121
    v_cvt_pk_bf16_f32 v121, v122, v123
    v_cvt_pk_bf16_f32 v122, v124, v125
    v_cvt_pk_bf16_f32 v123, v126, v127
    v_cvt_pk_bf16_f32 v124, v128, v129
    v_cvt_pk_bf16_f32 v125, v130, v131
    v_cvt_pk_bf16_f32 v126, v132, v133
    v_cvt_pk_bf16_f32 v127, v134, v135
    v_permlane16_swap_b32 v120, v122
    v_permlane16_swap_b32 v121, v123
    buffer_store_dwordx4 v[120:123], v8, s[32:35], s41 offen sc1
    v_permlane16_swap_b32 v124, v126
    v_permlane16_swap_b32 v125, v127
    buffer_store_dwordx4 v[124:127], v34, s[32:35], s41 offen sc1
L_k1_wo2:
    v_mfma_f32_16x16x32_bf16 v[100:103], v[36:39], v[60:63], v[100:103]
    v_mfma_f32_16x16x32_bf16 v[104:107], v[64:67], v[40:43], v[104:107]
    ds_read_b128 v[36:39], v33 offset:36864
    v_mfma_f32_16x16x32_bf16 v[108:111], v[64:67], v[56:59], v[108:111]
    ds_read_b128 v[40:43], v33 offset:38912
    v_mfma_f32_16x16x32_bf16 v[112:115], v[64:67], v[44:47], v[112:115]
    ds_read_b64_tr_b16 v[56:57], v31 offset:28672
    ds_read_b64_tr_b16 v[58:59], v31 offset:29184
    s_cmp_eq_u32 s42, 0
    s_cbranch_scc1 L_k1_vo6
    v_mul_f32 v136, s42, v136
    v_mul_f32 v137, s42, v137
    v_mul_f32 v138, s42, v138
    v_mul_f32 v139, s42, v139
    v_mul_f32 v140, s42, v140
    v_mul_f32 v141, s42, v141
    v_mul_f32 v142, s42, v142
    v_mul_f32 v143, s42, v143
    v_mul_f32 v144, s42, v144
    v_mul_f32 v145, s42, v145
    v_mul_f32 v146, s42, v146
    v_mul_f32 v147, s42, v147
    v_mul_f32 v148, s42, v148
    v_mul_f32 v149, s42, v149
    v_mul_f32 v150, s42, v150
    v_mul_f32 v151, s42, v151
    v_cvt_pk_bf16_f32 v136, v136, v137
    v_cvt_pk_bf16_f32 v137, v138, v139
    v_cvt_pk_bf16_f32 v138, v140, v141
    v_cvt_pk_bf16_f32 v139, v142, v143
    v_cvt_pk_bf16_f32 v144, v144, v145
    v_cvt_pk_bf16_f32 v145, v146, v147
    v_cvt_pk_bf16_f32 v146, v148, v149
    v_cvt_pk_bf16_f32 v147, v150, v151
    v_permlane16_swap_b32 v136, v138
    v_permlane16_swap_b32 v137, v139
    v_and_b32 v136, s46, v136
    v_and_b32 v138, s46, v138
    buffer_store_dwordx4 v[136:139], v8, s[32:35], s39 offen sc1
    v_permlane16_swap_b32 v144, v146
    v_permlane16_swap_b32 v145, v147
    v_and_b32 v144, s46, v144
    v_and_b32 v146, s46, v146
    buffer_store_dwordx4 v[144:147], v34, s[32:35], s39 offen sc1
    s_branch L_k1_wo6
L_k1_vo6:
    s_add_u32 s42, s39, 22986752
    v_cvt_pk_f16_f32 v80, v136, v137
    v_cvt_pk_f16_f32 v81, v138, v139
    v_cvt_pk_f16_f32 v82, v140, v141
    v_cvt_pk_f16_f32 v83, v142, v143
    v_cvt_pk_f16_f32 v84, v144, v145
    v_cvt_pk_f16_f32 v85, v146, v147
    v_cvt_pk_f16_f32 v86, v148, v149
    v_cvt_pk_f16_f32 v87, v150, v151
    v_permlane16_swap_b32 v80, v82
    v_permlane16_swap_b32 v81, v83
    buffer_store_dwordx4 v[80:83], v8, s[32:35], s39 offen sc1
    v_permlane16_swap_b32 v84, v86
    v_permlane16_swap_b32 v85, v87
    buffer_store_dwordx4 v[84:87], v34, s[32:35], s39 offen sc1
    v_minimum3_f32 v2, |v136|, |v137|, |v137|
    v_maximum3_f32 v3, |v136|, |v137|, |v137|
    v_minimum3_f32 v2, |v138|, |v139|, v2
    v_maximum3_f32 v3, |v138|, |v139|, v3
    v_minimum3_f32 v2, |v140|, |v141|, v2
    v_maximum3_f32 v3, |v140|, |v141|, v3
    v_minimum3_f32 v2, |v142|, |v143|, v2
    v_maximum3_f32 v3, |v142|, |v143|, v3
    v_minimum3_f32 v2, |v144|, |v145|, v2
    v_maximum3_f32 v3, |v144|, |v145|, v3
    v_minimum3_f32 v2, |v146|, |v147|, v2
    v_maximum3_f32 v3, |v146|, |v147|, v3
    v_minimum3_f32 v2, |v148|, |v149|, v2
    v_maximum3_f32 v3, |v148|, |v149|, v3
    v_minimum3_f32 v2, |v150|, |v151|, v2
    v_maximum3_f32 v3, |v150|, |v151|, v3
    v_cmp_nge_f32 vcc, v2, s48
    v_cmp_nle_f32 s[50:51], v3, s49
    s_nop 0
    s_or_b64 vcc, vcc, s[50:51]
    s_cbranch_scc0 L_k1_wo6
    v_cvt_pk_bf16_f32 v136, v136, v137
    v_cvt_pk_bf16_f32 v137, v138, v139
    v_cvt_pk_bf16_f32 v138, v140, v141
    v_cvt_pk_bf16_f32 v139, v142, v143
    v_cvt_pk_bf16_f32 v140, v144, v145
    v_cvt_pk_bf16_f32 v141, v146, v147
    v_cvt_pk_bf16_f32 v142, v148, v149
    v_cvt_pk_bf16_f32 v143, v150, v151
    v_permlane16_swap_b32 v136, v138
    v_permlane16_swap_b32 v137, v139
    buffer_store_dwordx4 v[136:139], v8, s[32:35], s42 offen sc1
    v_permlane16_swap_b32 v140, v142
    v_permlane16_swap_b32 v141, v143
    buffer_store_dwordx4 v[140:143], v34, s[32:35], s42 offen sc1
L_k1_wo6:
    v_mfma_f32_16x16x32_bf16 v[116:119], v[64:67], v[60:63], v[116:119]
    s_waitcnt lgkmcnt(4)
    v_mfma_f32_16x16x32_bf16 v[88:91], v[48:51], v[52:55], v[88:91]
    s_barrier
    ds_read_b64_tr_b16 v[44:45], v30 offset:45056
    ds_read_b64_tr_b16 v[46:47], v30 offset:45568
    v_mfma_f32_16x16x32_bf16 v[92:95], v[48:51], v[68:71], v[92:95]
    ds_read_b128 v[60:63], v32 offset:16384
    ds_read_b128 v[64:67], v32 offset:18432
    s_waitcnt lgkmcnt(7)
    v_mfma_f32_16x16x32_bf16 v[96:99], v[48:51], v[36:39], v[96:99]
    s_cmp_eq_u32 s43, 0
    s_cbranch_scc1 L_k1_vo10
    v_mul_f32 v152, s43, v152
    v_mul_f32 v153, s43, v153
    v_mul_f32 v154, s43, v154
    v_mul_f32 v155, s43, v155
    v_mul_f32 v156, s43, v156
    v_mul_f32 v157, s43, v157
    v_mul_f32 v158, s43, v158
    v_mul_f32 v159, s43, v159
    v_mul_f32 v160, s43, v160
    v_mul_f32 v161, s43, v161
    v_mul_f32 v162, s43, v162
    v_mul_f32 v163, s43, v163
    v_mul_f32 v164, s43, v164
    v_mul_f32 v165, s43, v165
    v_mul_f32 v166, s43, v166
    v_mul_f32 v167, s43, v167
    v_cvt_pk_bf16_f32 v152, v152, v153
    v_cvt_pk_bf16_f32 v153, v154, v155
    v_cvt_pk_bf16_f32 v154, v156, v157
    v_cvt_pk_bf16_f32 v155, v158, v159
    v_cvt_pk_bf16_f32 v160, v160, v161
    v_cvt_pk_bf16_f32 v161, v162, v163
    v_cvt_pk_bf16_f32 v162, v164, v165
    v_cvt_pk_bf16_f32 v163, v166, v167
    v_permlane16_swap_b32 v152, v154
    v_permlane16_swap_b32 v153, v155
    v_and_b32 v152, s47, v152
    v_and_b32 v154, s47, v154
    buffer_store_dwordx4 v[152:155], v8, s[32:35], s40 offen sc1
    v_permlane16_swap_b32 v160, v162
    v_permlane16_swap_b32 v161, v163
    v_and_b32 v160, s47, v160
    v_and_b32 v162, s47, v162
    buffer_store_dwordx4 v[160:163], v34, s[32:35], s40 offen sc1
    s_branch L_k1_wo10
L_k1_vo10:
    s_add_u32 s43, s40, 22986752
    v_cvt_pk_f16_f32 v72, v152, v153
    v_cvt_pk_f16_f32 v73, v154, v155
    v_cvt_pk_f16_f32 v74, v156, v157
    v_cvt_pk_f16_f32 v75, v158, v159
    v_cvt_pk_f16_f32 v76, v160, v161
    v_cvt_pk_f16_f32 v77, v162, v163
    v_cvt_pk_f16_f32 v78, v164, v165
    v_cvt_pk_f16_f32 v79, v166, v167
    v_permlane16_swap_b32 v72, v74
    v_permlane16_swap_b32 v73, v75
    buffer_store_dwordx4 v[72:75], v8, s[32:35], s40 offen sc1
    v_permlane16_swap_b32 v76, v78
    v_permlane16_swap_b32 v77, v79
    buffer_store_dwordx4 v[76:79], v34, s[32:35], s40 offen sc1
    v_minimum3_f32 v2, |v152|, |v153|, |v153|
    v_maximum3_f32 v3, |v152|, |v153|, |v153|
    v_minimum3_f32 v2, |v154|, |v155|, v2
    v_maximum3_f32 v3, |v154|, |v155|, v3
    v_minimum3_f32 v2, |v156|, |v157|, v2
    v_maximum3_f32 v3, |v156|, |v157|, v3
    v_minimum3_f32 v2, |v158|, |v159|, v2
    v_maximum3_f32 v3, |v158|, |v159|, v3
    v_minimum3_f32 v2, |v160|, |v161|, v2
    v_maximum3_f32 v3, |v160|, |v161|, v3
    v_minimum3_f32 v2, |v162|, |v163|, v2
    v_maximum3_f32 v3, |v162|, |v163|, v3
    v_minimum3_f32 v2, |v164|, |v165|, v2
    v_maximum3_f32 v3, |v164|, |v165|, v3
    v_minimum3_f32 v2, |v166|, |v167|, v2
    v_maximum3_f32 v3, |v166|, |v167|, v3
    v_cmp_nge_f32 vcc, v2, s48
    v_cmp_nle_f32 s[50:51], v3, s49
    s_nop 0
    s_or_b64 vcc, vcc, s[50:51]
    s_cbranch_scc0 L_k1_wo10
    v_cvt_pk_bf16_f32 v152, v152, v153
    v_cvt_pk_bf16_f32 v153, v154, v155
    v_cvt_pk_bf16_f32 v154, v156, v157
    v_cvt_pk_bf16_f32 v155, v158, v159
    v_cvt_pk_bf16_f32 v156, v160, v161
    v_cvt_pk_bf16_f32 v157, v162, v163
    v_cvt_pk_bf16_f32 v158, v164, v165
    v_cvt_pk_bf16_f32 v159, v166, v167
    v_permlane16_swap_b32 v152, v154
    v_permlane16_swap_b32 v153, v155
    buffer_store_dwordx4 v[152:155], v8, s[32:35], s43 offen sc1
    v_permlane16_swap_b32 v156, v158
    v_permlane16_swap_b32 v157, v159
    buffer_store_dwordx4 v[156:159], v34, s[32:35], s43 offen sc1
L_k1_wo10:
    s_waitcnt lgkmcnt(6)
    v_mfma_f32_16x16x32_bf16 v[100:103], v[48:51], v[40:43], v[100:103]
    s_waitcnt lgkmcnt(4)
    v_mfma_f32_16x16x32_bf16 v[104:107], v[56:59], v[52:55], v[104:107]
    ds_read_b128 v[48:51], v32 offset:20480
    v_mfma_f32_16x16x32_bf16 v[108:111], v[56:59], v[68:71], v[108:111]
    ds_read_b128 v[52:55], v32 offset:22528
    v_mfma_f32_16x16x32_bf16 v[112:115], v[56:59], v[36:39], v[112:115]
    ds_read_b64_tr_b16 v[68:69], v30 offset:40960
    ds_read_b64_tr_b16 v[70:71], v30 offset:41472
    v_mfma_f32_16x16x32_bf16 v[116:119], v[56:59], v[40:43], v[116:119]
    s_waitcnt lgkmcnt(4)
    v_mfma_f32_16x16x32_bf16 v[88:91], v[44:47], v[60:63], v[88:91]
    s_barrier
    ds_read_b64_tr_b16 v[36:37], v30 offset:36864
    ds_read_b64_tr_b16 v[38:39], v30 offset:37376
    v_mfma_f32_16x16x32_bf16 v[92:95], v[44:47], v[64:67], v[92:95]
    ds_read_b128 v[40:43], v33 offset:16384
    ds_read_b128 v[56:59], v33 offset:18432
    s_waitcnt lgkmcnt(7)
    v_mfma_f32_16x16x32_bf16 v[96:99], v[44:47], v[48:51], v[96:99]
    s_waitcnt lgkmcnt(6)
    v_mfma_f32_16x16x32_bf16 v[100:103], v[44:47], v[52:55], v[100:103]
    s_waitcnt lgkmcnt(4)
    v_mfma_f32_16x16x32_bf16 v[104:107], v[68:71], v[60:63], v[104:107]
    ds_read_b128 v[44:47], v33 offset:20480
    v_mfma_f32_16x16x32_bf16 v[108:111], v[68:71], v[64:67], v[108:111]
    ds_read_b128 v[60:63], v33 offset:22528
    v_mfma_f32_16x16x32_bf16 v[112:115], v[68:71], v[48:51], v[112:115]
    ds_read_b64_tr_b16 v[64:65], v30 offset:20480
    ds_read_b64_tr_b16 v[66:67], v30 offset:20992
    v_mfma_f32_16x16x32_bf16 v[116:119], v[68:71], v[52:55], v[116:119]
    s_waitcnt lgkmcnt(4)
    v_mfma_f32_16x16x32_bf16 v[88:91], v[36:39], v[40:43], v[88:91]
    s_barrier
    ds_read_b64_tr_b16 v[48:49], v31 offset:36864
    ds_read_b64_tr_b16 v[50:51], v31 offset:37376
    v_mfma_f32_16x16x32_bf16 v[92:95], v[36:39], v[56:59], v[92:95]
    ds_read_b128 v[52:55], v32 offset:0
    ds_read_b128 v[68:71], v32 offset:2048
    s_waitcnt lgkmcnt(7)
    v_mfma_f32_16x16x32_bf16 v[96:99], v[36:39], v[44:47], v[96:99]
    s_waitcnt lgkmcnt(6)
    v_mfma_f32_16x16x32_bf16 v[100:103], v[36:39], v[60:63], v[100:103]
    s_waitcnt lgkmcnt(4)
    v_mfma_f32_16x16x32_bf16 v[104:107], v[64:67], v[40:43], v[104:107]
    ds_read_b128 v[36:39], v32 offset:4096
    v_mfma_f32_16x16x32_bf16 v[108:111], v[64:67], v[56:59], v[108:111]
    ds_read_b128 v[40:43], v32 offset:6144
    v_mfma_f32_16x16x32_bf16 v[112:115], v[64:67], v[44:47], v[112:115]
    ds_read_b64_tr_b16 v[56:57], v30 offset:8192
    ds_read_b64_tr_b16 v[58:59], v30 offset:8704
    v_mfma_f32_16x16x32_bf16 v[116:119], v[64:67], v[60:63], v[116:119]
    s_waitcnt lgkmcnt(4)
    v_mfma_f32_16x16x32_bf16 v[88:91], v[48:51], v[52:55], v[88:91]
    s_waitcnt vmcnt(0)
    s_barrier
    ds_read_b64_tr_b16 v[44:45], v30 offset:4096
    ds_read_b64_tr_b16 v[46:47], v30 offset:4608
    v_mfma_f32_16x16x32_bf16 v[92:95], v[48:51], v[68:71], v[92:95]
    ds_read_b128 v[60:63], v33 offset:0
    ds_read_b128 v[64:67], v33 offset:2048
L_k1_j:
    s_waitcnt lgkmcnt(7)
    v_mfma_f32_16x16x32_bf16 v[96:99], v[48:51], v[36:39], v[96:99]
    s_waitcnt lgkmcnt(6)
    v_mfma_f32_16x16x32_bf16 v[100:103], v[48:51], v[40:43], v[100:103]
    s_waitcnt lgkmcnt(4)
    v_mfma_f32_16x16x32_bf16 v[104:107], v[56:59], v[52:55], v[104:107]
    ds_read_b128 v[48:51], v33 offset:4096
    v_mfma_f32_16x16x32_bf16 v[108:111], v[56:59], v[68:71], v[108:111]
    ds_read_b128 v[52:55], v33 offset:6144
    v_mfma_f32_16x16x32_bf16 v[112:115], v[56:59], v[36:39], v[112:115]
    ds_read_b64_tr_b16 v[68:69], v31 offset:24576
    ds_read_b64_tr_b16 v[70:71], v31 offset:25088
    v_mfma_f32_16x16x32_bf16 v[116:119], v[56:59], v[40:43], v[116:119]
    s_waitcnt lgkmcnt(4)
    v_mfma_f32_16x16x32_bf16 v[88:91], v[44:47], v[60:63], v[88:91]
    s_barrier
    ds_read_b64_tr_b16 v[36:37], v31 offset:20480
    ds_read_b64_tr_b16 v[38:39], v31 offset:20992
    v_mfma_f32_16x16x32_bf16 v[92:95], v[44:47], v[64:67], v[92:95]
    ds_read_b128 v[40:43], v32 offset:49152
    ds_read_b128 v[56:59], v32 offset:51200
    s_waitcnt lgkmcnt(7)
    v_mfma_f32_16x16x32_bf16 v[96:99], v[44:47], v[48:51], v[96:99]
    s_waitcnt lgkmcnt(6)
    v_mfma_f32_16x16x32_bf16 v[100:103], v[44:47], v[52:55], v[100:103]
    s_waitcnt lgkmcnt(4)
    v_mfma_f32_16x16x32_bf16 v[104:107], v[68:71], v[60:63], v[104:107]
    ds_read_b128 v[44:47], v32 offset:53248
    v_mfma_f32_16x16x32_bf16 v[108:111], v[68:71], v[64:67], v[108:111]
    ds_read_b128 v[60:63], v32 offset:55296
    v_mfma_f32_16x16x32_bf16 v[112:115], v[68:71], v[48:51], v[112:115]
    ds_read_b64_tr_b16 v[64:65], v30 offset:49152
    ds_read_b64_tr_b16 v[66:67], v30 offset:49664
    v_mfma_f32_16x16x32_bf16 v[116:119], v[68:71], v[52:55], v[116:119]
    s_waitcnt lgkmcnt(4)
    v_mfma_f32_16x16x32_bf16 v[88:91], v[36:39], v[40:43], v[88:91]
    s_barrier
    ds_read_b64_tr_b16 v[48:49], v30 offset:32768
    ds_read_b64_tr_b16 v[50:51], v30 offset:33280
    v_mfma_f32_16x16x32_bf16 v[92:95], v[36:39], v[56:59], v[92:95]
    ds_read_b128 v[52:55], v33 offset:49152
    ds_read_b128 v[68:71], v33 offset:51200
    s_waitcnt lgkmcnt(7)
    v_mfma_f32_16x16x32_bf16 v[96:99], v[36:39], v[44:47], v[96:99]
    s_waitcnt lgkmcnt(6)
    v_mfma_f32_16x16x32_bf16 v[100:103], v[36:39], v[60:63], v[100:103]
    s_waitcnt lgkmcnt(4)
    v_mfma_f32_16x16x32_bf16 v[104:107], v[64:67], v[40:43], v[104:107]
    ds_read_b128 v[36:39], v33 offset:53248
    v_mfma_f32_16x16x32_bf16 v[108:111], v[64:67], v[56:59], v[108:111]
    ds_read_b128 v[40:43], v33 offset:55296
    v_mfma_f32_16x16x32_bf16 v[112:115], v[64:67], v[44:47], v[112:115]
    ds_read_b64_tr_b16 v[56:57], v30 offset:28672
    ds_read_b64_tr_b16 v[58:59], v30 offset:29184
    v_mfma_f32_16x16x32_bf16 v[116:119], v[64:67], v[60:63], v[116:119]
    s_waitcnt lgkmcnt(4)
    v_mfma_f32_16x16x32_bf16 v[88:91], v[48:51], v[52:55], v[88:91]
    s_barrier
    ds_read_b64_tr_b16 v[44:45], v30 offset:24576
    ds_read_b64_tr_b16 v[46:47], v30 offset:25088
    v_mfma_f32_16x16x32_bf16 v[92:95], v[48:51], v[68:71], v[92:95]
    ds_read_b128 v[60:63], v32 offset:32768
    ds_read_b128 v[64:67], v32 offset:34816
    s_waitcnt lgkmcnt(7)
    v_mfma_f32_16x16x32_bf16 v[96:99], v[48:51], v[36:39], v[96:99]
    s_waitcnt lgkmcnt(6)
    v_mfma_f32_16x16x32_bf16 v[100:103], v[48:51], v[40:43], v[100:103]
    s_waitcnt lgkmcnt(4)
    v_mfma_f32_16x16x32_bf16 v[104:107], v[56:59], v[52:55], v[104:107]
    ds_read_b128 v[48:51], v32 offset:36864
    v_mfma_f32_16x16x32_bf16 v[108:111], v[56:59], v[68:71], v[108:111]
    ds_read_b128 v[52:55], v32 offset:38912
    v_mfma_f32_16x16x32_bf16 v[112:115], v[56:59], v[36:39], v[112:115]
    ds_read_b64_tr_b16 v[68:69], v30 offset:16384
    ds_read_b64_tr_b16 v[70:71], v30 offset:16896
    v_mfma_f32_16x16x32_bf16 v[116:119], v[56:59], v[40:43], v[116:119]
    s_waitcnt lgkmcnt(4)
    v_mfma_f32_16x16x32_bf16 v[88:91], v[44:47], v[60:63], v[88:91]
    s_barrier
    ds_read_b64_tr_b16 v[36:37], v31 offset:32768
    ds_read_b64_tr_b16 v[38:39], v31 offset:33280
    v_mfma_f32_16x16x32_bf16 v[92:95], v[44:47], v[64:67], v[92:95]
    ds_read_b128 v[40:43], v33 offset:32768
    ds_read_b128 v[56:59], v33 offset:34816
    s_waitcnt lgkmcnt(7)
    v_mfma_f32_16x16x32_bf16 v[96:99], v[44:47], v[48:51], v[96:99]
    s_waitcnt lgkmcnt(6)
    v_mfma_f32_16x16x32_bf16 v[100:103], v[44:47], v[52:55], v[100:103]
    s_waitcnt lgkmcnt(4)
    v_mfma_f32_16x16x32_bf16 v[104:107], v[68:71], v[60:63], v[104:107]
    ds_read_b128 v[44:47], v33 offset:36864
    v_mfma_f32_16x16x32_bf16 v[108:111], v[68:71], v[64:67], v[108:111]
    ds_read_b128 v[60:63], v33 offset:38912
    v_mfma_f32_16x16x32_bf16 v[112:115], v[68:71], v[48:51], v[112:115]
    ds_read_b64_tr_b16 v[64:65], v31 offset:28672
    ds_read_b64_tr_b16 v[66:67], v31 offset:29184
    v_mfma_f32_16x16x32_bf16 v[116:119], v[68:71], v[52:55], v[116:119]
    s_waitcnt lgkmcnt(4)
    v_mfma_f32_16x16x32_bf16 v[88:91], v[36:39], v[40:43], v[88:91]
    s_barrier
    ds_read_b64_tr_b16 v[48:49], v30 offset:45056
    ds_read_b64_tr_b16 v[50:51], v30 offset:45568
    v_mfma_f32_16x16x32_bf16 v[92:95], v[36:39], v[56:59], v[92:95]
    ds_read_b128 v[52:55], v32 offset:16384
    ds_read_b128 v[68:71], v32 offset:18432
    s_waitcnt lgkmcnt(7)
    v_mfma_f32_16x16x32_bf16 v[96:99], v[36:39], v[44:47], v[96:99]
    s_waitcnt lgkmcnt(6)
    v_mfma_f32_16x16x32_bf16 v[100:103], v[36:39], v[60:63], v[100:103]
    s_waitcnt lgkmcnt(4)
    v_mfma_f32_16x16x32_bf16 v[104:107], v[64:67], v[40:43], v[104:107]
    ds_read_b128 v[36:39], v32 offset:20480
    v_mfma_f32_16x16x32_bf16 v[108:111], v[64:67], v[56:59], v[108:111]
    ds_read_b128 v[40:43], v32 offset:22528
    v_mfma_f32_16x16x32_bf16 v[112:115], v[64:67], v[44:47], v[112:115]
    ds_read_b64_tr_b16 v[56:57], v30 offset:40960
    ds_read_b64_tr_b16 v[58:59], v30 offset:41472
    v_mfma_f32_16x16x32_bf16 v[116:119], v[64:67], v[60:63], v[116:119]
    ds_read_b64_tr_b16 v[44:45], v30 offset:36864
    ds_read_b64_tr_b16 v[46:47], v30 offset:37376
    s_waitcnt lgkmcnt(6)
    v_mfma_f32_16x16x32_bf16 v[88:91], v[48:51], v[52:55], v[88:91]
    ds_read_b128 v[60:63], v33 offset:16384
    ds_read_b128 v[64:67], v33 offset:18432
    v_mfma_f32_16x16x32_bf16 v[92:95], v[48:51], v[68:71], v[92:95]
    s_waitcnt lgkmcnt(7)
    v_mfma_f32_16x16x32_bf16 v[96:99], v[48:51], v[36:39], v[96:99]
    s_waitcnt lgkmcnt(6)
    v_mfma_f32_16x16x32_bf16 v[100:103], v[48:51], v[40:43], v[100:103]
    s_waitcnt lgkmcnt(4)
    v_mfma_f32_16x16x32_bf16 v[104:107], v[56:59], v[52:55], v[104:107]
    ds_read_b128 v[48:51], v33 offset:20480
    v_mfma_f32_16x16x32_bf16 v[108:111], v[56:59], v[68:71], v[108:111]
    ds_read_b128 v[52:55], v33 offset:22528
    v_mfma_f32_16x16x32_bf16 v[112:115], v[56:59], v[36:39], v[112:115]
    ds_read_b64_tr_b16 v[68:69], v30 offset:20480
    ds_read_b64_tr_b16 v[70:71], v30 offset:20992
    v_mfma_f32_16x16x32_bf16 v[116:119], v[56:59], v[40:43], v[116:119]
    s_waitcnt lgkmcnt(4)
    v_mfma_f32_16x16x32_bf16 v[88:91], v[44:47], v[60:63], v[88:91]
    v_mfma_f32_16x16x32_bf16 v[92:95], v[44:47], v[64:67], v[92:95]
    s_waitcnt lgkmcnt(3)
    v_mfma_f32_16x16x32_bf16 v[96:99], v[44:47], v[48:51], v[96:99]
    s_waitcnt lgkmcnt(2)
    v_mfma_f32_16x16x32_bf16 v[100:103], v[44:47], v[52:55], v[100:103]
    s_waitcnt lgkmcnt(0)
    v_mfma_f32_16x16x32_bf16 v[104:107], v[68:71], v[60:63], v[104:107]
    v_mfma_f32_16x16x32_bf16 v[108:111], v[68:71], v[64:67], v[108:111]
    v_mfma_f32_16x16x32_bf16 v[112:115], v[68:71], v[48:51], v[112:115]
    v_mfma_f32_16x16x32_bf16 v[116:119], v[68:71], v[52:55], v[116:119]
    v_pk_mul_f32 v[72:73], v[88:89], v[88:89]
    v_pk_mul_f32 v[74:75], v[90:91], v[90:91]
    v_pk_fma_f32 v[72:73], v[72:73], s[44:45], v[28:29] op_sel_hi:[1,0,0]
    v_pk_fma_f32 v[74:75], v[74:75], s[44:45], v[28:29] op_sel_hi:[1,0,0]
    v_pk_mul_f32 v[72:73], v[72:73], v[88:89]
    v_pk_mul_f32 v[74:75], v[74:75], v[90:91]
    v_exp_f32 v72, v72
    v_exp_f32 v73, v73
    v_exp_f32 v74, v74
    v_exp_f32 v75, v75
    v_pk_mul_f32 v[88:89], v[88:89], v[104:105]
    v_pk_mul_f32 v[90:91], v[90:91], v[106:107]
    v_pk_add_f32 v[72:73], v[72:73], 1.0 op_sel_hi:[1,0]
    v_pk_add_f32 v[74:75], v[74:75], 1.0 op_sel_hi:[1,0]
    v_rcp_f32 v72, v72
    v_rcp_f32 v73, v73
    v_rcp_f32 v74, v74
    v_rcp_f32 v75, v75
    v_pk_mul_f32 v[88:89], v[88:89], v[72:73]
    v_pk_mul_f32 v[90:91], v[90:91], v[74:75]
    v_pk_mul_f32 v[76:77], v[92:93], v[92:93]
    v_pk_mul_f32 v[78:79], v[94:95], v[94:95]
    v_pk_fma_f32 v[76:77], v[76:77], s[44:45], v[28:29] op_sel_hi:[1,0,0]
    v_pk_fma_f32 v[78:79], v[78:79], s[44:45], v[28:29] op_sel_hi:[1,0,0]
    v_pk_mul_f32 v[76:77], v[76:77], v[92:93]
    v_pk_mul_f32 v[78:79], v[78:79], v[94:95]
    v_exp_f32 v76, v76
    v_exp_f32 v77, v77
    v_exp_f32 v78, v78
    v_exp_f32 v79, v79
    v_pk_mul_f32 v[92:93], v[92:93], v[108:109]
    v_pk_mul_f32 v[94:95], v[94:95], v[110:111]
    v_pk_add_f32 v[76:77], v[76:77], 1.0 op_sel_hi:[1,0]
    v_pk_add_f32 v[78:79], v[78:79], 1.0 op_sel_hi:[1,0]
    v_rcp_f32 v76, v76
    v_rcp_f32 v77, v77
    v_rcp_f32 v78, v78
    v_rcp_f32 v79, v79
    v_pk_mul_f32 v[92:93], v[92:93], v[76:77]
    v_pk_mul_f32 v[94:95], v[94:95], v[78:79]
    v_cvt_pk_bf16_f32 v88, v88, v89
    v_cvt_pk_bf16_f32 v89, v90, v91
    v_cvt_pk_bf16_f32 v90, v92, v93
    v_cvt_pk_bf16_f32 v91, v94, v95
    v_pk_mul_f32 v[80:81], v[96:97], v[96:97]
    v_pk_mul_f32 v[82:83], v[98:99], v[98:99]
    v_permlane16_swap_b32 v88, v90
    v_permlane16_swap_b32 v89, v91
    buffer_store_dwordx4 v[88:91], v8, s[32:35], s36 offen sc1
    v_pk_fma_f32 v[80:81], v[80:81], s[44:45], v[28:29] op_sel_hi:[1,0,0]
    v_pk_fma_f32 v[82:83], v[82:83], s[44:45], v[28:29] op_sel_hi:[1,0,0]
    v_pk_mul_f32 v[80:81], v[80:81], v[96:97]
    v_pk_mul_f32 v[82:83], v[82:83], v[98:99]
    v_exp_f32 v80, v80
    v_exp_f32 v81, v81
    v_exp_f32 v82, v82
    v_exp_f32 v83, v83
    v_pk_mul_f32 v[96:97], v[96:97], v[112:113]
    v_pk_mul_f32 v[98:99], v[98:99], v[114:115]
    v_pk_add_f32 v[80:81], v[80:81], 1.0 op_sel_hi:[1,0]
    v_pk_add_f32 v[82:83], v[82:83], 1.0 op_sel_hi:[1,0]
    v_rcp_f32 v80, v80
    v_rcp_f32 v81, v81
    v_rcp_f32 v82, v82
    v_rcp_f32 v83, v83
    v_pk_mul_f32 v[96:97], v[96:97], v[80:81]
    v_pk_mul_f32 v[98:99], v[98:99], v[82:83]
    v_pk_mul_f32 v[84:85], v[100:101], v[100:101]
    v_pk_mul_f32 v[86:87], v[102:103], v[102:103]
    v_pk_fma_f32 v[84:85], v[84:85], s[44:45], v[28:29] op_sel_hi:[1,0,0]
    v_pk_fma_f32 v[86:87], v[86:87], s[44:45], v[28:29] op_sel_hi:[1,0,0]
    v_pk_mul_f32 v[84:85], v[84:85], v[100:101]
    v_pk_mul_f32 v[86:87], v[86:87], v[102:103]
    v_exp_f32 v84, v84
    v_exp_f32 v85, v85
    v_exp_f32 v86, v86
    v_exp_f32 v87, v87
    v_pk_mul_f32 v[100:101], v[100:101], v[116:117]
    v_pk_mul_f32 v[102:103], v[102:103], v[118:119]
    v_pk_add_f32 v[84:85], v[84:85], 1.0 op_sel_hi:[1,0]
    v_pk_add_f32 v[86:87], v[86:87], 1.0 op_sel_hi:[1,0]
    v_rcp_f32 v84, v84
    v_rcp_f32 v85, v85
    v_rcp_f32 v86, v86
    v_rcp_f32 v87, v87
    v_pk_mul_f32 v[100:101], v[100:101], v[84:85]
    v_pk_mul_f32 v[102:103], v[102:103], v[86:87]
    v_cvt_pk_bf16_f32 v96, v96, v97
    v_cvt_pk_bf16_f32 v97, v98, v99
    v_cvt_pk_bf16_f32 v98, v100, v101
    v_cvt_pk_bf16_f32 v99, v102, v103
    s_nop 0
    v_permlane16_swap_b32 v96, v98
    v_permlane16_swap_b32 v97, v99
    buffer_store_dwordx4 v[96:99], v35, s[32:35], s36 offen sc1
    s_setprio 3
    s_barrier
    ds_read_b128 v[32:35], v22
    ds_read_b64 v[40:41], v23
    ds_read_b128 v[44:47], v9 offset:25088
    ds_read_b64 v[48:49], v10 offset:25088
    ds_read_b128 v[36:39], v24
    ds_read_b64 v[42:43], v25
    s_waitcnt lgkmcnt(2)
    v_mfma_f32_32x32x16_bf16 v[136:151], v[44:47], v[32:35], 0
    v_mfma_f32_32x32x8_bf16 v[136:151], v[48:49], v[40:41], v[136:151]
    s_waitcnt lgkmcnt(0)
    s_nop 10
    v_cvt_pknorm_u16_f32 v136, v136, v137
    v_cvt_pknorm_u16_f32 v138, v138, v139
    v_pk_add_u16 v137, v136, s8 clamp
    v_cvt_pknorm_u16_f32 v140, v140, v141
    v_pk_add_u16 v139, v138, s8 clamp
    ds_read_b64_tr_b16 v[52:53], v11 offset:25088
    ds_read_b64_tr_b16 v[54:55], v12 offset:25088
    ds_read_b64_tr_b16 v[56:57], v13 offset:25088
    ds_read_b64_tr_b16 v[58:59], v14 offset:25088
    v_pk_fma_f16 v120, v137, s9, v136
    v_cvt_pknorm_u16_f32 v142, v142, v143
    v_pk_add_u16 v141, v140, s8 clamp
    v_pk_fma_f16 v121, v139, s9, v138
    v_mfma_f32_32x32x16_bf16 v[152:167], v[44:47], v[36:39], 0
    v_cvt_pknorm_u16_f32 v144, v144, v145
    v_pk_add_u16 v143, v142, s8 clamp
    v_pk_fma_f16 v122, v141, s9, v140
    v_cvt_pknorm_u16_f32 v146, v146, v147
    v_mfma_f32_32x32x8_bf16 v[152:167], v[48:49], v[42:43], v[152:167]
    ds_read_b128 v[44:47], v9 offset:28224
    ds_read_b64 v[48:49], v10 offset:28224
    v_pk_add_u16 v145, v144, s8 clamp
    s_setprio 2
    v_pk_fma_f16 v123, v143, s9, v142
    v_cvt_pknorm_u16_f32 v148, v148, v149
    v_pk_add_u16 v147, v146, s8 clamp
    v_pk_fma_f16 v124, v145, s9, v144
    v_cvt_pknorm_u16_f32 v150, v150, v151
    v_pk_add_u16 v149, v148, s8 clamp
    v_pk_fma_f16 v125, v147, s9, v146
    v_pk_add_u16 v151, v150, s8 clamp
    v_pk_fma_f16 v126, v149, s9, v148
    v_pk_fma_f16 v127, v151, s9, v150
    s_waitcnt lgkmcnt(4)
    v_mfma_f32_32x32x16_f16 v[64:79], v[52:55], v[120:123], 0
    v_cvt_pknorm_u16_f32 v152, v152, v153
    v_cvt_pknorm_u16_f32 v154, v154, v155
    v_pk_add_u16 v153, v152, s8 clamp
    v_cvt_pknorm_u16_f32 v156, v156, v157
    v_pk_add_u16 v155, v154, s8 clamp
    s_waitcnt lgkmcnt(2)
    v_mfma_f32_32x32x16_f16 v[64:79], v[56:59], v[124:127], v[64:79]
    v_pk_fma_f16 v128, v153, s9, v152
    v_cvt_pknorm_u16_f32 v158, v158, v159
    v_pk_add_u16 v157, v156, s8 clamp
    v_pk_fma_f16 v129, v155, s9, v154
    s_waitcnt lgkmcnt(0)
    v_mfma_f32_32x32x16_bf16 v[136:151], v[44:47], v[32:35], 0
    v_cvt_pknorm_u16_f32 v160, v160, v161
    v_pk_add_u16 v159, v158, s8 clamp
    v_pk_fma_f16 v130, v157, s9, v156
    v_cvt_pknorm_u16_f32 v162, v162, v163
    v_mfma_f32_32x32x8_bf16 v[136:151], v[48:49], v[40:41], v[136:151]
    v_pk_add_u16 v161, v160, s8 clamp
    v_pk_fma_f16 v131, v159, s9, v158
    v_cvt_pknorm_u16_f32 v164, v164, v165
    v_pk_add_u16 v163, v162, s8 clamp
    v_pk_fma_f16 v132, v161, s9, v160
    v_cvt_pknorm_u16_f32 v166, v166, v167
    v_pk_add_u16 v165, v164, s8 clamp
    v_pk_fma_f16 v133, v163, s9, v162
    v_pk_add_u16 v167, v166, s8 clamp
    v_pk_fma_f16 v134, v165, s9, v164
    v_pk_fma_f16 v135, v167, s9, v166
    v_mfma_f32_32x32x16_f16 v[80:95], v[52:55], v[128:131], 0
    v_cvt_pknorm_u16_f32 v136, v136, v137
    v_cvt_pknorm_u16_f32 v138, v138, v139
    v_pk_add_u16 v137, v136, s8 clamp
    v_cvt_pknorm_u16_f32 v140, v140, v141
    v_pk_add_u16 v139, v138, s8 clamp
    v_mfma_f32_32x32x16_f16 v[80:95], v[56:59], v[132:135], v[80:95]
    ds_read_b64_tr_b16 v[52:53], v11 offset:28224
    ds_read_b64_tr_b16 v[54:55], v12 offset:28224
    ds_read_b64_tr_b16 v[56:57], v13 offset:28224
    ds_read_b64_tr_b16 v[58:59], v14 offset:28224
    v_pk_fma_f16 v120, v137, s9, v136
    v_cvt_pknorm_u16_f32 v142, v142, v143
    v_pk_add_u16 v141, v140, s8 clamp
    v_pk_fma_f16 v121, v139, s9, v138
    v_mfma_f32_32x32x16_bf16 v[152:167], v[44:47], v[36:39], 0
    v_cvt_pknorm_u16_f32 v144, v144, v145
    v_pk_add_u16 v143, v142, s8 clamp
    v_pk_fma_f16 v122, v141, s9, v140
    v_cvt_pknorm_u16_f32 v146, v146, v147
    v_mfma_f32_32x32x8_bf16 v[152:167], v[48:49], v[42:43], v[152:167]
    ds_read_b128 v[44:47], v9 offset:31360
    ds_read_b64 v[48:49], v10 offset:31360
    v_pk_add_u16 v145, v144, s8 clamp
    s_setprio 1
    v_pk_fma_f16 v123, v143, s9, v142
    v_cvt_pknorm_u16_f32 v148, v148, v149
    v_pk_add_u16 v147, v146, s8 clamp
    v_pk_fma_f16 v124, v145, s9, v144
    v_cvt_pknorm_u16_f32 v150, v150, v151
    v_pk_add_u16 v149, v148, s8 clamp
    v_pk_fma_f16 v125, v147, s9, v146
    v_pk_add_u16 v151, v150, s8 clamp
    v_pk_fma_f16 v126, v149, s9, v148
    v_pk_fma_f16 v127, v151, s9, v150
    s_waitcnt lgkmcnt(4)
    v_mfma_f32_32x32x16_f16 v[64:79], v[52:55], v[120:123], v[64:79]
    v_cvt_pknorm_u16_f32 v152, v152, v153
    v_cvt_pknorm_u16_f32 v154, v154, v155
    v_pk_add_u16 v153, v152, s8 clamp
    v_cvt_pknorm_u16_f32 v156, v156, v157
    v_pk_add_u16 v155, v154, s8 clamp
    s_waitcnt lgkmcnt(2)
    v_mfma_f32_32x32x16_f16 v[64:79], v[56:59], v[124:127], v[64:79]
    v_pk_fma_f16 v128, v153, s9, v152
    v_cvt_pknorm_u16_f32 v158, v158, v159
    v_pk_add_u16 v157, v156, s8 clamp
    v_pk_fma_f16 v129, v155, s9, v154
    s_waitcnt lgkmcnt(0)
    v_mfma_f32_32x32x16_bf16 v[136:151], v[44:47], v[32:35], 0
    v_cvt_pknorm_u16_f32 v160, v160, v161
    v_pk_add_u16 v159, v158, s8 clamp
    v_pk_fma_f16 v130, v157, s9, v156
    v_cvt_pknorm_u16_f32 v162, v162, v163
    v_mfma_f32_32x32x8_bf16 v[136:151], v[48:49], v[40:41], v[136:151]
    v_pk_add_u16 v161, v160, s8 clamp
    v_pk_fma_f16 v131, v159, s9, v158
    v_cvt_pknorm_u16_f32 v164, v164, v165
    v_pk_add_u16 v163, v162, s8 clamp
    v_pk_fma_f16 v132, v161, s9, v160
    v_cvt_pknorm_u16_f32 v166, v166, v167
    v_pk_add_u16 v165, v164, s8 clamp
    v_pk_fma_f16 v133, v163, s9, v162
    v_pk_add_u16 v167, v166, s8 clamp
    v_pk_fma_f16 v134, v165, s9, v164
    v_pk_fma_f16 v135, v167, s9, v166
    v_mfma_f32_32x32x16_f16 v[80:95], v[52:55], v[128:131], v[80:95]
    v_cvt_pknorm_u16_f32 v136, v136, v137
    v_cvt_pknorm_u16_f32 v138, v138, v139
    v_pk_add_u16 v137, v136, s8 clamp
    v_cvt_pknorm_u16_f32 v140, v140, v141
    v_pk_add_u16 v139, v138, s8 clamp
    v_mfma_f32_32x32x16_f16 v[80:95], v[56:59], v[132:135], v[80:95]
    ds_read_b64_tr_b16 v[52:53], v11 offset:31360
    ds_read_b64_tr_b16 v[54:55], v12 offset:31360
    ds_read_b64_tr_b16 v[56:57], v13 offset:31360
    ds_read_b64_tr_b16 v[58:59], v14 offset:31360
    v_pk_fma_f16 v120, v137, s9, v136
    v_cvt_pknorm_u16_f32 v142, v142, v143
    v_pk_add_u16 v141, v140, s8 clamp
    v_pk_fma_f16 v121, v139, s9, v138
    v_mfma_f32_32x32x16_bf16 v[152:167], v[44:47], v[36:39], 0
    v_cvt_pknorm_u16_f32 v144, v144, v145
    v_pk_add_u16 v143, v142, s8 clamp
    v_pk_fma_f16 v122, v141, s9, v140
    v_cvt_pknorm_u16_f32 v146, v146, v147
    v_mfma_f32_32x32x8_bf16 v[152:167], v[48:49], v[42:43], v[152:167]
    ds_read_b128 v[44:47], v9 offset:34496
    ds_read_b64 v[48:49], v10 offset:34496
    v_pk_add_u16 v145, v144, s8 clamp
    s_setprio 0
    v_pk_fma_f16 v123, v143, s9, v142
    v_cvt_pknorm_u16_f32 v148, v148, v149
    v_pk_add_u16 v147, v146, s8 clamp
    v_pk_fma_f16 v124, v145, s9, v144
    v_cvt_pknorm_u16_f32 v150, v150, v151
    v_pk_add_u16 v149, v148, s8 clamp
    v_pk_fma_f16 v125, v147, s9, v146
    v_pk_add_u16 v151, v150, s8 clamp
    v_pk_fma_f16 v126, v149, s9, v148
    v_pk_fma_f16 v127, v151, s9, v150
    s_waitcnt lgkmcnt(4)
    v_mfma_f32_32x32x16_f16 v[64:79], v[52:55], v[120:123], v[64:79]
    v_cvt_pknorm_u16_f32 v152, v152, v153
    v_cvt_pknorm_u16_f32 v154, v154, v155
    v_pk_add_u16 v153, v152, s8 clamp
    v_cvt_pknorm_u16_f32 v156, v156, v157
    v_pk_add_u16 v155, v154, s8 clamp
    s_waitcnt lgkmcnt(2)
    v_mfma_f32_32x32x16_f16 v[64:79], v[56:59], v[124:127], v[64:79]
    v_pk_fma_f16 v128, v153, s9, v152
    v_cvt_pknorm_u16_f32 v158, v158, v159
    v_pk_add_u16 v157, v156, s8 clamp
    v_pk_fma_f16 v129, v155, s9, v154
    s_waitcnt lgkmcnt(0)
    v_mfma_f32_32x32x16_bf16 v[136:151], v[44:47], v[32:35], 0
    v_cvt_pknorm_u16_f32 v160, v160, v161
    v_pk_add_u16 v159, v158, s8 clamp
    v_pk_fma_f16 v130, v157, s9, v156
    v_cvt_pknorm_u16_f32 v162, v162, v163
    v_mfma_f32_32x32x8_bf16 v[136:151], v[48:49], v[40:41], v[136:151]
    v_pk_add_u16 v161, v160, s8 clamp
    v_pk_fma_f16 v131, v159, s9, v158
    v_cvt_pknorm_u16_f32 v164, v164, v165
    v_pk_add_u16 v163, v162, s8 clamp
    v_pk_fma_f16 v132, v161, s9, v160
    v_cvt_pknorm_u16_f32 v166, v166, v167
    v_pk_add_u16 v165, v164, s8 clamp
    v_pk_fma_f16 v133, v163, s9, v162
    v_pk_add_u16 v167, v166, s8 clamp
    v_pk_fma_f16 v134, v165, s9, v164
    v_pk_fma_f16 v135, v167, s9, v166
    v_mfma_f32_32x32x16_f16 v[80:95], v[52:55], v[128:131], v[80:95]
    v_cvt_pknorm_u16_f32 v136, v136, v137
    v_cvt_pknorm_u16_f32 v138, v138, v139
    v_pk_add_u16 v137, v136, s8 clamp
    v_cvt_pknorm_u16_f32 v140, v140, v141
    v_pk_add_u16 v139, v138, s8 clamp
    v_mfma_f32_32x32x16_f16 v[80:95], v[56:59], v[132:135], v[80:95]
    ds_read_b64_tr_b16 v[52:53], v11 offset:34496
    ds_read_b64_tr_b16 v[54:55], v12 offset:34496
    ds_read_b64_tr_b16 v[56:57], v13 offset:34496
    ds_read_b64_tr_b16 v[58:59], v14 offset:34496
    v_pk_fma_f16 v120, v137, s9, v136
    v_cvt_pknorm_u16_f32 v142, v142, v143
    v_pk_add_u16 v141, v140, s8 clamp
    v_pk_fma_f16 v121, v139, s9, v138
    v_mfma_f32_32x32x16_bf16 v[152:167], v[44:47], v[36:39], 0
    v_cvt_pknorm_u16_f32 v144, v144, v145
    v_pk_add_u16 v143, v142, s8 clamp
    v_pk_fma_f16 v122, v141, s9, v140
    v_cvt_pknorm_u16_f32 v146, v146, v147
    v_mfma_f32_32x32x8_bf16 v[152:167], v[48:49], v[42:43], v[152:167]
    s_waitcnt vmcnt(0) lgkmcnt(0)
    s_barrier
    ds_read_b128 v[44:47], v9 offset:0
    ds_read_b64 v[48:49], v10 offset:0
    s_setprio 3
    v_pk_add_u16 v145, v144, s8 clamp
    v_pk_fma_f16 v123, v143, s9, v142
    v_cvt_pknorm_u16_f32 v148, v148, v149
    v_pk_add_u16 v147, v146, s8 clamp
    v_pk_fma_f16 v124, v145, s9, v144
    v_cvt_pknorm_u16_f32 v150, v150, v151
    v_pk_add_u16 v149, v148, s8 clamp
    v_pk_fma_f16 v125, v147, s9, v146
    v_pk_add_u16 v151, v150, s8 clamp
    v_pk_fma_f16 v126, v149, s9, v148
    v_pk_fma_f16 v127, v151, s9, v150
    v_mfma_f32_32x32x16_f16 v[64:79], v[52:55], v[120:123], v[64:79]
    v_cvt_pknorm_u16_f32 v152, v152, v153
    v_cvt_pknorm_u16_f32 v154, v154, v155
    v_pk_add_u16 v153, v152, s8 clamp
    v_cvt_pknorm_u16_f32 v156, v156, v157
    v_pk_add_u16 v155, v154, s8 clamp
    v_mfma_f32_32x32x16_f16 v[64:79], v[56:59], v[124:127], v[64:79]
    v_pk_fma_f16 v128, v153, s9, v152
    v_cvt_pknorm_u16_f32 v158, v158, v159
    v_pk_add_u16 v157, v156, s8 clamp
    v_pk_fma_f16 v129, v155, s9, v154
    s_waitcnt lgkmcnt(0)
    v_mfma_f32_32x32x16_bf16 v[136:151], v[44:47], v[32:35], 0
    v_cvt_pknorm_u16_f32 v160, v160, v161
    v_pk_add_u16 v159, v158, s8 clamp
    v_pk_fma_f16 v130, v157, s9, v156
    v_cvt_pknorm_u16_f32 v162, v162, v163
    v_mfma_f32_32x32x8_bf16 v[136:151], v[48:49], v[40:41], v[136:151]
    v_pk_add_u16 v161, v160, s8 clamp
    v_pk_fma_f16 v131, v159, s9, v158
    v_cvt_pknorm_u16_f32 v164, v164, v165
    v_pk_add_u16 v163, v162, s8 clamp
    v_pk_fma_f16 v132, v161, s9, v160
    v_cvt_pknorm_u16_f32 v166, v166, v167
    v_pk_add_u16 v165, v164, s8 clamp
    v_pk_fma_f16 v133, v163, s9, v162
    v_pk_add_u16 v167, v166, s8 clamp
    v_pk_fma_f16 v134, v165, s9, v164
    v_pk_fma_f16 v135, v167, s9, v166
    v_mfma_f32_32x32x16_f16 v[80:95], v[52:55], v[128:131], v[80:95]
    v_cvt_pknorm_u16_f32 v136, v136, v137
    v_cvt_pknorm_u16_f32 v138, v138, v139
    v_pk_add_u16 v137, v136, s8 clamp
    v_cvt_pknorm_u16_f32 v140, v140, v141
    v_pk_add_u16 v139, v138, s8 clamp
    v_mfma_f32_32x32x16_f16 v[80:95], v[56:59], v[132:135], v[80:95]
    ds_read_b64_tr_b16 v[52:53], v11 offset:0
    ds_read_b64_tr_b16 v[54:55], v12 offset:0
    ds_read_b64_tr_b16 v[56:57], v13 offset:0
    ds_read_b64_tr_b16 v[58:59], v14 offset:0
    v_pk_fma_f16 v120, v137, s9, v136
    v_cvt_pknorm_u16_f32 v142, v142, v143
    v_pk_add_u16 v141, v140, s8 clamp
    v_pk_fma_f16 v121, v139, s9, v138
    v_mfma_f32_32x32x16_bf16 v[152:167], v[44:47], v[36:39], 0
    v_cvt_pknorm_u16_f32 v144, v144, v145
    v_pk_add_u16 v143, v142, s8 clamp
    v_pk_fma_f16 v122, v141, s9, v140
    v_cvt_pknorm_u16_f32 v146, v146, v147
    v_mfma_f32_32x32x8_bf16 v[152:167], v[48:49], v[42:43], v[152:167]
    ds_read_b128 v[44:47], v9 offset:3136
    ds_read_b64 v[48:49], v10 offset:3136
    v_pk_add_u16 v145, v144, s8 clamp
    s_setprio 2
    v_pk_fma_f16 v123, v143, s9, v142
    v_cvt_pknorm_u16_f32 v148, v148, v149
    v_pk_add_u16 v147, v146, s8 clamp
    v_pk_fma_f16 v124, v145, s9, v144
    v_cvt_pknorm_u16_f32 v150, v150, v151
    v_pk_add_u16 v149, v148, s8 clamp
    v_pk_fma_f16 v125, v147, s9, v146
    v_pk_add_u16 v151, v150, s8 clamp
    v_pk_fma_f16 v126, v149, s9, v148
    v_pk_fma_f16 v127, v151, s9, v150
    s_waitcnt lgkmcnt(4)
    v_mfma_f32_32x32x16_f16 v[64:79], v[52:55], v[120:123], v[64:79]
    v_cvt_pknorm_u16_f32 v152, v152, v153
    v_cvt_pknorm_u16_f32 v154, v154, v155
    v_pk_add_u16 v153, v152, s8 clamp
    v_cvt_pknorm_u16_f32 v156, v156, v157
    v_pk_add_u16 v155, v154, s8 clamp
    s_waitcnt lgkmcnt(2)
    v_mfma_f32_32x32x16_f16 v[64:79], v[56:59], v[124:127], v[64:79]
    v_pk_fma_f16 v128, v153, s9, v152
    v_cvt_pknorm_u16_f32 v158, v158, v159
    v_pk_add_u16 v157, v156, s8 clamp
    v_pk_fma_f16 v129, v155, s9, v154
    s_waitcnt lgkmcnt(0)
    v_mfma_f32_32x32x16_bf16 v[136:151], v[44:47], v[32:35], 0
    v_cvt_pknorm_u16_f32 v160, v160, v161
    v_pk_add_u16 v159, v158, s8 clamp
    v_pk_fma_f16 v130, v157, s9, v156
    v_cvt_pknorm_u16_f32 v162, v162, v163
    v_mfma_f32_32x32x8_bf16 v[136:151], v[48:49], v[40:41], v[136:151]
    v_pk_add_u16 v161, v160, s8 clamp
    v_pk_fma_f16 v131, v159, s9, v158
    v_cvt_pknorm_u16_f32 v164, v164, v165
    v_pk_add_u16 v163, v162, s8 clamp
    v_pk_fma_f16 v132, v161, s9, v160
    v_cvt_pknorm_u16_f32 v166, v166, v167
    v_pk_add_u16 v165, v164, s8 clamp
    v_pk_fma_f16 v133, v163, s9, v162
    v_pk_add_u16 v167, v166, s8 clamp
    v_pk_fma_f16 v134, v165, s9, v164
    v_pk_fma_f16 v135, v167, s9, v166
    v_mfma_f32_32x32x16_f16 v[80:95], v[52:55], v[128:131], v[80:95]
    v_cvt_pknorm_u16_f32 v136, v136, v137
    v_cvt_pknorm_u16_f32 v138, v138, v139
    v_pk_add_u16 v137, v136, s8 clamp
    v_cvt_pknorm_u16_f32 v140, v140, v141
    v_pk_add_u16 v139, v138, s8 clamp
    v_mfma_f32_32x32x16_f16 v[80:95], v[56:59], v[132:135], v[80:95]
    ds_read_b64_tr_b16 v[52:53], v11 offset:3136
    ds_read_b64_tr_b16 v[54:55], v12 offset:3136
    ds_read_b64_tr_b16 v[56:57], v13 offset:3136
    ds_read_b64_tr_b16 v[58:59], v14 offset:3136
    v_pk_fma_f16 v120, v137, s9, v136
    v_cvt_pknorm_u16_f32 v142, v142, v143
    v_pk_add_u16 v141, v140, s8 clamp
    v_pk_fma_f16 v121, v139, s9, v138
    v_mfma_f32_32x32x16_bf16 v[152:167], v[44:47], v[36:39], 0
    v_cvt_pknorm_u16_f32 v144, v144, v145
    v_pk_add_u16 v143, v142, s8 clamp
    v_pk_fma_f16 v122, v141, s9, v140
    v_cvt_pknorm_u16_f32 v146, v146, v147
    v_mfma_f32_32x32x8_bf16 v[152:167], v[48:49], v[42:43], v[152:167]
    ds_read_b128 v[44:47], v9 offset:6272
    ds_read_b64 v[48:49], v10 offset:6272
    v_pk_add_u16 v145, v144, s8 clamp
    s_setprio 1
    v_pk_fma_f16 v123, v143, s9, v142
    v_cvt_pknorm_u16_f32 v148, v148, v149
    v_pk_add_u16 v147, v146, s8 clamp
    v_pk_fma_f16 v124, v145, s9, v144
    v_cvt_pknorm_u16_f32 v150, v150, v151
    v_pk_add_u16 v149, v148, s8 clamp
    v_pk_fma_f16 v125, v147, s9, v146
    v_pk_add_u16 v151, v150, s8 clamp
    v_pk_fma_f16 v126, v149, s9, v148
    v_pk_fma_f16 v127, v151, s9, v150
    s_waitcnt lgkmcnt(4)
    v_mfma_f32_32x32x16_f16 v[64:79], v[52:55], v[120:123], v[64:79]
    v_cvt_pknorm_u16_f32 v152, v152, v153
    v_cvt_pknorm_u16_f32 v154, v154, v155
    v_pk_add_u16 v153, v152, s8 clamp
    v_cvt_pknorm_u16_f32 v156, v156, v157
    v_pk_add_u16 v155, v154, s8 clamp
    s_waitcnt lgkmcnt(2)
    v_mfma_f32_32x32x16_f16 v[64:79], v[56:59], v[124:127], v[64:79]
    v_pk_fma_f16 v128, v153, s9, v152
    v_cvt_pknorm_u16_f32 v158, v158, v159
    v_pk_add_u16 v157, v156, s8 clamp
    v_pk_fma_f16 v129, v155, s9, v154
    s_waitcnt lgkmcnt(0)
    v_mfma_f32_32x32x16_bf16 v[136:151], v[44:47], v[32:35], 0
    v_cvt_pknorm_u16_f32 v160, v160, v161
    v_pk_add_u16 v159, v158, s8 clamp
    v_pk_fma_f16 v130, v157, s9, v156
    v_cvt_pknorm_u16_f32 v162, v162, v163
    v_mfma_f32_32x32x8_bf16 v[136:151], v[48:49], v[40:41], v[136:151]
    v_pk_add_u16 v161, v160, s8 clamp
    v_pk_fma_f16 v131, v159, s9, v158
    v_cvt_pknorm_u16_f32 v164, v164, v165
    v_pk_add_u16 v163, v162, s8 clamp
    v_pk_fma_f16 v132, v161, s9, v160
    v_cvt_pknorm_u16_f32 v166, v166, v167
    v_pk_add_u16 v165, v164, s8 clamp
    v_pk_fma_f16 v133, v163, s9, v162
    v_pk_add_u16 v167, v166, s8 clamp
    v_pk_fma_f16 v134, v165, s9, v164
    v_pk_fma_f16 v135, v167, s9, v166
    v_mfma_f32_32x32x16_f16 v[80:95], v[52:55], v[128:131], v[80:95]
    v_cvt_pknorm_u16_f32 v136, v136, v137
    v_cvt_pknorm_u16_f32 v138, v138, v139
    v_pk_add_u16 v137, v136, s8 clamp
    v_cvt_pknorm_u16_f32 v140, v140, v141
    v_pk_add_u16 v139, v138, s8 clamp
    v_mfma_f32_32x32x16_f16 v[80:95], v[56:59], v[132:135], v[80:95]
    ds_read_b64_tr_b16 v[52:53], v11 offset:6272
    ds_read_b64_tr_b16 v[54:55], v12 offset:6272
    ds_read_b64_tr_b16 v[56:57], v13 offset:6272
    ds_read_b64_tr_b16 v[58:59], v14 offset:6272
    v_pk_fma_f16 v120, v137, s9, v136
    v_cvt_pknorm_u16_f32 v142, v142, v143
    v_pk_add_u16 v141, v140, s8 clamp
    v_pk_fma_f16 v121, v139, s9, v138
    v_mfma_f32_32x32x16_bf16 v[152:167], v[44:47], v[36:39], 0
    v_cvt_pknorm_u16_f32 v144, v144, v145
    v_pk_add_u16 v143, v142, s8 clamp
    v_pk_fma_f16 v122, v141, s9, v140
    v_cvt_pknorm_u16_f32 v146, v146, v147
    v_mfma_f32_32x32x8_bf16 v[152:167], v[48:49], v[42:43], v[152:167]
    ds_read_b128 v[44:47], v9 offset:9408
    ds_read_b64 v[48:49], v10 offset:9408
    v_pk_add_u16 v145, v144, s8 clamp
    s_setprio 0
    v_pk_fma_f16 v123, v143, s9, v142
    v_cvt_pknorm_u16_f32 v148, v148, v149
    v_pk_add_u16 v147, v146, s8 clamp
    v_pk_fma_f16 v124, v145, s9, v144
    v_cvt_pknorm_u16_f32 v150, v150, v151
    v_pk_add_u16 v149, v148, s8 clamp
    v_pk_fma_f16 v125, v147, s9, v146
    v_pk_add_u16 v151, v150, s8 clamp
    v_pk_fma_f16 v126, v149, s9, v148
    v_pk_fma_f16 v127, v151, s9, v150
    s_waitcnt lgkmcnt(4)
    v_mfma_f32_32x32x16_f16 v[64:79], v[52:55], v[120:123], v[64:79]
    v_cvt_pknorm_u16_f32 v152, v152, v153
    v_cvt_pknorm_u16_f32 v154, v154, v155
    v_pk_add_u16 v153, v152, s8 clamp
    v_cvt_pknorm_u16_f32 v156, v156, v157
    v_pk_add_u16 v155, v154, s8 clamp
    s_waitcnt lgkmcnt(2)
    v_mfma_f32_32x32x16_f16 v[64:79], v[56:59], v[124:127], v[64:79]
    v_pk_fma_f16 v128, v153, s9, v152
    v_cvt_pknorm_u16_f32 v158, v158, v159
    v_pk_add_u16 v157, v156, s8 clamp
    v_pk_fma_f16 v129, v155, s9, v154
    s_waitcnt lgkmcnt(0)
    v_mfma_f32_32x32x16_bf16 v[136:151], v[44:47], v[32:35], 0
    v_cvt_pknorm_u16_f32 v160, v160, v161
    v_pk_add_u16 v159, v158, s8 clamp
    v_pk_fma_f16 v130, v157, s9, v156
    v_cvt_pknorm_u16_f32 v162, v162, v163
    v_mfma_f32_32x32x8_bf16 v[136:151], v[48:49], v[40:41], v[136:151]
    v_pk_add_u16 v161, v160, s8 clamp
    v_pk_fma_f16 v131, v159, s9, v158
    v_cvt_pknorm_u16_f32 v164, v164, v165
    v_pk_add_u16 v163, v162, s8 clamp
    v_pk_fma_f16 v132, v161, s9, v160
    v_cvt_pknorm_u16_f32 v166, v166, v167
    v_pk_add_u16 v165, v164, s8 clamp
    v_pk_fma_f16 v133, v163, s9, v162
    v_pk_add_u16 v167, v166, s8 clamp
    v_pk_fma_f16 v134, v165, s9, v164
    v_pk_fma_f16 v135, v167, s9, v166
    v_mfma_f32_32x32x16_f16 v[80:95], v[52:55], v[128:131], v[80:95]
    v_cvt_pknorm_u16_f32 v136, v136, v137
    v_cvt_pknorm_u16_f32 v138, v138, v139
    v_pk_add_u16 v137, v136, s8 clamp
    v_cvt_pknorm_u16_f32 v140, v140, v141
    v_pk_add_u16 v139, v138, s8 clamp
    v_mfma_f32_32x32x16_f16 v[80:95], v[56:59], v[132:135], v[80:95]
    ds_read_b64_tr_b16 v[52:53], v11 offset:9408
    ds_read_b64_tr_b16 v[54:55], v12 offset:9408
    ds_read_b64_tr_b16 v[56:57], v13 offset:9408
    ds_read_b64_tr_b16 v[58:59], v14 offset:9408
    v_pk_fma_f16 v120, v137, s9, v136
    v_cvt_pknorm_u16_f32 v142, v142, v143
    v_pk_add_u16 v141, v140, s8 clamp
    v_pk_fma_f16 v121, v139, s9, v138
    v_mfma_f32_32x32x16_bf16 v[152:167], v[44:47], v[36:39], 0
    v_cvt_pknorm_u16_f32 v144, v144, v145
    v_pk_add_u16 v143, v142, s8 clamp
    v_pk_fma_f16 v122, v141, s9, v140
    v_cvt_pknorm_u16_f32 v146, v146, v147
    v_mfma_f32_32x32x8_bf16 v[152:167], v[48:49], v[42:43], v[152:167]
    s_waitcnt lgkmcnt(0)
    s_barrier
    ds_read_b128 v[44:47], v9 offset:25088
    ds_read_b64 v[48:49], v10 offset:25088
    s_setprio 3
    v_pk_add_u16 v145, v144, s8 clamp
    v_pk_fma_f16 v123, v143, s9, v142
    v_cvt_pknorm_u16_f32 v148, v148, v149
    v_pk_add_u16 v147, v146, s8 clamp
    v_pk_fma_f16 v124, v145, s9, v144
    v_cvt_pknorm_u16_f32 v150, v150, v151
    v_pk_add_u16 v149, v148, s8 clamp
    v_pk_fma_f16 v125, v147, s9, v146
    v_pk_add_u16 v151, v150, s8 clamp
    v_pk_fma_f16 v126, v149, s9, v148
    v_pk_fma_f16 v127, v151, s9, v150
    v_mfma_f32_32x32x16_f16 v[64:79], v[52:55], v[120:123], v[64:79]
    v_cvt_pknorm_u16_f32 v152, v152, v153
    v_cvt_pknorm_u16_f32 v154, v154, v155
    v_pk_add_u16 v153, v152, s8 clamp
    v_cvt_pknorm_u16_f32 v156, v156, v157
    v_pk_add_u16 v155, v154, s8 clamp
    v_mfma_f32_32x32x16_f16 v[64:79], v[56:59], v[124:127], v[64:79]
    v_pk_fma_f16 v128, v153, s9, v152
    v_cvt_pknorm_u16_f32 v158, v158, v159
    v_pk_add_u16 v157, v156, s8 clamp
    v_pk_fma_f16 v129, v155, s9, v154
    s_waitcnt lgkmcnt(0)
    v_mfma_f32_32x32x16_bf16 v[136:151], v[44:47], v[32:35], 0
    v_cvt_pknorm_u16_f32 v160, v160, v161
    v_pk_add_u16 v159, v158, s8 clamp
    v_pk_fma_f16 v130, v157, s9, v156
    v_cvt_pknorm_u16_f32 v162, v162, v163
    v_mfma_f32_32x32x8_bf16 v[136:151], v[48:49], v[40:41], v[136:151]
    v_pk_add_u16 v161, v160, s8 clamp
    v_pk_fma_f16 v131, v159, s9, v158
    v_cvt_pknorm_u16_f32 v164, v164, v165
    v_pk_add_u16 v163, v162, s8 clamp
    v_pk_fma_f16 v132, v161, s9, v160
    v_cvt_pknorm_u16_f32 v166, v166, v167
    v_pk_add_u16 v165, v164, s8 clamp
    v_pk_fma_f16 v133, v163, s9, v162
    v_pk_add_u16 v167, v166, s8 clamp
    v_pk_fma_f16 v134, v165, s9, v164
    v_pk_fma_f16 v135, v167, s9, v166
    v_mfma_f32_32x32x16_f16 v[80:95], v[52:55], v[128:131], v[80:95]
    v_cvt_pknorm_u16_f32 v136, v136, v137
    v_cvt_pknorm_u16_f32 v138, v138, v139
    v_pk_add_u16 v137, v136, s8 clamp
    v_cvt_pknorm_u16_f32 v140, v140, v141
    v_pk_add_u16 v139, v138, s8 clamp
    v_mfma_f32_32x32x16_f16 v[80:95], v[56:59], v[132:135], v[80:95]
    ds_read_b64_tr_b16 v[52:53], v11 offset:25088
    ds_read_b64_tr_b16 v[54:55], v12 offset:25088
    ds_read_b64_tr_b16 v[56:57], v13 offset:25088
    ds_read_b64_tr_b16 v[58:59], v14 offset:25088
    v_pk_fma_f16 v120, v137, s9, v136
    v_cvt_pknorm_u16_f32 v142, v142, v143
    v_pk_add_u16 v141, v140, s8 clamp
    v_pk_fma_f16 v121, v139, s9, v138
    v_mfma_f32_32x32x16_bf16 v[152:167], v[44:47], v[36:39], 0
    v_cvt_pknorm_u16_f32 v144, v144, v145
    v_pk_add_u16 v143, v142, s8 clamp
    v_pk_fma_f16 v122, v141, s9, v140
    v_cvt_pknorm_u16_f32 v146, v146, v147
    v_mfma_f32_32x32x8_bf16 v[152:167], v[48:49], v[42:43], v[152:167]
    ds_read_b128 v[44:47], v9 offset:28224
    ds_read_b64 v[48:49], v10 offset:28224
    v_pk_add_u16 v145, v144, s8 clamp
    s_setprio 2
    v_pk_fma_f16 v123, v143, s9, v142
    v_cvt_pknorm_u16_f32 v148, v148, v149
    v_pk_add_u16 v147, v146, s8 clamp
    v_pk_fma_f16 v124, v145, s9, v144
    v_cvt_pknorm_u16_f32 v150, v150, v151
    v_pk_add_u16 v149, v148, s8 clamp
    v_pk_fma_f16 v125, v147, s9, v146
    v_pk_add_u16 v151, v150, s8 clamp
    v_pk_fma_f16 v126, v149, s9, v148
    v_pk_fma_f16 v127, v151, s9, v150
    s_waitcnt lgkmcnt(4)
    v_mfma_f32_32x32x16_f16 v[64:79], v[52:55], v[120:123], v[64:79]
    v_cvt_pknorm_u16_f32 v152, v152, v153
    v_cvt_pknorm_u16_f32 v154, v154, v155
    v_pk_add_u16 v153, v152, s8 clamp
    v_cvt_pknorm_u16_f32 v156, v156, v157
    v_pk_add_u16 v155, v154, s8 clamp
    s_waitcnt lgkmcnt(2)
    v_mfma_f32_32x32x16_f16 v[64:79], v[56:59], v[124:127], v[64:79]
    v_pk_fma_f16 v128, v153, s9, v152
    v_cvt_pknorm_u16_f32 v158, v158, v159
    v_pk_add_u16 v157, v156, s8 clamp
    v_pk_fma_f16 v129, v155, s9, v154
    s_waitcnt lgkmcnt(0)
    v_mfma_f32_32x32x16_bf16 v[136:151], v[44:47], v[32:35], 0
    v_cvt_pknorm_u16_f32 v160, v160, v161
    v_pk_add_u16 v159, v158, s8 clamp
    v_pk_fma_f16 v130, v157, s9, v156
    v_cvt_pknorm_u16_f32 v162, v162, v163
    v_mfma_f32_32x32x8_bf16 v[136:151], v[48:49], v[40:41], v[136:151]
    v_pk_add_u16 v161, v160, s8 clamp
    v_pk_fma_f16 v131, v159, s9, v158
    v_cvt_pknorm_u16_f32 v164, v164, v165
    v_pk_add_u16 v163, v162, s8 clamp
    v_pk_fma_f16 v132, v161, s9, v160
    v_cvt_pknorm_u16_f32 v166, v166, v167
    v_pk_add_u16 v165, v164, s8 clamp
    v_pk_fma_f16 v133, v163, s9, v162
    v_pk_add_u16 v167, v166, s8 clamp
    v_pk_fma_f16 v134, v165, s9, v164
    v_pk_fma_f16 v135, v167, s9, v166
    v_mfma_f32_32x32x16_f16 v[80:95], v[52:55], v[128:131], v[80:95]
    v_cvt_pknorm_u16_f32 v136, v136, v137
    v_cvt_pknorm_u16_f32 v138, v138, v139
    v_pk_add_u16 v137, v136, s8 clamp
    v_cvt_pknorm_u16_f32 v140, v140, v141
    v_pk_add_u16 v139, v138, s8 clamp
    v_mfma_f32_32x32x16_f16 v[80:95], v[56:59], v[132:135], v[80:95]
    ds_read_b64_tr_b16 v[52:53], v11 offset:28224
    ds_read_b64_tr_b16 v[54:55], v12 offset:28224
    ds_read_b64_tr_b16 v[56:57], v13 offset:28224
    ds_read_b64_tr_b16 v[58:59], v14 offset:28224
    v_pk_fma_f16 v120, v137, s9, v136
    v_cvt_pknorm_u16_f32 v142, v142, v143
    v_pk_add_u16 v141, v140, s8 clamp
    v_pk_fma_f16 v121, v139, s9, v138
    v_mfma_f32_32x32x16_bf16 v[152:167], v[44:47], v[36:39], 0
    v_cvt_pknorm_u16_f32 v144, v144, v145
    v_pk_add_u16 v143, v142, s8 clamp
    v_pk_fma_f16 v122, v141, s9, v140
    v_cvt_pknorm_u16_f32 v146, v146, v147
    v_mfma_f32_32x32x8_bf16 v[152:167], v[48:49], v[42:43], v[152:167]
    ds_read_b128 v[44:47], v9 offset:31360
    ds_read_b64 v[48:49], v10 offset:31360
    v_pk_add_u16 v145, v144, s8 clamp
    s_setprio 1
    v_pk_fma_f16 v123, v143, s9, v142
    v_cvt_pknorm_u16_f32 v148, v148, v149
    v_pk_add_u16 v147, v146, s8 clamp
    v_pk_fma_f16 v124, v145, s9, v144
    v_cvt_pknorm_u16_f32 v150, v150, v151
    v_pk_add_u16 v149, v148, s8 clamp
    v_pk_fma_f16 v125, v147, s9, v146
    v_pk_add_u16 v151, v150, s8 clamp
    v_pk_fma_f16 v126, v149, s9, v148
    v_pk_fma_f16 v127, v151, s9, v150
    s_waitcnt lgkmcnt(4)
    v_mfma_f32_32x32x16_f16 v[64:79], v[52:55], v[120:123], v[64:79]
    v_cvt_pknorm_u16_f32 v152, v152, v153
    v_cvt_pknorm_u16_f32 v154, v154, v155
    v_pk_add_u16 v153, v152, s8 clamp
    v_cvt_pknorm_u16_f32 v156, v156, v157
    v_pk_add_u16 v155, v154, s8 clamp
    s_waitcnt lgkmcnt(2)
    v_mfma_f32_32x32x16_f16 v[64:79], v[56:59], v[124:127], v[64:79]
    v_pk_fma_f16 v128, v153, s9, v152
    v_cvt_pknorm_u16_f32 v158, v158, v159
    v_pk_add_u16 v157, v156, s8 clamp
    v_pk_fma_f16 v129, v155, s9, v154
    s_waitcnt lgkmcnt(0)
    v_mfma_f32_32x32x16_bf16 v[136:151], v[44:47], v[32:35], 0
    v_cvt_pknorm_u16_f32 v160, v160, v161
    v_pk_add_u16 v159, v158, s8 clamp
    v_pk_fma_f16 v130, v157, s9, v156
    v_cvt_pknorm_u16_f32 v162, v162, v163
    v_mfma_f32_32x32x8_bf16 v[136:151], v[48:49], v[40:41], v[136:151]
    v_pk_add_u16 v161, v160, s8 clamp
    v_pk_fma_f16 v131, v159, s9, v158
    v_cvt_pknorm_u16_f32 v164, v164, v165
    v_pk_add_u16 v163, v162, s8 clamp
    v_pk_fma_f16 v132, v161, s9, v160
    v_cvt_pknorm_u16_f32 v166, v166, v167
    v_pk_add_u16 v165, v164, s8 clamp
    v_pk_fma_f16 v133, v163, s9, v162
    v_pk_add_u16 v167, v166, s8 clamp
    v_pk_fma_f16 v134, v165, s9, v164
    v_pk_fma_f16 v135, v167, s9, v166
    v_mfma_f32_32x32x16_f16 v[80:95], v[52:55], v[128:131], v[80:95]
    v_cvt_pknorm_u16_f32 v136, v136, v137
    v_cvt_pknorm_u16_f32 v138, v138, v139
    v_pk_add_u16 v137, v136, s8 clamp
    v_cvt_pknorm_u16_f32 v140, v140, v141
    v_pk_add_u16 v139, v138, s8 clamp
    v_mfma_f32_32x32x16_f16 v[80:95], v[56:59], v[132:135], v[80:95]
    ds_read_b64_tr_b16 v[52:53], v11 offset:31360
    ds_read_b64_tr_b16 v[54:55], v12 offset:31360
    ds_read_b64_tr_b16 v[56:57], v13 offset:31360
    ds_read_b64_tr_b16 v[58:59], v14 offset:31360
    v_pk_fma_f16 v120, v137, s9, v136
    v_cvt_pknorm_u16_f32 v142, v142, v143
    v_pk_add_u16 v141, v140, s8 clamp
    v_pk_fma_f16 v121, v139, s9, v138
    v_mfma_f32_32x32x16_bf16 v[152:167], v[44:47], v[36:39], 0
    v_cvt_pknorm_u16_f32 v144, v144, v145
    v_pk_add_u16 v143, v142, s8 clamp
    v_pk_fma_f16 v122, v141, s9, v140
    v_cvt_pknorm_u16_f32 v146, v146, v147
    v_mfma_f32_32x32x8_bf16 v[152:167], v[48:49], v[42:43], v[152:167]
    ds_read_b128 v[44:47], v9 offset:34496
    ds_read_b64 v[48:49], v10 offset:34496
    v_pk_add_u16 v145, v144, s8 clamp
    s_setprio 0
    v_pk_fma_f16 v123, v143, s9, v142
    v_cvt_pknorm_u16_f32 v148, v148, v149
    v_pk_add_u16 v147, v146, s8 clamp
    v_pk_fma_f16 v124, v145, s9, v144
    v_cvt_pknorm_u16_f32 v150, v150, v151
    v_pk_add_u16 v149, v148, s8 clamp
    v_pk_fma_f16 v125, v147, s9, v146
    v_pk_add_u16 v151, v150, s8 clamp
    v_pk_fma_f16 v126, v149, s9, v148
    v_pk_fma_f16 v127, v151, s9, v150
    s_waitcnt lgkmcnt(4)
    v_mfma_f32_32x32x16_f16 v[64:79], v[52:55], v[120:123], v[64:79]
    v_cvt_pknorm_u16_f32 v152, v152, v153
    v_cvt_pknorm_u16_f32 v154, v154, v155
    v_pk_add_u16 v153, v152, s8 clamp
    v_cvt_pknorm_u16_f32 v156, v156, v157
    v_pk_add_u16 v155, v154, s8 clamp
    s_waitcnt lgkmcnt(2)
    v_mfma_f32_32x32x16_f16 v[64:79], v[56:59], v[124:127], v[64:79]
    v_pk_fma_f16 v128, v153, s9, v152
    v_cvt_pknorm_u16_f32 v158, v158, v159
    v_pk_add_u16 v157, v156, s8 clamp
    v_pk_fma_f16 v129, v155, s9, v154
    s_waitcnt lgkmcnt(0)
    v_mfma_f32_32x32x16_bf16 v[136:151], v[44:47], v[32:35], 0
    v_cvt_pknorm_u16_f32 v160, v160, v161
    v_pk_add_u16 v159, v158, s8 clamp
    v_pk_fma_f16 v130, v157, s9, v156
    v_cvt_pknorm_u16_f32 v162, v162, v163
    v_mfma_f32_32x32x8_bf16 v[136:151], v[48:49], v[40:41], v[136:151]
    v_pk_add_u16 v161, v160, s8 clamp
    v_pk_fma_f16 v131, v159, s9, v158
    v_cvt_pknorm_u16_f32 v164, v164, v165
    v_pk_add_u16 v163, v162, s8 clamp
    v_pk_fma_f16 v132, v161, s9, v160
    v_cvt_pknorm_u16_f32 v166, v166, v167
    v_pk_add_u16 v165, v164, s8 clamp
    v_pk_fma_f16 v133, v163, s9, v162
    v_pk_add_u16 v167, v166, s8 clamp
    v_pk_fma_f16 v134, v165, s9, v164
    v_pk_fma_f16 v135, v167, s9, v166
    v_mfma_f32_32x32x16_f16 v[80:95], v[52:55], v[128:131], v[80:95]
    v_cvt_pknorm_u16_f32 v136, v136, v137
    v_cvt_pknorm_u16_f32 v138, v138, v139
    v_pk_add_u16 v137, v136, s8 clamp
    v_cvt_pknorm_u16_f32 v140, v140, v141
    v_pk_add_u16 v139, v138, s8 clamp
    v_mfma_f32_32x32x16_f16 v[80:95], v[56:59], v[132:135], v[80:95]
    ds_read_b64_tr_b16 v[52:53], v11 offset:34496
    ds_read_b64_tr_b16 v[54:55], v12 offset:34496
    ds_read_b64_tr_b16 v[56:57], v13 offset:34496
    ds_read_b64_tr_b16 v[58:59], v14 offset:34496
    v_pk_fma_f16 v120, v137, s9, v136
    v_cvt_pknorm_u16_f32 v142, v142, v143
    v_pk_add_u16 v141, v140, s8 clamp
    v_pk_fma_f16 v121, v139, s9, v138
    v_mfma_f32_32x32x16_bf16 v[152:167], v[44:47], v[36:39], 0
    v_cvt_pknorm_u16_f32 v144, v144, v145
    v_pk_add_u16 v143, v142, s8 clamp
    v_pk_fma_f16 v122, v141, s9, v140
    v_cvt_pknorm_u16_f32 v146, v146, v147
    v_mfma_f32_32x32x8_bf16 v[152:167], v[48:49], v[42:43], v[152:167]
    s_waitcnt lgkmcnt(0)
    s_barrier
    ds_read_b128 v[44:47], v9 offset:0
    ds_read_b64 v[48:49], v10 offset:0
    s_setprio 3
    v_pk_add_u16 v145, v144, s8 clamp
    v_pk_fma_f16 v123, v143, s9, v142
    v_cvt_pknorm_u16_f32 v148, v148, v149
    v_pk_add_u16 v147, v146, s8 clamp
    v_pk_fma_f16 v124, v145, s9, v144
    v_cvt_pknorm_u16_f32 v150, v150, v151
    v_pk_add_u16 v149, v148, s8 clamp
    v_pk_fma_f16 v125, v147, s9, v146
    v_pk_add_u16 v151, v150, s8 clamp
    v_pk_fma_f16 v126, v149, s9, v148
    v_pk_fma_f16 v127, v151, s9, v150
    v_mfma_f32_32x32x16_f16 v[64:79], v[52:55], v[120:123], v[64:79]
    v_cvt_pknorm_u16_f32 v152, v152, v153
    v_cvt_pknorm_u16_f32 v154, v154, v155
    ds_read_b32 v31, v21 offset:544
    v_pk_add_u16 v153, v152, s8 clamp
    v_cvt_pknorm_u16_f32 v156, v156, v157
    v_pk_add_u16 v155, v154, s8 clamp
    v_mfma_f32_32x32x16_f16 v[64:79], v[56:59], v[124:127], v[64:79]
    v_pk_fma_f16 v128, v153, s9, v152
    v_cvt_pknorm_u16_f32 v158, v158, v159
    v_pk_add_u16 v157, v156, s8 clamp
    v_pk_fma_f16 v129, v155, s9, v154
    s_waitcnt lgkmcnt(1)
    v_mfma_f32_32x32x16_bf16 v[136:151], v[44:47], v[32:35], 0
    v_cvt_pknorm_u16_f32 v160, v160, v161
    v_pk_add_u16 v159, v158, s8 clamp
    v_pk_fma_f16 v130, v157, s9, v156
    s_waitcnt lgkmcnt(0)
    v_readlane_b32 s18, v31, s28
    s_nop 0
    s_bfe_u32 s24, s18, 393216
    s_mul_i32 s11, s24, 123392
    s_sub_u32 m0, s4, 0
    s_add_u32 s11, s11, 40960
    buffer_load_dwordx4 v5, s[32:35], s11 offen offset:0 sc1 lds
    buffer_load_dwordx4 v6, s[32:35], s11 offen offset:1024 sc1 lds
    buffer_load_dwordx4 v7, s[32:35], s11 offen offset:2048 sc1 lds
    v_cvt_pknorm_u16_f32 v162, v162, v163
    v_mfma_f32_32x32x8_bf16 v[136:151], v[48:49], v[40:41], v[136:151]
    v_pk_add_u16 v161, v160, s8 clamp
    v_pk_fma_f16 v131, v159, s9, v158
    v_cvt_pknorm_u16_f32 v164, v164, v165
    v_pk_add_u16 v163, v162, s8 clamp
    v_pk_fma_f16 v132, v161, s9, v160
    v_cvt_pknorm_u16_f32 v166, v166, v167
    v_pk_add_u16 v165, v164, s8 clamp
    v_pk_fma_f16 v133, v163, s9, v162
    v_pk_add_u16 v167, v166, s8 clamp
    v_pk_fma_f16 v134, v165, s9, v164
    v_pk_fma_f16 v135, v167, s9, v166
    v_mfma_f32_32x32x16_f16 v[80:95], v[52:55], v[128:131], v[80:95]
    v_cvt_pknorm_u16_f32 v136, v136, v137
    v_cvt_pknorm_u16_f32 v138, v138, v139
    v_pk_add_u16 v137, v136, s8 clamp
    v_cvt_pknorm_u16_f32 v140, v140, v141
    v_pk_add_u16 v139, v138, s8 clamp
    v_mfma_f32_32x32x16_f16 v[80:95], v[56:59], v[132:135], v[80:95]
    ds_read_b64_tr_b16 v[52:53], v11 offset:0
    ds_read_b64_tr_b16 v[54:55], v12 offset:0
    ds_read_b64_tr_b16 v[56:57], v13 offset:0
    ds_read_b64_tr_b16 v[58:59], v14 offset:0
    v_pk_fma_f16 v120, v137, s9, v136
    v_cvt_pknorm_u16_f32 v142, v142, v143
    v_pk_add_u16 v141, v140, s8 clamp
    v_pk_fma_f16 v121, v139, s9, v138
    v_mfma_f32_32x32x16_bf16 v[152:167], v[44:47], v[36:39], 0
    v_cvt_pknorm_u16_f32 v144, v144, v145
    v_pk_add_u16 v143, v142, s8 clamp
    v_pk_fma_f16 v122, v141, s9, v140
    v_cvt_pknorm_u16_f32 v146, v146, v147
    v_mfma_f32_32x32x8_bf16 v[152:167], v[48:49], v[42:43], v[152:167]
    ds_read_b128 v[44:47], v9 offset:3136
    ds_read_b64 v[48:49], v10 offset:3136
    v_pk_add_u16 v145, v144, s8 clamp
    s_setprio 2
    v_pk_fma_f16 v123, v143, s9, v142
    v_cvt_pknorm_u16_f32 v148, v148, v149
    v_pk_add_u16 v147, v146, s8 clamp
    v_pk_fma_f16 v124, v145, s9, v144
    v_cvt_pknorm_u16_f32 v150, v150, v151
    v_pk_add_u16 v149, v148, s8 clamp
    v_pk_fma_f16 v125, v147, s9, v146
    v_pk_add_u16 v151, v150, s8 clamp
    v_pk_fma_f16 v126, v149, s9, v148
    v_pk_fma_f16 v127, v151, s9, v150
    s_waitcnt lgkmcnt(4)
    v_mfma_f32_32x32x16_f16 v[64:79], v[52:55], v[120:123], v[64:79]
    v_cvt_pknorm_u16_f32 v152, v152, v153
    v_cvt_pknorm_u16_f32 v154, v154, v155
    v_pk_add_u16 v153, v152, s8 clamp
    v_cvt_pknorm_u16_f32 v156, v156, v157
    v_pk_add_u16 v155, v154, s8 clamp
    s_waitcnt lgkmcnt(2)
    v_mfma_f32_32x32x16_f16 v[64:79], v[56:59], v[124:127], v[64:79]
    v_pk_fma_f16 v128, v153, s9, v152
    v_cvt_pknorm_u16_f32 v158, v158, v159
    v_pk_add_u16 v157, v156, s8 clamp
    v_pk_fma_f16 v129, v155, s9, v154
    s_waitcnt lgkmcnt(0)
    v_mfma_f32_32x32x16_bf16 v[136:151], v[44:47], v[32:35], 0
    v_cvt_pknorm_u16_f32 v160, v160, v161
    v_pk_add_u16 v159, v158, s8 clamp
    v_pk_fma_f16 v130, v157, s9, v156
    v_cvt_pknorm_u16_f32 v162, v162, v163
    v_mfma_f32_32x32x8_bf16 v[136:151], v[48:49], v[40:41], v[136:151]
    v_pk_add_u16 v161, v160, s8 clamp
    v_pk_fma_f16 v131, v159, s9, v158
    v_cvt_pknorm_u16_f32 v164, v164, v165
    v_pk_add_u16 v163, v162, s8 clamp
    v_pk_fma_f16 v132, v161, s9, v160
    v_cvt_pknorm_u16_f32 v166, v166, v167
    v_pk_add_u16 v165, v164, s8 clamp
    v_pk_fma_f16 v133, v163, s9, v162
    v_pk_add_u16 v167, v166, s8 clamp
    v_pk_fma_f16 v134, v165, s9, v164
    v_pk_fma_f16 v135, v167, s9, v166
    v_mfma_f32_32x32x16_f16 v[80:95], v[52:55], v[128:131], v[80:95]
    v_cvt_pknorm_u16_f32 v136, v136, v137
    v_cvt_pknorm_u16_f32 v138, v138, v139
    v_pk_add_u16 v137, v136, s8 clamp
    v_cvt_pknorm_u16_f32 v140, v140, v141
    v_pk_add_u16 v139, v138, s8 clamp
    v_mfma_f32_32x32x16_f16 v[80:95], v[56:59], v[132:135], v[80:95]
    ds_read_b64_tr_b16 v[52:53], v11 offset:3136
    ds_read_b64_tr_b16 v[54:55], v12 offset:3136
    ds_read_b64_tr_b16 v[56:57], v13 offset:3136
    ds_read_b64_tr_b16 v[58:59], v14 offset:3136
    v_pk_fma_f16 v120, v137, s9, v136
    v_cvt_pknorm_u16_f32 v142, v142, v143
    v_pk_add_u16 v141, v140, s8 clamp
    v_pk_fma_f16 v121, v139, s9, v138
    v_mfma_f32_32x32x16_bf16 v[152:167], v[44:47], v[36:39], 0
    v_cvt_pknorm_u16_f32 v144, v144, v145
    v_pk_add_u16 v143, v142, s8 clamp
    v_pk_fma_f16 v122, v141, s9, v140
    v_cvt_pknorm_u16_f32 v146, v146, v147
    v_mfma_f32_32x32x8_bf16 v[152:167], v[48:49], v[42:43], v[152:167]
    ds_read_b128 v[44:47], v9 offset:6272
    ds_read_b64 v[48:49], v10 offset:6272
    v_pk_add_u16 v145, v144, s8 clamp
    s_setprio 1
    v_pk_fma_f16 v123, v143, s9, v142
    v_cvt_pknorm_u16_f32 v148, v148, v149
    v_pk_add_u16 v147, v146, s8 clamp
    v_pk_fma_f16 v124, v145, s9, v144
    v_cvt_pknorm_u16_f32 v150, v150, v151
    v_pk_add_u16 v149, v148, s8 clamp
    v_pk_fma_f16 v125, v147, s9, v146
    v_pk_add_u16 v151, v150, s8 clamp
    v_pk_fma_f16 v126, v149, s9, v148
    v_pk_fma_f16 v127, v151, s9, v150
    s_waitcnt lgkmcnt(4)
    v_mfma_f32_32x32x16_f16 v[64:79], v[52:55], v[120:123], v[64:79]
    v_cvt_pknorm_u16_f32 v152, v152, v153
    v_cvt_pknorm_u16_f32 v154, v154, v155
    v_pk_add_u16 v153, v152, s8 clamp
    v_cvt_pknorm_u16_f32 v156, v156, v157
    v_pk_add_u16 v155, v154, s8 clamp
    s_waitcnt lgkmcnt(2)
    v_mfma_f32_32x32x16_f16 v[64:79], v[56:59], v[124:127], v[64:79]
    v_pk_fma_f16 v128, v153, s9, v152
    v_cvt_pknorm_u16_f32 v158, v158, v159
    v_pk_add_u16 v157, v156, s8 clamp
    v_pk_fma_f16 v129, v155, s9, v154
    s_waitcnt lgkmcnt(0)
    v_mfma_f32_32x32x16_bf16 v[136:151], v[44:47], v[32:35], 0
    v_cvt_pknorm_u16_f32 v160, v160, v161
    v_pk_add_u16 v159, v158, s8 clamp
    v_pk_fma_f16 v130, v157, s9, v156
    v_cvt_pknorm_u16_f32 v162, v162, v163
    v_mfma_f32_32x32x8_bf16 v[136:151], v[48:49], v[40:41], v[136:151]
    v_pk_add_u16 v161, v160, s8 clamp
    v_pk_fma_f16 v131, v159, s9, v158
    v_cvt_pknorm_u16_f32 v164, v164, v165
    v_pk_add_u16 v163, v162, s8 clamp
    v_pk_fma_f16 v132, v161, s9, v160
    v_cvt_pknorm_u16_f32 v166, v166, v167
    v_pk_add_u16 v165, v164, s8 clamp
    v_pk_fma_f16 v133, v163, s9, v162
    v_pk_add_u16 v167, v166, s8 clamp
    v_pk_fma_f16 v134, v165, s9, v164
    v_pk_fma_f16 v135, v167, s9, v166
    v_mfma_f32_32x32x16_f16 v[80:95], v[52:55], v[128:131], v[80:95]
    v_cvt_pknorm_u16_f32 v136, v136, v137
    v_cvt_pknorm_u16_f32 v138, v138, v139
    v_pk_add_u16 v137, v136, s8 clamp
    v_cvt_pknorm_u16_f32 v140, v140, v141
    v_pk_add_u16 v139, v138, s8 clamp
    v_mfma_f32_32x32x16_f16 v[80:95], v[56:59], v[132:135], v[80:95]
    ds_read_b64_tr_b16 v[52:53], v11 offset:6272
    ds_read_b64_tr_b16 v[54:55], v12 offset:6272
    ds_read_b64_tr_b16 v[56:57], v13 offset:6272
    ds_read_b64_tr_b16 v[58:59], v14 offset:6272
    v_pk_fma_f16 v120, v137, s9, v136
    v_cvt_pknorm_u16_f32 v142, v142, v143
    v_pk_add_u16 v141, v140, s8 clamp
    v_pk_fma_f16 v121, v139, s9, v138
    v_mfma_f32_32x32x16_bf16 v[152:167], v[44:47], v[36:39], 0
    v_cvt_pknorm_u16_f32 v144, v144, v145
    v_pk_add_u16 v143, v142, s8 clamp
    v_pk_fma_f16 v122, v141, s9, v140
    v_cvt_pknorm_u16_f32 v146, v146, v147
    v_mfma_f32_32x32x8_bf16 v[152:167], v[48:49], v[42:43], v[152:167]
    ds_read_b128 v[44:47], v9 offset:9408
    ds_read_b64 v[48:49], v10 offset:9408
    v_pk_add_u16 v145, v144, s8 clamp
    s_setprio 0
    v_pk_fma_f16 v123, v143, s9, v142
    v_cvt_pknorm_u16_f32 v148, v148, v149
    v_pk_add_u16 v147, v146, s8 clamp
    v_pk_fma_f16 v124, v145, s9, v144
    v_cvt_pknorm_u16_f32 v150, v150, v151
    v_pk_add_u16 v149, v148, s8 clamp
    v_pk_fma_f16 v125, v147, s9, v146
    v_pk_add_u16 v151, v150, s8 clamp
    v_pk_fma_f16 v126, v149, s9, v148
    v_pk_fma_f16 v127, v151, s9, v150
    s_waitcnt lgkmcnt(4)
    v_mfma_f32_32x32x16_f16 v[64:79], v[52:55], v[120:123], v[64:79]
    v_cvt_pknorm_u16_f32 v152, v152, v153
    v_cvt_pknorm_u16_f32 v154, v154, v155
    v_pk_add_u16 v153, v152, s8 clamp
    v_cvt_pknorm_u16_f32 v156, v156, v157
    v_pk_add_u16 v155, v154, s8 clamp
    s_waitcnt lgkmcnt(2)
    v_mfma_f32_32x32x16_f16 v[64:79], v[56:59], v[124:127], v[64:79]
    v_pk_fma_f16 v128, v153, s9, v152
    v_cvt_pknorm_u16_f32 v158, v158, v159
    v_pk_add_u16 v157, v156, s8 clamp
    v_pk_fma_f16 v129, v155, s9, v154
    s_waitcnt lgkmcnt(0)
    v_mfma_f32_32x32x16_bf16 v[136:151], v[44:47], v[32:35], 0
    v_cvt_pknorm_u16_f32 v160, v160, v161
    v_pk_add_u16 v159, v158, s8 clamp
    v_pk_fma_f16 v130, v157, s9, v156
    v_cvt_pknorm_u16_f32 v162, v162, v163
    v_mfma_f32_32x32x8_bf16 v[136:151], v[48:49], v[40:41], v[136:151]
    v_pk_add_u16 v161, v160, s8 clamp
    v_pk_fma_f16 v131, v159, s9, v158
    v_cvt_pknorm_u16_f32 v164, v164, v165
    v_pk_add_u16 v163, v162, s8 clamp
    v_pk_fma_f16 v132, v161, s9, v160
    v_cvt_pknorm_u16_f32 v166, v166, v167
    v_pk_add_u16 v165, v164, s8 clamp
    v_pk_fma_f16 v133, v163, s9, v162
    v_pk_add_u16 v167, v166, s8 clamp
    v_pk_fma_f16 v134, v165, s9, v164
    v_pk_fma_f16 v135, v167, s9, v166
    v_mfma_f32_32x32x16_f16 v[80:95], v[52:55], v[128:131], v[80:95]
    s_waitcnt vmcnt(0)
    ds_write_b32 v20, v20 offset:256
    v_cvt_pknorm_u16_f32 v136, v136, v137
    v_cvt_pknorm_u16_f32 v138, v138, v139
    v_pk_add_u16 v137, v136, s8 clamp
    v_cvt_pknorm_u16_f32 v140, v140, v141
    ds_read_b32 v31, v21 offset:256
    v_pk_add_u16 v139, v138, s8 clamp
    v_mfma_f32_32x32x16_f16 v[80:95], v[56:59], v[132:135], v[80:95]
    ds_read_b64_tr_b16 v[52:53], v11 offset:9408
    ds_read_b64_tr_b16 v[54:55], v12 offset:9408
    ds_read_b64_tr_b16 v[56:57], v13 offset:9408
    ds_read_b64_tr_b16 v[58:59], v14 offset:9408
    v_pk_fma_f16 v120, v137, s9, v136
    v_cvt_pknorm_u16_f32 v142, v142, v143
    v_pk_add_u16 v141, v140, s8 clamp
    v_pk_fma_f16 v121, v139, s9, v138
    v_mfma_f32_32x32x16_bf16 v[152:167], v[44:47], v[36:39], 0
    v_cvt_pknorm_u16_f32 v144, v144, v145
    v_pk_add_u16 v143, v142, s8 clamp
    v_pk_fma_f16 v122, v141, s9, v140
    s_waitcnt lgkmcnt(4)
    v_cmp_eq_u32 vcc, 0, v31
    s_nop 0
    s_and_b32 vcc_lo, vcc_lo, s20
    s_cbranch_scc1 L_k2_es0
L_k2_ex0:
    v_cvt_pknorm_u16_f32 v146, v146, v147
    v_mfma_f32_32x32x8_bf16 v[152:167], v[48:49], v[42:43], v[152:167]
    ds_read_b128 v[44:47], v9 offset:25088
    ds_read_b64 v[48:49], v10 offset:25088
    s_setprio 3
    v_pk_add_u16 v145, v144, s8 clamp
    v_pk_fma_f16 v123, v143, s9, v142
    v_cvt_pknorm_u16_f32 v148, v148, v149
    v_pk_add_u16 v147, v146, s8 clamp
    v_pk_fma_f16 v124, v145, s9, v144
    v_cvt_pknorm_u16_f32 v150, v150, v151
    v_pk_add_u16 v149, v148, s8 clamp
    v_pk_fma_f16 v125, v147, s9, v146
    v_pk_add_u16 v151, v150, s8 clamp
    v_pk_fma_f16 v126, v149, s9, v148
    v_pk_fma_f16 v127, v151, s9, v150
    s_waitcnt lgkmcnt(4)
    v_mfma_f32_32x32x16_f16 v[64:79], v[52:55], v[120:123], v[64:79]
    v_cvt_pknorm_u16_f32 v152, v152, v153
    v_cvt_pknorm_u16_f32 v154, v154, v155
    v_pk_add_u16 v153, v152, s8 clamp
    v_cvt_pknorm_u16_f32 v156, v156, v157
    v_pk_add_u16 v155, v154, s8 clamp
    s_waitcnt lgkmcnt(2)
    v_mfma_f32_32x32x16_f16 v[64:79], v[56:59], v[124:127], v[64:79]
    v_pk_fma_f16 v128, v153, s9, v152
    v_cvt_pknorm_u16_f32 v158, v158, v159
    ds_write_b32 v20, v20 offset:288
    v_pk_add_u16 v157, v156, s8 clamp
    v_pk_fma_f16 v129, v155, s9, v154
    s_waitcnt lgkmcnt(1)
    v_mfma_f32_32x32x16_bf16 v[136:151], v[44:47], v[32:35], 0
    v_cvt_pknorm_u16_f32 v160, v160, v161
    v_pk_add_u16 v159, v158, s8 clamp
    v_pk_fma_f16 v130, v157, s9, v156
    v_cvt_pknorm_u16_f32 v162, v162, v163
    v_mfma_f32_32x32x8_bf16 v[136:151], v[48:49], v[40:41], v[136:151]
    v_pk_add_u16 v161, v160, s8 clamp
    v_pk_fma_f16 v131, v159, s9, v158
    v_cvt_pknorm_u16_f32 v164, v164, v165
    v_pk_add_u16 v163, v162, s8 clamp
    v_pk_fma_f16 v132, v161, s9, v160
    v_cvt_pknorm_u16_f32 v166, v166, v167
    v_pk_add_u16 v165, v164, s8 clamp
    v_pk_fma_f16 v133, v163, s9, v162
    v_pk_add_u16 v167, v166, s8 clamp
    v_pk_fma_f16 v134, v165, s9, v164
    v_pk_fma_f16 v135, v167, s9, v166
    v_mfma_f32_32x32x16_f16 v[80:95], v[52:55], v[128:131], v[80:95]
    v_cvt_pknorm_u16_f32 v136, v136, v137
    v_cvt_pknorm_u16_f32 v138, v138, v139
    ds_read_b32 v31, v21 offset:288
    v_pk_add_u16 v137, v136, s8 clamp
    v_cvt_pknorm_u16_f32 v140, v140, v141
    v_pk_add_u16 v139, v138, s8 clamp
    v_mfma_f32_32x32x16_f16 v[80:95], v[56:59], v[132:135], v[80:95]
    ds_read_b64_tr_b16 v[52:53], v11 offset:25088
    ds_read_b64_tr_b16 v[54:55], v12 offset:25088
    ds_read_b64_tr_b16 v[56:57], v13 offset:25088
    ds_read_b64_tr_b16 v[58:59], v14 offset:25088
    v_pk_fma_f16 v120, v137, s9, v136
    v_cvt_pknorm_u16_f32 v142, v142, v143
    v_pk_add_u16 v141, v140, s8 clamp
    v_pk_fma_f16 v121, v139, s9, v138
    v_mfma_f32_32x32x16_bf16 v[152:167], v[44:47], v[36:39], 0
    v_cvt_pknorm_u16_f32 v144, v144, v145
    v_pk_add_u16 v143, v142, s8 clamp
    v_pk_fma_f16 v122, v141, s9, v140
    s_waitcnt lgkmcnt(4)
    v_cmp_eq_u32 vcc, 0, v31
    s_nop 0
    s_and_b32 vcc_lo, vcc_lo, s19
    s_cbranch_scc1 L_k2_es1
L_k2_ex1:
    s_bfe_u32 s24, s18, 393222
    s_mul_i32 s11, s24, 123392
    s_sub_u32 m0, s4, 25088
    s_add_u32 s11, s11, 40960
    buffer_load_dwordx4 v5, s[32:35], s11 offen offset:0 sc1 lds
    buffer_load_dwordx4 v6, s[32:35], s11 offen offset:1024 sc1 lds
    buffer_load_dwordx4 v7, s[32:35], s11 offen offset:2048 sc1 lds
    v_cvt_pknorm_u16_f32 v146, v146, v147
    v_mfma_f32_32x32x8_bf16 v[152:167], v[48:49], v[42:43], v[152:167]
    ds_read_b128 v[44:47], v9 offset:28224
    ds_read_b64 v[48:49], v10 offset:28224
    v_pk_add_u16 v145, v144, s8 clamp
    s_setprio 2
    v_pk_fma_f16 v123, v143, s9, v142
    v_cvt_pknorm_u16_f32 v148, v148, v149
    v_pk_add_u16 v147, v146, s8 clamp
    v_pk_fma_f16 v124, v145, s9, v144
    v_cvt_pknorm_u16_f32 v150, v150, v151
    v_pk_add_u16 v149, v148, s8 clamp
    v_pk_fma_f16 v125, v147, s9, v146
    v_pk_add_u16 v151, v150, s8 clamp
    v_pk_fma_f16 v126, v149, s9, v148
    v_pk_fma_f16 v127, v151, s9, v150
    s_waitcnt lgkmcnt(4)
    v_mfma_f32_32x32x16_f16 v[64:79], v[52:55], v[120:123], v[64:79]
    v_cvt_pknorm_u16_f32 v152, v152, v153
    v_cvt_pknorm_u16_f32 v154, v154, v155
    v_pk_add_u16 v153, v152, s8 clamp
    v_cvt_pknorm_u16_f32 v156, v156, v157
    v_pk_add_u16 v155, v154, s8 clamp
    s_waitcnt lgkmcnt(2)
    v_mfma_f32_32x32x16_f16 v[64:79], v[56:59], v[124:127], v[64:79]
    v_pk_fma_f16 v128, v153, s9, v152
    v_cvt_pknorm_u16_f32 v158, v158, v159
    v_pk_add_u16 v157, v156, s8 clamp
    v_pk_fma_f16 v129, v155, s9, v154
    s_waitcnt lgkmcnt(0)
    v_mfma_f32_32x32x16_bf16 v[136:151], v[44:47], v[32:35], 0
    v_cvt_pknorm_u16_f32 v160, v160, v161
    v_pk_add_u16 v159, v158, s8 clamp
    v_pk_fma_f16 v130, v157, s9, v156
    v_cvt_pknorm_u16_f32 v162, v162, v163
    v_mfma_f32_32x32x8_bf16 v[136:151], v[48:49], v[40:41], v[136:151]
    v_pk_add_u16 v161, v160, s8 clamp
    v_pk_fma_f16 v131, v159, s9, v158
    v_cvt_pknorm_u16_f32 v164, v164, v165
    v_pk_add_u16 v163, v162, s8 clamp
    v_pk_fma_f16 v132, v161, s9, v160
    v_cvt_pknorm_u16_f32 v166, v166, v167
    v_pk_add_u16 v165, v164, s8 clamp
    v_pk_fma_f16 v133, v163, s9, v162
    v_pk_add_u16 v167, v166, s8 clamp
    v_pk_fma_f16 v134, v165, s9, v164
    v_pk_fma_f16 v135, v167, s9, v166
    v_mfma_f32_32x32x16_f16 v[80:95], v[52:55], v[128:131], v[80:95]
    v_cvt_pknorm_u16_f32 v136, v136, v137
    v_cvt_pknorm_u16_f32 v138, v138, v139
    v_pk_add_u16 v137, v136, s8 clamp
    v_cvt_pknorm_u16_f32 v140, v140, v141
    v_pk_add_u16 v139, v138, s8 clamp
    v_mfma_f32_32x32x16_f16 v[80:95], v[56:59], v[132:135], v[80:95]
    ds_read_b64_tr_b16 v[52:53], v11 offset:28224
    ds_read_b64_tr_b16 v[54:55], v12 offset:28224
    ds_read_b64_tr_b16 v[56:57], v13 offset:28224
    ds_read_b64_tr_b16 v[58:59], v14 offset:28224
    v_pk_fma_f16 v120, v137, s9, v136
    v_cvt_pknorm_u16_f32 v142, v142, v143
    v_pk_add_u16 v141, v140, s8 clamp
    v_pk_fma_f16 v121, v139, s9, v138
    v_mfma_f32_32x32x16_bf16 v[152:167], v[44:47], v[36:39], 0
    v_cvt_pknorm_u16_f32 v144, v144, v145
    v_pk_add_u16 v143, v142, s8 clamp
    v_pk_fma_f16 v122, v141, s9, v140
    v_cvt_pknorm_u16_f32 v146, v146, v147
    v_mfma_f32_32x32x8_bf16 v[152:167], v[48:49], v[42:43], v[152:167]
    ds_read_b128 v[44:47], v9 offset:31360
    ds_read_b64 v[48:49], v10 offset:31360
    v_pk_add_u16 v145, v144, s8 clamp
    s_setprio 1
    v_pk_fma_f16 v123, v143, s9, v142
    v_cvt_pknorm_u16_f32 v148, v148, v149
    v_pk_add_u16 v147, v146, s8 clamp
    v_pk_fma_f16 v124, v145, s9, v144
    v_cvt_pknorm_u16_f32 v150, v150, v151
    v_pk_add_u16 v149, v148, s8 clamp
    v_pk_fma_f16 v125, v147, s9, v146
    v_pk_add_u16 v151, v150, s8 clamp
    v_pk_fma_f16 v126, v149, s9, v148
    v_pk_fma_f16 v127, v151, s9, v150
    s_waitcnt lgkmcnt(4)
    v_mfma_f32_32x32x16_f16 v[64:79], v[52:55], v[120:123], v[64:79]
    v_cvt_pknorm_u16_f32 v152, v152, v153
    v_cvt_pknorm_u16_f32 v154, v154, v155
    v_pk_add_u16 v153, v152, s8 clamp
    v_cvt_pknorm_u16_f32 v156, v156, v157
    v_pk_add_u16 v155, v154, s8 clamp
    s_waitcnt lgkmcnt(2)
    v_mfma_f32_32x32x16_f16 v[64:79], v[56:59], v[124:127], v[64:79]
    v_pk_fma_f16 v128, v153, s9, v152
    v_cvt_pknorm_u16_f32 v158, v158, v159
    v_pk_add_u16 v157, v156, s8 clamp
    v_pk_fma_f16 v129, v155, s9, v154
    s_waitcnt lgkmcnt(0)
    v_mfma_f32_32x32x16_bf16 v[136:151], v[44:47], v[32:35], 0
    v_cvt_pknorm_u16_f32 v160, v160, v161
    v_pk_add_u16 v159, v158, s8 clamp
    v_pk_fma_f16 v130, v157, s9, v156
    v_cvt_pknorm_u16_f32 v162, v162, v163
    v_mfma_f32_32x32x8_bf16 v[136:151], v[48:49], v[40:41], v[136:151]
    v_pk_add_u16 v161, v160, s8 clamp
    v_pk_fma_f16 v131, v159, s9, v158
    v_cvt_pknorm_u16_f32 v164, v164, v165
    v_pk_add_u16 v163, v162, s8 clamp
    v_pk_fma_f16 v132, v161, s9, v160
    v_cvt_pknorm_u16_f32 v166, v166, v167
    v_pk_add_u16 v165, v164, s8 clamp
    v_pk_fma_f16 v133, v163, s9, v162
    v_pk_add_u16 v167, v166, s8 clamp
    v_pk_fma_f16 v134, v165, s9, v164
    v_pk_fma_f16 v135, v167, s9, v166
    v_mfma_f32_32x32x16_f16 v[80:95], v[52:55], v[128:131], v[80:95]
    v_cvt_pknorm_u16_f32 v136, v136, v137
    v_cvt_pknorm_u16_f32 v138, v138, v139
    v_pk_add_u16 v137, v136, s8 clamp
    v_cvt_pknorm_u16_f32 v140, v140, v141
    v_pk_add_u16 v139, v138, s8 clamp
    v_mfma_f32_32x32x16_f16 v[80:95], v[56:59], v[132:135], v[80:95]
    ds_read_b64_tr_b16 v[52:53], v11 offset:31360
    ds_read_b64_tr_b16 v[54:55], v12 offset:31360
    ds_read_b64_tr_b16 v[56:57], v13 offset:31360
    ds_read_b64_tr_b16 v[58:59], v14 offset:31360
    v_pk_fma_f16 v120, v137, s9, v136
    v_cvt_pknorm_u16_f32 v142, v142, v143
    v_pk_add_u16 v141, v140, s8 clamp
    v_pk_fma_f16 v121, v139, s9, v138
    v_mfma_f32_32x32x16_bf16 v[152:167], v[44:47], v[36:39], 0
    v_cvt_pknorm_u16_f32 v144, v144, v145
    v_pk_add_u16 v143, v142, s8 clamp
    v_pk_fma_f16 v122, v141, s9, v140
    v_cvt_pknorm_u16_f32 v146, v146, v147
    v_mfma_f32_32x32x8_bf16 v[152:167], v[48:49], v[42:43], v[152:167]
    ds_read_b128 v[44:47], v9 offset:34496
    ds_read_b64 v[48:49], v10 offset:34496
    v_pk_add_u16 v145, v144, s8 clamp
    s_setprio 0
    v_pk_fma_f16 v123, v143, s9, v142
    v_cvt_pknorm_u16_f32 v148, v148, v149
    v_pk_add_u16 v147, v146, s8 clamp
    v_pk_fma_f16 v124, v145, s9, v144
    v_cvt_pknorm_u16_f32 v150, v150, v151
    v_pk_add_u16 v149, v148, s8 clamp
    v_pk_fma_f16 v125, v147, s9, v146
    v_pk_add_u16 v151, v150, s8 clamp
    v_pk_fma_f16 v126, v149, s9, v148
    v_pk_fma_f16 v127, v151, s9, v150
    s_waitcnt lgkmcnt(4)
    v_mfma_f32_32x32x16_f16 v[64:79], v[52:55], v[120:123], v[64:79]
    v_cvt_pknorm_u16_f32 v152, v152, v153
    v_cvt_pknorm_u16_f32 v154, v154, v155
    v_pk_add_u16 v153, v152, s8 clamp
    v_cvt_pknorm_u16_f32 v156, v156, v157
    v_pk_add_u16 v155, v154, s8 clamp
    s_waitcnt lgkmcnt(2)
    v_mfma_f32_32x32x16_f16 v[64:79], v[56:59], v[124:127], v[64:79]
    v_pk_fma_f16 v128, v153, s9, v152
    v_cvt_pknorm_u16_f32 v158, v158, v159
    v_pk_add_u16 v157, v156, s8 clamp
    v_pk_fma_f16 v129, v155, s9, v154
    s_waitcnt lgkmcnt(0)
    v_mfma_f32_32x32x16_bf16 v[136:151], v[44:47], v[32:35], 0
    v_cvt_pknorm_u16_f32 v160, v160, v161
    v_pk_add_u16 v159, v158, s8 clamp
    v_pk_fma_f16 v130, v157, s9, v156
    v_cvt_pknorm_u16_f32 v162, v162, v163
    v_mfma_f32_32x32x8_bf16 v[136:151], v[48:49], v[40:41], v[136:151]
    v_pk_add_u16 v161, v160, s8 clamp
    v_pk_fma_f16 v131, v159, s9, v158
    v_cvt_pknorm_u16_f32 v164, v164, v165
    v_pk_add_u16 v163, v162, s8 clamp
    v_pk_fma_f16 v132, v161, s9, v160
    v_cvt_pknorm_u16_f32 v166, v166, v167
    v_pk_add_u16 v165, v164, s8 clamp
    v_pk_fma_f16 v133, v163, s9, v162
    v_pk_add_u16 v167, v166, s8 clamp
    v_pk_fma_f16 v134, v165, s9, v164
    v_pk_fma_f16 v135, v167, s9, v166
    v_mfma_f32_32x32x16_f16 v[80:95], v[52:55], v[128:131], v[80:95]
    s_waitcnt vmcnt(0)
    ds_write_b32 v20, v20 offset:320
    v_cvt_pknorm_u16_f32 v136, v136, v137
    v_cvt_pknorm_u16_f32 v138, v138, v139
    v_pk_add_u16 v137, v136, s8 clamp
    v_cvt_pknorm_u16_f32 v140, v140, v141
    ds_read_b32 v31, v21 offset:320
    v_pk_add_u16 v139, v138, s8 clamp
    v_mfma_f32_32x32x16_f16 v[80:95], v[56:59], v[132:135], v[80:95]
    ds_read_b64_tr_b16 v[52:53], v11 offset:34496
    ds_read_b64_tr_b16 v[54:55], v12 offset:34496
    ds_read_b64_tr_b16 v[56:57], v13 offset:34496
    ds_read_b64_tr_b16 v[58:59], v14 offset:34496
    v_pk_fma_f16 v120, v137, s9, v136
    v_cvt_pknorm_u16_f32 v142, v142, v143
    v_pk_add_u16 v141, v140, s8 clamp
    v_pk_fma_f16 v121, v139, s9, v138
    v_mfma_f32_32x32x16_bf16 v[152:167], v[44:47], v[36:39], 0
    v_cvt_pknorm_u16_f32 v144, v144, v145
    v_pk_add_u16 v143, v142, s8 clamp
    v_pk_fma_f16 v122, v141, s9, v140
    s_waitcnt lgkmcnt(4)
    v_cmp_eq_u32 vcc, 0, v31
    s_nop 0
    s_and_b32 vcc_lo, vcc_lo, s20
    s_cbranch_scc1 L_k2_es2
L_k2_ex2:
    v_cvt_pknorm_u16_f32 v146, v146, v147
    v_mfma_f32_32x32x8_bf16 v[152:167], v[48:49], v[42:43], v[152:167]
    ds_read_b128 v[44:47], v9 offset:0
    ds_read_b64 v[48:49], v10 offset:0
    s_setprio 3
    v_pk_add_u16 v145, v144, s8 clamp
    v_pk_fma_f16 v123, v143, s9, v142
    v_cvt_pknorm_u16_f32 v148, v148, v149
    v_pk_add_u16 v147, v146, s8 clamp
    v_pk_fma_f16 v124, v145, s9, v144
    v_cvt_pknorm_u16_f32 v150, v150, v151
    v_pk_add_u16 v149, v148, s8 clamp
    v_pk_fma_f16 v125, v147, s9, v146
    v_pk_add_u16 v151, v150, s8 clamp
    v_pk_fma_f16 v126, v149, s9, v148
    v_pk_fma_f16 v127, v151, s9, v150
    s_waitcnt lgkmcnt(4)
    v_mfma_f32_32x32x16_f16 v[64:79], v[52:55], v[120:123], v[64:79]
    v_cvt_pknorm_u16_f32 v152, v152, v153
    v_cvt_pknorm_u16_f32 v154, v154, v155
    v_pk_add_u16 v153, v152, s8 clamp
    v_cvt_pknorm_u16_f32 v156, v156, v157
    v_pk_add_u16 v155, v154, s8 clamp
    s_waitcnt lgkmcnt(2)
    v_mfma_f32_32x32x16_f16 v[64:79], v[56:59], v[124:127], v[64:79]
    v_pk_fma_f16 v128, v153, s9, v152
    v_cvt_pknorm_u16_f32 v158, v158, v159
    ds_write_b32 v20, v20 offset:352
    v_pk_add_u16 v157, v156, s8 clamp
    v_pk_fma_f16 v129, v155, s9, v154
    s_waitcnt lgkmcnt(1)
    v_mfma_f32_32x32x16_bf16 v[136:151], v[44:47], v[32:35], 0
    v_cvt_pknorm_u16_f32 v160, v160, v161
    v_pk_add_u16 v159, v158, s8 clamp
    v_pk_fma_f16 v130, v157, s9, v156
    v_cvt_pknorm_u16_f32 v162, v162, v163
    v_mfma_f32_32x32x8_bf16 v[136:151], v[48:49], v[40:41], v[136:151]
    v_pk_add_u16 v161, v160, s8 clamp
    v_pk_fma_f16 v131, v159, s9, v158
    v_cvt_pknorm_u16_f32 v164, v164, v165
    v_pk_add_u16 v163, v162, s8 clamp
    v_pk_fma_f16 v132, v161, s9, v160
    v_cvt_pknorm_u16_f32 v166, v166, v167
    v_pk_add_u16 v165, v164, s8 clamp
    v_pk_fma_f16 v133, v163, s9, v162
    v_pk_add_u16 v167, v166, s8 clamp
    v_pk_fma_f16 v134, v165, s9, v164
    v_pk_fma_f16 v135, v167, s9, v166
    v_mfma_f32_32x32x16_f16 v[80:95], v[52:55], v[128:131], v[80:95]
    v_cvt_pknorm_u16_f32 v136, v136, v137
    v_cvt_pknorm_u16_f32 v138, v138, v139
    ds_read_b32 v31, v21 offset:352
    v_pk_add_u16 v137, v136, s8 clamp
    v_cvt_pknorm_u16_f32 v140, v140, v141
    v_pk_add_u16 v139, v138, s8 clamp
    v_mfma_f32_32x32x16_f16 v[80:95], v[56:59], v[132:135], v[80:95]
    ds_read_b64_tr_b16 v[52:53], v11 offset:0
    ds_read_b64_tr_b16 v[54:55], v12 offset:0
    ds_read_b64_tr_b16 v[56:57], v13 offset:0
    ds_read_b64_tr_b16 v[58:59], v14 offset:0
    v_pk_fma_f16 v120, v137, s9, v136
    v_cvt_pknorm_u16_f32 v142, v142, v143
    v_pk_add_u16 v141, v140, s8 clamp
    v_pk_fma_f16 v121, v139, s9, v138
    v_mfma_f32_32x32x16_bf16 v[152:167], v[44:47], v[36:39], 0
    v_cvt_pknorm_u16_f32 v144, v144, v145
    v_pk_add_u16 v143, v142, s8 clamp
    v_pk_fma_f16 v122, v141, s9, v140
    s_waitcnt lgkmcnt(4)
    v_cmp_eq_u32 vcc, 0, v31
    s_nop 0
    s_and_b32 vcc_lo, vcc_lo, s19
    s_cbranch_scc1 L_k2_es3
L_k2_ex3:
    s_bfe_u32 s24, s18, 393228
    s_mul_i32 s11, s24, 123392
    s_sub_u32 m0, s4, 0
    s_add_u32 s11, s11, 40960
    buffer_load_dwordx4 v5, s[32:35], s11 offen offset:0 sc1 lds
    buffer_load_dwordx4 v6, s[32:35], s11 offen offset:1024 sc1 lds
    buffer_load_dwordx4 v7, s[32:35], s11 offen offset:2048 sc1 lds
    v_cvt_pknorm_u16_f32 v146, v146, v147
    v_mfma_f32_32x32x8_bf16 v[152:167], v[48:49], v[42:43], v[152:167]
    ds_read_b128 v[44:47], v9 offset:3136
    ds_read_b64 v[48:49], v10 offset:3136
    v_pk_add_u16 v145, v144, s8 clamp
    s_setprio 2
    v_pk_fma_f16 v123, v143, s9, v142
    v_cvt_pknorm_u16_f32 v148, v148, v149
    v_pk_add_u16 v147, v146, s8 clamp
    v_pk_fma_f16 v124, v145, s9, v144
    v_cvt_pknorm_u16_f32 v150, v150, v151
    v_pk_add_u16 v149, v148, s8 clamp
    v_pk_fma_f16 v125, v147, s9, v146
    v_pk_add_u16 v151, v150, s8 clamp
    v_pk_fma_f16 v126, v149, s9, v148
    v_pk_fma_f16 v127, v151, s9, v150
    s_waitcnt lgkmcnt(4)
    v_mfma_f32_32x32x16_f16 v[64:79], v[52:55], v[120:123], v[64:79]
    v_cvt_pknorm_u16_f32 v152, v152, v153
    v_cvt_pknorm_u16_f32 v154, v154, v155
    v_pk_add_u16 v153, v152, s8 clamp
    v_cvt_pknorm_u16_f32 v156, v156, v157
    v_pk_add_u16 v155, v154, s8 clamp
    s_waitcnt lgkmcnt(2)
    v_mfma_f32_32x32x16_f16 v[64:79], v[56:59], v[124:127], v[64:79]
    v_pk_fma_f16 v128, v153, s9, v152
    v_cvt_pknorm_u16_f32 v158, v158, v159
    v_pk_add_u16 v157, v156, s8 clamp
    v_pk_fma_f16 v129, v155, s9, v154
    s_waitcnt lgkmcnt(0)
    v_mfma_f32_32x32x16_bf16 v[136:151], v[44:47], v[32:35], 0
    v_cvt_pknorm_u16_f32 v160, v160, v161
    v_pk_add_u16 v159, v158, s8 clamp
    v_pk_fma_f16 v130, v157, s9, v156
    v_cvt_pknorm_u16_f32 v162, v162, v163
    v_mfma_f32_32x32x8_bf16 v[136:151], v[48:49], v[40:41], v[136:151]
    v_pk_add_u16 v161, v160, s8 clamp
    v_pk_fma_f16 v131, v159, s9, v158
    v_cvt_pknorm_u16_f32 v164, v164, v165
    v_pk_add_u16 v163, v162, s8 clamp
    v_pk_fma_f16 v132, v161, s9, v160
    v_cvt_pknorm_u16_f32 v166, v166, v167
    v_pk_add_u16 v165, v164, s8 clamp
    v_pk_fma_f16 v133, v163, s9, v162
    v_pk_add_u16 v167, v166, s8 clamp
    v_pk_fma_f16 v134, v165, s9, v164
    v_pk_fma_f16 v135, v167, s9, v166
    v_mfma_f32_32x32x16_f16 v[80:95], v[52:55], v[128:131], v[80:95]
    v_cvt_pknorm_u16_f32 v136, v136, v137
    v_cvt_pknorm_u16_f32 v138, v138, v139
    v_pk_add_u16 v137, v136, s8 clamp
    v_cvt_pknorm_u16_f32 v140, v140, v141
    v_pk_add_u16 v139, v138, s8 clamp
    v_mfma_f32_32x32x16_f16 v[80:95], v[56:59], v[132:135], v[80:95]
    ds_read_b64_tr_b16 v[52:53], v11 offset:3136
    ds_read_b64_tr_b16 v[54:55], v12 offset:3136
    ds_read_b64_tr_b16 v[56:57], v13 offset:3136
    ds_read_b64_tr_b16 v[58:59], v14 offset:3136
    v_pk_fma_f16 v120, v137, s9, v136
    v_cvt_pknorm_u16_f32 v142, v142, v143
    v_pk_add_u16 v141, v140, s8 clamp
    v_pk_fma_f16 v121, v139, s9, v138
    v_mfma_f32_32x32x16_bf16 v[152:167], v[44:47], v[36:39], 0
    v_cvt_pknorm_u16_f32 v144, v144, v145
    v_pk_add_u16 v143, v142, s8 clamp
    v_pk_fma_f16 v122, v141, s9, v140
    v_cvt_pknorm_u16_f32 v146, v146, v147
    v_mfma_f32_32x32x8_bf16 v[152:167], v[48:49], v[42:43], v[152:167]
    ds_read_b128 v[44:47], v9 offset:6272
    ds_read_b64 v[48:49], v10 offset:6272
    v_pk_add_u16 v145, v144, s8 clamp
    s_setprio 1
    v_pk_fma_f16 v123, v143, s9, v142
    v_cvt_pknorm_u16_f32 v148, v148, v149
    v_pk_add_u16 v147, v146, s8 clamp
    v_pk_fma_f16 v124, v145, s9, v144
    v_cvt_pknorm_u16_f32 v150, v150, v151
    v_pk_add_u16 v149, v148, s8 clamp
    v_pk_fma_f16 v125, v147, s9, v146
    v_pk_add_u16 v151, v150, s8 clamp
    v_pk_fma_f16 v126, v149, s9, v148
    v_pk_fma_f16 v127, v151, s9, v150
    s_waitcnt lgkmcnt(4)
    v_mfma_f32_32x32x16_f16 v[64:79], v[52:55], v[120:123], v[64:79]
    v_cvt_pknorm_u16_f32 v152, v152, v153
    v_cvt_pknorm_u16_f32 v154, v154, v155
    v_pk_add_u16 v153, v152, s8 clamp
    v_cvt_pknorm_u16_f32 v156, v156, v157
    v_pk_add_u16 v155, v154, s8 clamp
    s_waitcnt lgkmcnt(2)
    v_mfma_f32_32x32x16_f16 v[64:79], v[56:59], v[124:127], v[64:79]
    v_pk_fma_f16 v128, v153, s9, v152
    v_cvt_pknorm_u16_f32 v158, v158, v159
    v_pk_add_u16 v157, v156, s8 clamp
    v_pk_fma_f16 v129, v155, s9, v154
    s_waitcnt lgkmcnt(0)
    v_mfma_f32_32x32x16_bf16 v[136:151], v[44:47], v[32:35], 0
    v_cvt_pknorm_u16_f32 v160, v160, v161
    v_pk_add_u16 v159, v158, s8 clamp
    v_pk_fma_f16 v130, v157, s9, v156
    v_cvt_pknorm_u16_f32 v162, v162, v163
    v_mfma_f32_32x32x8_bf16 v[136:151], v[48:49], v[40:41], v[136:151]
    v_pk_add_u16 v161, v160, s8 clamp
    v_pk_fma_f16 v131, v159, s9, v158
    v_cvt_pknorm_u16_f32 v164, v164, v165
    v_pk_add_u16 v163, v162, s8 clamp
    v_pk_fma_f16 v132, v161, s9, v160
    v_cvt_pknorm_u16_f32 v166, v166, v167
    v_pk_add_u16 v165, v164, s8 clamp
    v_pk_fma_f16 v133, v163, s9, v162
    v_pk_add_u16 v167, v166, s8 clamp
    v_pk_fma_f16 v134, v165, s9, v164
    v_pk_fma_f16 v135, v167, s9, v166
    v_mfma_f32_32x32x16_f16 v[80:95], v[52:55], v[128:131], v[80:95]
    v_cvt_pknorm_u16_f32 v136, v136, v137
    v_cvt_pknorm_u16_f32 v138, v138, v139
    v_pk_add_u16 v137, v136, s8 clamp
    v_cvt_pknorm_u16_f32 v140, v140, v141
    v_pk_add_u16 v139, v138, s8 clamp
    v_mfma_f32_32x32x16_f16 v[80:95], v[56:59], v[132:135], v[80:95]
    ds_read_b64_tr_b16 v[52:53], v11 offset:6272
    ds_read_b64_tr_b16 v[54:55], v12 offset:6272
    ds_read_b64_tr_b16 v[56:57], v13 offset:6272
    ds_read_b64_tr_b16 v[58:59], v14 offset:6272
    v_pk_fma_f16 v120, v137, s9, v136
    v_cvt_pknorm_u16_f32 v142, v142, v143
    v_pk_add_u16 v141, v140, s8 clamp
    v_pk_fma_f16 v121, v139, s9, v138
    v_mfma_f32_32x32x16_bf16 v[152:167], v[44:47], v[36:39], 0
    v_cvt_pknorm_u16_f32 v144, v144, v145
    v_pk_add_u16 v143, v142, s8 clamp
    v_pk_fma_f16 v122, v141, s9, v140
    v_cvt_pknorm_u16_f32 v146, v146, v147
    v_mfma_f32_32x32x8_bf16 v[152:167], v[48:49], v[42:43], v[152:167]
    ds_read_b128 v[44:47], v9 offset:9408
    ds_read_b64 v[48:49], v10 offset:9408
    v_pk_add_u16 v145, v144, s8 clamp
    s_setprio 0
    v_pk_fma_f16 v123, v143, s9, v142
    v_cvt_pknorm_u16_f32 v148, v148, v149
    v_pk_add_u16 v147, v146, s8 clamp
    v_pk_fma_f16 v124, v145, s9, v144
    v_cvt_pknorm_u16_f32 v150, v150, v151
    v_pk_add_u16 v149, v148, s8 clamp
    v_pk_fma_f16 v125, v147, s9, v146
    v_pk_add_u16 v151, v150, s8 clamp
    v_pk_fma_f16 v126, v149, s9, v148
    v_pk_fma_f16 v127, v151, s9, v150
    s_waitcnt lgkmcnt(4)
    v_mfma_f32_32x32x16_f16 v[64:79], v[52:55], v[120:123], v[64:79]
    v_cvt_pknorm_u16_f32 v152, v152, v153
    v_cvt_pknorm_u16_f32 v154, v154, v155
    v_pk_add_u16 v153, v152, s8 clamp
    v_cvt_pknorm_u16_f32 v156, v156, v157
    v_pk_add_u16 v155, v154, s8 clamp
    s_waitcnt lgkmcnt(2)
    v_mfma_f32_32x32x16_f16 v[64:79], v[56:59], v[124:127], v[64:79]
    v_pk_fma_f16 v128, v153, s9, v152
    v_cvt_pknorm_u16_f32 v158, v158, v159
    v_pk_add_u16 v157, v156, s8 clamp
    v_pk_fma_f16 v129, v155, s9, v154
    s_waitcnt lgkmcnt(0)
    v_mfma_f32_32x32x16_bf16 v[136:151], v[44:47], v[32:35], 0
    v_cvt_pknorm_u16_f32 v160, v160, v161
    v_pk_add_u16 v159, v158, s8 clamp
    v_pk_fma_f16 v130, v157, s9, v156
    v_cvt_pknorm_u16_f32 v162, v162, v163
    v_mfma_f32_32x32x8_bf16 v[136:151], v[48:49], v[40:41], v[136:151]
    v_pk_add_u16 v161, v160, s8 clamp
    v_pk_fma_f16 v131, v159, s9, v158
    v_cvt_pknorm_u16_f32 v164, v164, v165
    v_pk_add_u16 v163, v162, s8 clamp
    v_pk_fma_f16 v132, v161, s9, v160
    v_cvt_pknorm_u16_f32 v166, v166, v167
    v_pk_add_u16 v165, v164, s8 clamp
    v_pk_fma_f16 v133, v163, s9, v162
    v_pk_add_u16 v167, v166, s8 clamp
    v_pk_fma_f16 v134, v165, s9, v164
    v_pk_fma_f16 v135, v167, s9, v166
    v_mfma_f32_32x32x16_f16 v[80:95], v[52:55], v[128:131], v[80:95]
    s_waitcnt vmcnt(0)
    ds_write_b32 v20, v20 offset:384
    v_cvt_pknorm_u16_f32 v136, v136, v137
    v_cvt_pknorm_u16_f32 v138, v138, v139
    v_pk_add_u16 v137, v136, s8 clamp
    v_cvt_pknorm_u16_f32 v140, v140, v141
    ds_read_b32 v31, v21 offset:384
    v_pk_add_u16 v139, v138, s8 clamp
    v_mfma_f32_32x32x16_f16 v[80:95], v[56:59], v[132:135], v[80:95]
    ds_read_b64_tr_b16 v[52:53], v11 offset:9408
    ds_read_b64_tr_b16 v[54:55], v12 offset:9408
    ds_read_b64_tr_b16 v[56:57], v13 offset:9408
    ds_read_b64_tr_b16 v[58:59], v14 offset:9408
    v_pk_fma_f16 v120, v137, s9, v136
    v_cvt_pknorm_u16_f32 v142, v142, v143
    v_pk_add_u16 v141, v140, s8 clamp
    v_pk_fma_f16 v121, v139, s9, v138
    v_mfma_f32_32x32x16_bf16 v[152:167], v[44:47], v[36:39], 0
    v_cvt_pknorm_u16_f32 v144, v144, v145
    v_pk_add_u16 v143, v142, s8 clamp
    v_pk_fma_f16 v122, v141, s9, v140
    s_waitcnt lgkmcnt(4)
    v_cmp_eq_u32 vcc, 0, v31
    s_nop 0
    s_and_b32 vcc_lo, vcc_lo, s20
    s_cbranch_scc1 L_k2_es4
L_k2_ex4:
    v_cvt_pknorm_u16_f32 v146, v146, v147
    v_mfma_f32_32x32x8_bf16 v[152:167], v[48:49], v[42:43], v[152:167]
    s_waitcnt lgkmcnt(0)
    s_memrealtime s[36:37]
    s_memtime s[38:39]
    s_waitcnt lgkmcnt(0)
    ds_read_b128 v[44:47], v9 offset:25088
    ds_read_b64 v[48:49], v10 offset:25088
    s_setprio 3
    v_pk_add_u16 v145, v144, s8 clamp
    v_pk_fma_f16 v123, v143, s9, v142
    v_cvt_pknorm_u16_f32 v148, v148, v149
    v_pk_add_u16 v147, v146, s8 clamp
    v_pk_fma_f16 v124, v145, s9, v144
    v_cvt_pknorm_u16_f32 v150, v150, v151
    v_pk_add_u16 v149, v148, s8 clamp
    v_pk_fma_f16 v125, v147, s9, v146
    v_pk_add_u16 v151, v150, s8 clamp
    v_pk_fma_f16 v126, v149, s9, v148
    v_pk_fma_f16 v127, v151, s9, v150
    v_mfma_f32_32x32x16_f16 v[64:79], v[52:55], v[120:123], v[64:79]
    v_cvt_pknorm_u16_f32 v152, v152, v153
    v_cvt_pknorm_u16_f32 v154, v154, v155
    v_pk_add_u16 v153, v152, s8 clamp
    v_cvt_pknorm_u16_f32 v156, v156, v157
    v_pk_add_u16 v155, v154, s8 clamp
    v_mfma_f32_32x32x16_f16 v[64:79], v[56:59], v[124:127], v[64:79]
    v_pk_fma_f16 v128, v153, s9, v152
    v_cvt_pknorm_u16_f32 v158, v158, v159
    ds_write_b32 v20, v20 offset:416
    v_pk_add_u16 v157, v156, s8 clamp
    v_pk_fma_f16 v129, v155, s9, v154
    s_waitcnt lgkmcnt(1)
    v_mfma_f32_32x32x16_bf16 v[136:151], v[44:47], v[32:35], 0
    v_cvt_pknorm_u16_f32 v160, v160, v161
    v_pk_add_u16 v159, v158, s8 clamp
    v_pk_fma_f16 v130, v157, s9, v156
    v_cvt_pknorm_u16_f32 v162, v162, v163
    v_mfma_f32_32x32x8_bf16 v[136:151], v[48:49], v[40:41], v[136:151]
    v_pk_add_u16 v161, v160, s8 clamp
    v_pk_fma_f16 v131, v159, s9, v158
    v_cvt_pknorm_u16_f32 v164, v164, v165
    v_pk_add_u16 v163, v162, s8 clamp
    v_pk_fma_f16 v132, v161, s9, v160
    v_cvt_pknorm_u16_f32 v166, v166, v167
    v_pk_add_u16 v165, v164, s8 clamp
    v_pk_fma_f16 v133, v163, s9, v162
    v_pk_add_u16 v167, v166, s8 clamp
    v_pk_fma_f16 v134, v165, s9, v164
    v_pk_fma_f16 v135, v167, s9, v166
    v_mfma_f32_32x32x16_f16 v[80:95], v[52:55], v[128:131], v[80:95]
    v_cvt_pknorm_u16_f32 v136, v136, v137
    v_cvt_pknorm_u16_f32 v138, v138, v139
    ds_read_b32 v31, v21 offset:416
    v_pk_add_u16 v137, v136, s8 clamp
    v_cvt_pknorm_u16_f32 v140, v140, v141
    v_pk_add_u16 v139, v138, s8 clamp
    v_mfma_f32_32x32x16_f16 v[80:95], v[56:59], v[132:135], v[80:95]
    ds_read_b64_tr_b16 v[52:53], v11 offset:25088
    ds_read_b64_tr_b16 v[54:55], v12 offset:25088
    ds_read_b64_tr_b16 v[56:57], v13 offset:25088
    ds_read_b64_tr_b16 v[58:59], v14 offset:25088
    v_pk_fma_f16 v120, v137, s9, v136
    v_cvt_pknorm_u16_f32 v142, v142, v143
    v_pk_add_u16 v141, v140, s8 clamp
    v_pk_fma_f16 v121, v139, s9, v138
    v_mfma_f32_32x32x16_bf16 v[152:167], v[44:47], v[36:39], 0
    v_cvt_pknorm_u16_f32 v144, v144, v145
    v_pk_add_u16 v143, v142, s8 clamp
    v_pk_fma_f16 v122, v141, s9, v140
    s_waitcnt lgkmcnt(4)
    v_cmp_eq_u32 vcc, 0, v31
    s_nop 0
    s_and_b32 vcc_lo, vcc_lo, s19
    s_cbranch_scc1 L_k2_es5
L_k2_ex5:
    s_bfe_u32 s24, s18, 393234
    s_mul_i32 s11, s24, 123392
    s_sub_u32 m0, s4, 25088
    s_add_u32 s11, s11, 40960
    buffer_load_dwordx4 v5, s[32:35], s11 offen offset:0 sc1 lds
    buffer_load_dwordx4 v6, s[32:35], s11 offen offset:1024 sc1 lds
    buffer_load_dwordx4 v7, s[32:35], s11 offen offset:2048 sc1 lds
    v_cvt_pknorm_u16_f32 v146, v146, v147
    v_mfma_f32_32x32x8_bf16 v[152:167], v[48:49], v[42:43], v[152:167]
    ds_read_b128 v[44:47], v9 offset:28224
    ds_read_b64 v[48:49], v10 offset:28224
    v_pk_add_u16 v145, v144, s8 clamp
    s_setprio 2
    v_pk_fma_f16 v123, v143, s9, v142
    v_cvt_pknorm_u16_f32 v148, v148, v149
    v_pk_add_u16 v147, v146, s8 clamp
    v_pk_fma_f16 v124, v145, s9, v144
    v_cvt_pknorm_u16_f32 v150, v150, v151
    v_pk_add_u16 v149, v148, s8 clamp
    v_pk_fma_f16 v125, v147, s9, v146
    v_pk_add_u16 v151, v150, s8 clamp
    v_pk_fma_f16 v126, v149, s9, v148
    v_pk_fma_f16 v127, v151, s9, v150
    s_waitcnt lgkmcnt(4)
    v_mfma_f32_32x32x16_f16 v[64:79], v[52:55], v[120:123], v[64:79]
    v_cvt_pknorm_u16_f32 v152, v152, v153
    v_cvt_pknorm_u16_f32 v154, v154, v155
    v_pk_add_u16 v153, v152, s8 clamp
    v_cvt_pknorm_u16_f32 v156, v156, v157
    v_pk_add_u16 v155, v154, s8 clamp
    s_waitcnt lgkmcnt(2)
    v_mfma_f32_32x32x16_f16 v[64:79], v[56:59], v[124:127], v[64:79]
    v_pk_fma_f16 v128, v153, s9, v152
    v_cvt_pknorm_u16_f32 v158, v158, v159
    v_pk_add_u16 v157, v156, s8 clamp
    v_pk_fma_f16 v129, v155, s9, v154
    s_waitcnt lgkmcnt(0)
    v_mfma_f32_32x32x16_bf16 v[136:151], v[44:47], v[32:35], 0
    v_cvt_pknorm_u16_f32 v160, v160, v161
    v_pk_add_u16 v159, v158, s8 clamp
    v_pk_fma_f16 v130, v157, s9, v156
    v_cvt_pknorm_u16_f32 v162, v162, v163
    v_mfma_f32_32x32x8_bf16 v[136:151], v[48:49], v[40:41], v[136:151]
    v_pk_add_u16 v161, v160, s8 clamp
    v_pk_fma_f16 v131, v159, s9, v158
    v_cvt_pknorm_u16_f32 v164, v164, v165
    v_pk_add_u16 v163, v162, s8 clamp
    v_pk_fma_f16 v132, v161, s9, v160
    v_cvt_pknorm_u16_f32 v166, v166, v167
    v_pk_add_u16 v165, v164, s8 clamp
    v_pk_fma_f16 v133, v163, s9, v162
    v_pk_add_u16 v167, v166, s8 clamp
    v_pk_fma_f16 v134, v165, s9, v164
    v_pk_fma_f16 v135, v167, s9, v166
    v_mfma_f32_32x32x16_f16 v[80:95], v[52:55], v[128:131], v[80:95]
    v_cvt_pknorm_u16_f32 v136, v136, v137
    v_cvt_pknorm_u16_f32 v138, v138, v139
    v_pk_add_u16 v137, v136, s8 clamp
    v_cvt_pknorm_u16_f32 v140, v140, v141
    v_pk_add_u16 v139, v138, s8 clamp
    v_mfma_f32_32x32x16_f16 v[80:95], v[56:59], v[132:135], v[80:95]
    ds_read_b64_tr_b16 v[52:53], v11 offset:28224
    ds_read_b64_tr_b16 v[54:55], v12 offset:28224
    ds_read_b64_tr_b16 v[56:57], v13 offset:28224
    ds_read_b64_tr_b16 v[58:59], v14 offset:28224
    v_pk_fma_f16 v120, v137, s9, v136
    v_cvt_pknorm_u16_f32 v142, v142, v143
    v_pk_add_u16 v141, v140, s8 clamp
    v_pk_fma_f16 v121, v139, s9, v138
    v_mfma_f32_32x32x16_bf16 v[152:167], v[44:47], v[36:39], 0
    v_cvt_pknorm_u16_f32 v144, v144, v145
    v_pk_add_u16 v143, v142, s8 clamp
    v_pk_fma_f16 v122, v141, s9, v140
    v_cvt_pknorm_u16_f32 v146, v146, v147
    v_mfma_f32_32x32x8_bf16 v[152:167], v[48:49], v[42:43], v[152:167]
    ds_read_b128 v[44:47], v9 offset:31360
    ds_read_b64 v[48:49], v10 offset:31360
    v_pk_add_u16 v145, v144, s8 clamp
    s_setprio 1
    v_pk_fma_f16 v123, v143, s9, v142
    v_cvt_pknorm_u16_f32 v148, v148, v149
    v_pk_add_u16 v147, v146, s8 clamp
    v_pk_fma_f16 v124, v145, s9, v144
    v_cvt_pknorm_u16_f32 v150, v150, v151
    v_pk_add_u16 v149, v148, s8 clamp
    v_pk_fma_f16 v125, v147, s9, v146
    v_pk_add_u16 v151, v150, s8 clamp
    v_pk_fma_f16 v126, v149, s9, v148
    v_pk_fma_f16 v127, v151, s9, v150
    s_waitcnt lgkmcnt(4)
    v_mfma_f32_32x32x16_f16 v[64:79], v[52:55], v[120:123], v[64:79]
    v_cvt_pknorm_u16_f32 v152, v152, v153
    v_cvt_pknorm_u16_f32 v154, v154, v155
    v_pk_add_u16 v153, v152, s8 clamp
    v_cvt_pknorm_u16_f32 v156, v156, v157
    v_pk_add_u16 v155, v154, s8 clamp
    s_waitcnt lgkmcnt(2)
    v_mfma_f32_32x32x16_f16 v[64:79], v[56:59], v[124:127], v[64:79]
    v_pk_fma_f16 v128, v153, s9, v152
    v_cvt_pknorm_u16_f32 v158, v158, v159
    v_pk_add_u16 v157, v156, s8 clamp
    v_pk_fma_f16 v129, v155, s9, v154
    s_waitcnt lgkmcnt(0)
    v_mfma_f32_32x32x16_bf16 v[136:151], v[44:47], v[32:35], 0
    v_cvt_pknorm_u16_f32 v160, v160, v161
    v_pk_add_u16 v159, v158, s8 clamp
    v_pk_fma_f16 v130, v157, s9, v156
    v_cvt_pknorm_u16_f32 v162, v162, v163
    v_mfma_f32_32x32x8_bf16 v[136:151], v[48:49], v[40:41], v[136:151]
    v_pk_add_u16 v161, v160, s8 clamp
    v_pk_fma_f16 v131, v159, s9, v158
    v_cvt_pknorm_u16_f32 v164, v164, v165
    v_pk_add_u16 v163, v162, s8 clamp
    v_pk_fma_f16 v132, v161, s9, v160
    v_cvt_pknorm_u16_f32 v166, v166, v167
    v_pk_add_u16 v165, v164, s8 clamp
    v_pk_fma_f16 v133, v163, s9, v162
    v_pk_add_u16 v167, v166, s8 clamp
    v_pk_fma_f16 v134, v165, s9, v164
    v_pk_fma_f16 v135, v167, s9, v166
    v_mfma_f32_32x32x16_f16 v[80:95], v[52:55], v[128:131], v[80:95]
    v_cvt_pknorm_u16_f32 v136, v136, v137
    v_cvt_pknorm_u16_f32 v138, v138, v139
    v_pk_add_u16 v137, v136, s8 clamp
    v_cvt_pknorm_u16_f32 v140, v140, v141
    v_pk_add_u16 v139, v138, s8 clamp
    v_mfma_f32_32x32x16_f16 v[80:95], v[56:59], v[132:135], v[80:95]
    ds_read_b64_tr_b16 v[52:53], v11 offset:31360
    ds_read_b64_tr_b16 v[54:55], v12 offset:31360
    ds_read_b64_tr_b16 v[56:57], v13 offset:31360
    ds_read_b64_tr_b16 v[58:59], v14 offset:31360
    v_pk_fma_f16 v120, v137, s9, v136
    v_cvt_pknorm_u16_f32 v142, v142, v143
    v_pk_add_u16 v141, v140, s8 clamp
    v_pk_fma_f16 v121, v139, s9, v138
    v_mfma_f32_32x32x16_bf16 v[152:167], v[44:47], v[36:39], 0
    v_cvt_pknorm_u16_f32 v144, v144, v145
    v_pk_add_u16 v143, v142, s8 clamp
    v_pk_fma_f16 v122, v141, s9, v140
    v_cvt_pknorm_u16_f32 v146, v146, v147
    v_mfma_f32_32x32x8_bf16 v[152:167], v[48:49], v[42:43], v[152:167]
    ds_read_b128 v[44:47], v9 offset:34496
    ds_read_b64 v[48:49], v10 offset:34496
    v_pk_add_u16 v145, v144, s8 clamp
    s_setprio 0
    v_pk_fma_f16 v123, v143, s9, v142
    v_cvt_pknorm_u16_f32 v148, v148, v149
    v_pk_add_u16 v147, v146, s8 clamp
    v_pk_fma_f16 v124, v145, s9, v144
    v_cvt_pknorm_u16_f32 v150, v150, v151
    v_pk_add_u16 v149, v148, s8 clamp
    v_pk_fma_f16 v125, v147, s9, v146
    v_pk_add_u16 v151, v150, s8 clamp
    v_pk_fma_f16 v126, v149, s9, v148
    v_pk_fma_f16 v127, v151, s9, v150
    s_waitcnt lgkmcnt(4)
    v_mfma_f32_32x32x16_f16 v[64:79], v[52:55], v[120:123], v[64:79]
    v_cvt_pknorm_u16_f32 v152, v152, v153
    v_cvt_pknorm_u16_f32 v154, v154, v155
    v_pk_add_u16 v153, v152, s8 clamp
    v_cvt_pknorm_u16_f32 v156, v156, v157
    v_pk_add_u16 v155, v154, s8 clamp
    s_waitcnt lgkmcnt(2)
    v_mfma_f32_32x32x16_f16 v[64:79], v[56:59], v[124:127], v[64:79]
    v_pk_fma_f16 v128, v153, s9, v152
    v_cvt_pknorm_u16_f32 v158, v158, v159
    v_pk_add_u16 v157, v156, s8 clamp
    v_pk_fma_f16 v129, v155, s9, v154
    s_waitcnt lgkmcnt(0)
    v_mfma_f32_32x32x16_bf16 v[136:151], v[44:47], v[32:35], 0
    v_cvt_pknorm_u16_f32 v160, v160, v161
    v_pk_add_u16 v159, v158, s8 clamp
    v_pk_fma_f16 v130, v157, s9, v156
    v_cvt_pknorm_u16_f32 v162, v162, v163
    v_mfma_f32_32x32x8_bf16 v[136:151], v[48:49], v[40:41], v[136:151]
    v_pk_add_u16 v161, v160, s8 clamp
    v_pk_fma_f16 v131, v159, s9, v158
    v_cvt_pknorm_u16_f32 v164, v164, v165
    v_pk_add_u16 v163, v162, s8 clamp
    v_pk_fma_f16 v132, v161, s9, v160
    v_cvt_pknorm_u16_f32 v166, v166, v167
    v_pk_add_u16 v165, v164, s8 clamp
    v_pk_fma_f16 v133, v163, s9, v162
    v_pk_add_u16 v167, v166, s8 clamp
    v_pk_fma_f16 v134, v165, s9, v164
    v_pk_fma_f16 v135, v167, s9, v166
    v_mfma_f32_32x32x16_f16 v[80:95], v[52:55], v[128:131], v[80:95]
    s_waitcnt vmcnt(0)
    ds_write_b32 v20, v20 offset:448
    v_cvt_pknorm_u16_f32 v136, v136, v137
    v_cvt_pknorm_u16_f32 v138, v138, v139
    v_pk_add_u16 v137, v136, s8 clamp
    v_cvt_pknorm_u16_f32 v140, v140, v141
    ds_read_b32 v31, v21 offset:448
    v_pk_add_u16 v139, v138, s8 clamp
    v_mfma_f32_32x32x16_f16 v[80:95], v[56:59], v[132:135], v[80:95]
    ds_read_b64_tr_b16 v[52:53], v11 offset:34496
    ds_read_b64_tr_b16 v[54:55], v12 offset:34496
    ds_read_b64_tr_b16 v[56:57], v13 offset:34496
    ds_read_b64_tr_b16 v[58:59], v14 offset:34496
    v_pk_fma_f16 v120, v137, s9, v136
    v_cvt_pknorm_u16_f32 v142, v142, v143
    v_pk_add_u16 v141, v140, s8 clamp
    v_pk_fma_f16 v121, v139, s9, v138
    v_mfma_f32_32x32x16_bf16 v[152:167], v[44:47], v[36:39], 0
    v_cvt_pknorm_u16_f32 v144, v144, v145
    v_pk_add_u16 v143, v142, s8 clamp
    v_pk_fma_f16 v122, v141, s9, v140
    s_waitcnt lgkmcnt(4)
    v_cmp_eq_u32 vcc, 0, v31
    s_nop 0
    s_and_b32 vcc_lo, vcc_lo, s20
    s_cbranch_scc1 L_k2_es6
L_k2_ex6:
    v_cvt_pknorm_u16_f32 v146, v146, v147
    v_mfma_f32_32x32x8_bf16 v[152:167], v[48:49], v[42:43], v[152:167]
    s_waitcnt lgkmcnt(0)
    s_memrealtime s[40:41]
    s_memtime s[42:43]
    s_waitcnt lgkmcnt(0)
    s_cmp_eq_u32 s96, 0
    s_cbranch_scc1 L_k2_pt
L_k2_ptx:
    ds_read_b128 v[44:47], v9 offset:0
    ds_read_b64 v[48:49], v10 offset:0
    s_setprio 3
    v_pk_add_u16 v145, v144, s8 clamp
    v_pk_fma_f16 v123, v143, s9, v142
    v_cvt_pknorm_u16_f32 v148, v148, v149
    v_pk_add_u16 v147, v146, s8 clamp
    v_pk_fma_f16 v124, v145, s9, v144
    v_cvt_pknorm_u16_f32 v150, v150, v151
    v_pk_add_u16 v149, v148, s8 clamp
    v_pk_fma_f16 v125, v147, s9, v146
    v_pk_add_u16 v151, v150, s8 clamp
    v_pk_fma_f16 v126, v149, s9, v148
    v_pk_fma_f16 v127, v151, s9, v150
    v_mfma_f32_32x32x16_f16 v[64:79], v[52:55], v[120:123], v[64:79]
    v_cvt_pknorm_u16_f32 v152, v152, v153
    v_cvt_pknorm_u16_f32 v154, v154, v155
    v_pk_add_u16 v153, v152, s8 clamp
    v_cvt_pknorm_u16_f32 v156, v156, v157
    v_pk_add_u16 v155, v154, s8 clamp
    v_mfma_f32_32x32x16_f16 v[64:79], v[56:59], v[124:127], v[64:79]
    v_pk_fma_f16 v128, v153, s9, v152
    v_cvt_pknorm_u16_f32 v158, v158, v159
    ds_write_b32 v20, v20 offset:480
    v_pk_add_u16 v157, v156, s8 clamp
    v_pk_fma_f16 v129, v155, s9, v154
    s_waitcnt lgkmcnt(1)
    v_mfma_f32_32x32x16_bf16 v[136:151], v[44:47], v[32:35], 0
    v_cvt_pknorm_u16_f32 v160, v160, v161
    v_pk_add_u16 v159, v158, s8 clamp
    v_pk_fma_f16 v130, v157, s9, v156
    v_cvt_pknorm_u16_f32 v162, v162, v163
    v_mfma_f32_32x32x8_bf16 v[136:151], v[48:49], v[40:41], v[136:151]
    v_pk_add_u16 v161, v160, s8 clamp
    v_pk_fma_f16 v131, v159, s9, v158
    v_cvt_pknorm_u16_f32 v164, v164, v165
    v_pk_add_u16 v163, v162, s8 clamp
    v_pk_fma_f16 v132, v161, s9, v160
    v_cvt_pknorm_u16_f32 v166, v166, v167
    v_pk_add_u16 v165, v164, s8 clamp
    v_pk_fma_f16 v133, v163, s9, v162
    v_pk_add_u16 v167, v166, s8 clamp
    v_pk_fma_f16 v134, v165, s9, v164
    v_pk_fma_f16 v135, v167, s9, v166
    v_mfma_f32_32x32x16_f16 v[80:95], v[52:55], v[128:131], v[80:95]
    v_cvt_pknorm_u16_f32 v136, v136, v137
    v_cvt_pknorm_u16_f32 v138, v138, v139
    ds_read_b32 v31, v21 offset:480
    v_pk_add_u16 v137, v136, s8 clamp
    v_cvt_pknorm_u16_f32 v140, v140, v141
    v_pk_add_u16 v139, v138, s8 clamp
    v_mfma_f32_32x32x16_f16 v[80:95], v[56:59], v[132:135], v[80:95]
    ds_read_b64_tr_b16 v[52:53], v11 offset:0
    ds_read_b64_tr_b16 v[54:55], v12 offset:0
    ds_read_b64_tr_b16 v[56:57], v13 offset:0
    ds_read_b64_tr_b16 v[58:59], v14 offset:0
    v_pk_fma_f16 v120, v137, s9, v136
    v_cvt_pknorm_u16_f32 v142, v142, v143
    v_pk_add_u16 v141, v140, s8 clamp
    v_pk_fma_f16 v121, v139, s9, v138
    v_mfma_f32_32x32x16_bf16 v[152:167], v[44:47], v[36:39], 0
    v_cvt_pknorm_u16_f32 v144, v144, v145
    v_pk_add_u16 v143, v142, s8 clamp
    v_pk_fma_f16 v122, v141, s9, v140
    s_waitcnt lgkmcnt(4)
    v_cmp_eq_u32 vcc, 0, v31
    s_nop 0
    s_and_b32 vcc_lo, vcc_lo, s19
    s_cbranch_scc1 L_k2_es7
L_k2_ex7:
    v_cvt_pknorm_u16_f32 v146, v146, v147
    v_mfma_f32_32x32x8_bf16 v[152:167], v[48:49], v[42:43], v[152:167]
    ds_read_b128 v[44:47], v9 offset:3136
    ds_read_b64 v[48:49], v10 offset:3136
    v_pk_add_u16 v145, v144, s8 clamp
    s_setprio 2
    v_pk_fma_f16 v123, v143, s9, v142
    v_cvt_pknorm_u16_f32 v148, v148, v149
    v_pk_add_u16 v147, v146, s8 clamp
    v_pk_fma_f16 v124, v145, s9, v144
    v_cvt_pknorm_u16_f32 v150, v150, v151
    v_pk_add_u16 v149, v148, s8 clamp
    v_pk_fma_f16 v125, v147, s9, v146
    v_pk_add_u16 v151, v150, s8 clamp
    v_pk_fma_f16 v126, v149, s9, v148
    v_pk_fma_f16 v127, v151, s9, v150
    s_waitcnt lgkmcnt(4)
    v_mfma_f32_32x32x16_f16 v[64:79], v[52:55], v[120:123], v[64:79]
    v_cvt_pknorm_u16_f32 v152, v152, v153
    v_cvt_pknorm_u16_f32 v154, v154, v155
    v_pk_add_u16 v153, v152, s8 clamp
    v_cvt_pknorm_u16_f32 v156, v156, v157
    v_pk_add_u16 v155, v154, s8 clamp
    s_waitcnt lgkmcnt(2)
    v_mfma_f32_32x32x16_f16 v[64:79], v[56:59], v[124:127], v[64:79]
    v_pk_fma_f16 v128, v153, s9, v152
    v_cvt_pknorm_u16_f32 v158, v158, v159
    v_pk_add_u16 v157, v156, s8 clamp
    v_pk_fma_f16 v129, v155, s9, v154
    s_waitcnt lgkmcnt(0)
    v_mfma_f32_32x32x16_bf16 v[136:151], v[44:47], v[32:35], 0
    v_cvt_pknorm_u16_f32 v160, v160, v161
    v_pk_add_u16 v159, v158, s8 clamp
    v_pk_fma_f16 v130, v157, s9, v156
    v_cvt_pknorm_u16_f32 v162, v162, v163
    v_mfma_f32_32x32x8_bf16 v[136:151], v[48:49], v[40:41], v[136:151]
    v_pk_add_u16 v161, v160, s8 clamp
    v_pk_fma_f16 v131, v159, s9, v158
    v_cvt_pknorm_u16_f32 v164, v164, v165
    v_pk_add_u16 v163, v162, s8 clamp
    v_pk_fma_f16 v132, v161, s9, v160
    v_cvt_pknorm_u16_f32 v166, v166, v167
    v_pk_add_u16 v165, v164, s8 clamp
    v_pk_fma_f16 v133, v163, s9, v162
    v_pk_add_u16 v167, v166, s8 clamp
    v_pk_fma_f16 v134, v165, s9, v164
    v_pk_fma_f16 v135, v167, s9, v166
    v_mfma_f32_32x32x16_f16 v[80:95], v[52:55], v[128:131], v[80:95]
    v_cvt_pknorm_u16_f32 v136, v136, v137
    v_cvt_pknorm_u16_f32 v138, v138, v139
    v_pk_add_u16 v137, v136, s8 clamp
    v_cvt_pknorm_u16_f32 v140, v140, v141
    v_pk_add_u16 v139, v138, s8 clamp
    v_mfma_f32_32x32x16_f16 v[80:95], v[56:59], v[132:135], v[80:95]
    ds_read_b64_tr_b16 v[52:53], v11 offset:3136
    ds_read_b64_tr_b16 v[54:55], v12 offset:3136
    ds_read_b64_tr_b16 v[56:57], v13 offset:3136
    ds_read_b64_tr_b16 v[58:59], v14 offset:3136
    v_pk_fma_f16 v120, v137, s9, v136
    v_cvt_pknorm_u16_f32 v142, v142, v143
    v_pk_add_u16 v141, v140, s8 clamp
    v_pk_fma_f16 v121, v139, s9, v138
    v_mfma_f32_32x32x16_bf16 v[152:167], v[44:47], v[36:39], 0
    v_cvt_pknorm_u16_f32 v144, v144, v145
    v_pk_add_u16 v143, v142, s8 clamp
    v_pk_fma_f16 v122, v141, s9, v140
    v_cvt_pknorm_u16_f32 v146, v146, v147
    v_mfma_f32_32x32x8_bf16 v[152:167], v[48:49], v[42:43], v[152:167]
    ds_read_b128 v[44:47], v9 offset:6272
    ds_read_b64 v[48:49], v10 offset:6272
    v_pk_add_u16 v145, v144, s8 clamp
    s_setprio 1
    v_pk_fma_f16 v123, v143, s9, v142
    v_cvt_pknorm_u16_f32 v148, v148, v149
    v_pk_add_u16 v147, v146, s8 clamp
    v_pk_fma_f16 v124, v145, s9, v144
    v_cvt_pknorm_u16_f32 v150, v150, v151
    v_pk_add_u16 v149, v148, s8 clamp
    v_pk_fma_f16 v125, v147, s9, v146
    v_pk_add_u16 v151, v150, s8 clamp
    v_pk_fma_f16 v126, v149, s9, v148
    v_pk_fma_f16 v127, v151, s9, v150
    s_waitcnt lgkmcnt(4)
    v_mfma_f32_32x32x16_f16 v[64:79], v[52:55], v[120:123], v[64:79]
    v_cvt_pknorm_u16_f32 v152, v152, v153
    v_cvt_pknorm_u16_f32 v154, v154, v155
    v_pk_add_u16 v153, v152, s8 clamp
    v_cvt_pknorm_u16_f32 v156, v156, v157
    v_pk_add_u16 v155, v154, s8 clamp
    s_waitcnt lgkmcnt(2)
    v_mfma_f32_32x32x16_f16 v[64:79], v[56:59], v[124:127], v[64:79]
    v_pk_fma_f16 v128, v153, s9, v152
    v_cvt_pknorm_u16_f32 v158, v158, v159
    v_pk_add_u16 v157, v156, s8 clamp
    v_pk_fma_f16 v129, v155, s9, v154
    s_waitcnt lgkmcnt(0)
    v_mfma_f32_32x32x16_bf16 v[136:151], v[44:47], v[32:35], 0
    v_cvt_pknorm_u16_f32 v160, v160, v161
    v_pk_add_u16 v159, v158, s8 clamp
    v_pk_fma_f16 v130, v157, s9, v156
    v_cvt_pknorm_u16_f32 v162, v162, v163
    v_mfma_f32_32x32x8_bf16 v[136:151], v[48:49], v[40:41], v[136:151]
    v_pk_add_u16 v161, v160, s8 clamp
    v_pk_fma_f16 v131, v159, s9, v158
    v_cvt_pknorm_u16_f32 v164, v164, v165
    v_pk_add_u16 v163, v162, s8 clamp
    v_pk_fma_f16 v132, v161, s9, v160
    v_cvt_pknorm_u16_f32 v166, v166, v167
    v_pk_add_u16 v165, v164, s8 clamp
    v_pk_fma_f16 v133, v163, s9, v162
    v_pk_add_u16 v167, v166, s8 clamp
    v_pk_fma_f16 v134, v165, s9, v164
    v_pk_fma_f16 v135, v167, s9, v166
    v_mfma_f32_32x32x16_f16 v[80:95], v[52:55], v[128:131], v[80:95]
    v_cvt_pknorm_u16_f32 v136, v136, v137
    v_cvt_pknorm_u16_f32 v138, v138, v139
    v_pk_add_u16 v137, v136, s8 clamp
    v_cvt_pknorm_u16_f32 v140, v140, v141
    v_pk_add_u16 v139, v138, s8 clamp
    v_mfma_f32_32x32x16_f16 v[80:95], v[56:59], v[132:135], v[80:95]
    ds_read_b64_tr_b16 v[52:53], v11 offset:6272
    ds_read_b64_tr_b16 v[54:55], v12 offset:6272
    ds_read_b64_tr_b16 v[56:57], v13 offset:6272
    ds_read_b64_tr_b16 v[58:59], v14 offset:6272
    v_pk_fma_f16 v120, v137, s9, v136
    v_cvt_pknorm_u16_f32 v142, v142, v143
    v_pk_add_u16 v141, v140, s8 clamp
    v_pk_fma_f16 v121, v139, s9, v138
    v_mfma_f32_32x32x16_bf16 v[152:167], v[44:47], v[36:39], 0
    v_cvt_pknorm_u16_f32 v144, v144, v145
    v_pk_add_u16 v143, v142, s8 clamp
    v_pk_fma_f16 v122, v141, s9, v140
    v_cvt_pknorm_u16_f32 v146, v146, v147
    v_mfma_f32_32x32x8_bf16 v[152:167], v[48:49], v[42:43], v[152:167]
    ds_read_b128 v[44:47], v9 offset:9408
    ds_read_b64 v[48:49], v10 offset:9408
    v_pk_add_u16 v145, v144, s8 clamp
    s_setprio 0
    v_pk_fma_f16 v123, v143, s9, v142
    v_cvt_pknorm_u16_f32 v148, v148, v149
    v_pk_add_u16 v147, v146, s8 clamp
    v_pk_fma_f16 v124, v145, s9, v144
    v_cvt_pknorm_u16_f32 v150, v150, v151
    v_pk_add_u16 v149, v148, s8 clamp
    v_pk_fma_f16 v125, v147, s9, v146
    v_pk_add_u16 v151, v150, s8 clamp
    v_pk_fma_f16 v126, v149, s9, v148
    v_pk_fma_f16 v127, v151, s9, v150
    s_waitcnt lgkmcnt(4)
    v_mfma_f32_32x32x16_f16 v[64:79], v[52:55], v[120:123], v[64:79]
    v_cvt_pknorm_u16_f32 v152, v152, v153
    v_cvt_pknorm_u16_f32 v154, v154, v155
    v_pk_add_u16 v153, v152, s8 clamp
    v_cvt_pknorm_u16_f32 v156, v156, v157
    v_pk_add_u16 v155, v154, s8 clamp
    s_waitcnt lgkmcnt(2)
    v_mfma_f32_32x32x16_f16 v[64:79], v[56:59], v[124:127], v[64:79]
    v_pk_fma_f16 v128, v153, s9, v152
    v_cvt_pknorm_u16_f32 v158, v158, v159
    v_pk_add_u16 v157, v156, s8 clamp
    v_pk_fma_f16 v129, v155, s9, v154
    s_waitcnt lgkmcnt(0)
    v_mfma_f32_32x32x16_bf16 v[136:151], v[44:47], v[32:35], 0
    v_cvt_pknorm_u16_f32 v160, v160, v161
    v_pk_add_u16 v159, v158, s8 clamp
    v_pk_fma_f16 v130, v157, s9, v156
    v_cvt_pknorm_u16_f32 v162, v162, v163
    v_mfma_f32_32x32x8_bf16 v[136:151], v[48:49], v[40:41], v[136:151]
    v_pk_add_u16 v161, v160, s8 clamp
    v_pk_fma_f16 v131, v159, s9, v158
    v_cvt_pknorm_u16_f32 v164, v164, v165
    v_pk_add_u16 v163, v162, s8 clamp
    v_pk_fma_f16 v132, v161, s9, v160
    v_cvt_pknorm_u16_f32 v166, v166, v167
    v_pk_add_u16 v165, v164, s8 clamp
    v_pk_fma_f16 v133, v163, s9, v162
    v_pk_add_u16 v167, v166, s8 clamp
    v_pk_fma_f16 v134, v165, s9, v164
    v_pk_fma_f16 v135, v167, s9, v166
    v_mfma_f32_32x32x16_f16 v[80:95], v[52:55], v[128:131], v[80:95]
    v_cvt_pknorm_u16_f32 v136, v136, v137
    v_cvt_pknorm_u16_f32 v138, v138, v139
    v_pk_add_u16 v137, v136, s8 clamp
    v_cvt_pknorm_u16_f32 v140, v140, v141
    v_pk_add_u16 v139, v138, s8 clamp
    v_mfma_f32_32x32x16_f16 v[80:95], v[56:59], v[132:135], v[80:95]
    ds_read_b64_tr_b16 v[52:53], v11 offset:9408
    ds_read_b64_tr_b16 v[54:55], v12 offset:9408
    ds_read_b64_tr_b16 v[56:57], v13 offset:9408
    ds_read_b64_tr_b16 v[58:59], v14 offset:9408
    v_pk_fma_f16 v120, v137, s9, v136
    v_cvt_pknorm_u16_f32 v142, v142, v143
    v_pk_add_u16 v141, v140, s8 clamp
    v_pk_fma_f16 v121, v139, s9, v138
    v_mfma_f32_32x32x16_bf16 v[152:167], v[44:47], v[36:39], 0
    v_cvt_pknorm_u16_f32 v144, v144, v145
    v_pk_add_u16 v143, v142, s8 clamp
    v_pk_fma_f16 v122, v141, s9, v140
    v_cvt_pknorm_u16_f32 v146, v146, v147
    v_mfma_f32_32x32x8_bf16 v[152:167], v[48:49], v[42:43], v[152:167]
    v_pk_add_u16 v145, v144, s8 clamp
    v_pk_fma_f16 v123, v143, s9, v142
    v_cvt_pknorm_u16_f32 v148, v148, v149
    v_pk_add_u16 v147, v146, s8 clamp
    v_pk_fma_f16 v124, v145, s9, v144
    v_cvt_pknorm_u16_f32 v150, v150, v151
    v_pk_add_u16 v149, v148, s8 clamp
    v_pk_fma_f16 v125, v147, s9, v146
    v_pk_add_u16 v151, v150, s8 clamp
    v_pk_fma_f16 v126, v149, s9, v148
    v_pk_fma_f16 v127, v151, s9, v150
    s_waitcnt lgkmcnt(2)
    v_mfma_f32_32x32x16_f16 v[64:79], v[52:55], v[120:123], v[64:79]
    v_cvt_pknorm_u16_f32 v152, v152, v153
    v_cvt_pknorm_u16_f32 v154, v154, v155
    v_pk_add_u16 v153, v152, s8 clamp
    v_cvt_pknorm_u16_f32 v156, v156, v157
    v_pk_add_u16 v155, v154, s8 clamp
    s_waitcnt lgkmcnt(0)
    v_mfma_f32_32x32x16_f16 v[64:79], v[56:59], v[124:127], v[64:79]
    v_pk_fma_f16 v128, v153, s9, v152
    v_cvt_pknorm_u16_f32 v158, v158, v159
    v_pk_add_u16 v157, v156, s8 clamp
    v_pk_fma_f16 v129, v155, s9, v154
    v_cvt_pknorm_u16_f32 v160, v160, v161
    v_pk_add_u16 v159, v158, s8 clamp
    v_pk_fma_f16 v130, v157, s9, v156
    v_cvt_pknorm_u16_f32 v162, v162, v163
    v_pk_add_u16 v161, v160, s8 clamp
    v_pk_fma_f16 v131, v159, s9, v158
    v_cvt_pknorm_u16_f32 v164, v164, v165
    v_pk_add_u16 v163, v162, s8 clamp
    v_pk_fma_f16 v132, v161, s9, v160
    ds_write_b128 v16, v[64:67] offset:0
    ds_write_b128 v16, v[68:71] offset:1024
    ds_write_b128 v16, v[72:75] offset:2048
    v_or_b32 v76, 1, v76
    ds_write_b32 v18, v76
    v_cvt_pknorm_u16_f32 v166, v166, v167
    v_pk_add_u16 v165, v164, s8 clamp
    v_pk_fma_f16 v133, v163, s9, v162
    v_pk_add_u16 v167, v166, s8 clamp
    v_pk_fma_f16 v134, v165, s9, v164
    v_pk_fma_f16 v135, v167, s9, v166
    v_mfma_f32_32x32x16_f16 v[80:95], v[52:55], v[128:131], v[80:95]
    s_nop 0
    v_mfma_f32_32x32x16_f16 v[80:95], v[56:59], v[132:135], v[80:95]
L_k2_mg:
    ds_read_b32 v148, v19
    ds_read_b128 v[136:139], v17 offset:0
    ds_read_b128 v[140:143], v17 offset:1024
    ds_read_b128 v[144:147], v17 offset:2048
    s_waitcnt lgkmcnt(3)
    v_cmp_eq_u32 vcc, 0, v148
    s_nop 0
    s_cbranch_vccnz L_k2_ms
    s_nop 3
    v_add_f32 v92, v92, v148
    v_rcp_f32 v2, v92
    v_cmp_nle_f32 vcc, 0x42800000, v92
    s_nop 0
    s_mov_b64 s[14:15], vcc
    s_waitcnt lgkmcnt(2)
    v_pk_add_f32 v[80:81], v[80:81], v[136:137]
    v_pk_add_f32 v[82:83], v[82:83], v[138:139]
    v_pk_mul_f32 v[80:81], v[80:81], v[2:3] op_sel_hi:[1,0]
    v_pk_mul_f32 v[82:83], v[82:83], v[2:3] op_sel_hi:[1,0]
    v_cvt_pk_bf16_f32 v120, v80, v81
    v_cvt_pk_bf16_f32 v121, v82, v83
    v_or_b32 v120, 1, v120
    v_maximum3_f32 v93, |v80|, |v81|, |v82|
    v_maximum3_f32 v93, |v83|, |v83|, v93
    s_waitcnt lgkmcnt(1)
    v_pk_add_f32 v[84:85], v[84:85], v[140:141]
    v_pk_add_f32 v[86:87], v[86:87], v[142:143]
    v_pk_mul_f32 v[84:85], v[84:85], v[2:3] op_sel_hi:[1,0]
    v_pk_mul_f32 v[86:87], v[86:87], v[2:3] op_sel_hi:[1,0]
    v_cvt_pk_bf16_f32 v122, v84, v85
    v_cvt_pk_bf16_f32 v123, v86, v87
    v_or_b32 v122, 1, v122
    v_maximum3_f32 v93, |v84|, |v85|, v93
    v_maximum3_f32 v93, |v86|, |v87|, v93
    s_waitcnt lgkmcnt(0)
    v_pk_add_f32 v[88:89], v[88:89], v[144:145]
    v_pk_add_f32 v[90:91], v[90:91], v[146:147]
    v_pk_mul_f32 v[88:89], v[88:89], v[2:3] op_sel_hi:[1,0]
    v_pk_mul_f32 v[90:91], v[90:91], v[2:3] op_sel_hi:[1,0]
    v_cvt_pk_bf16_f32 v124, v88, v89
    v_cvt_pk_bf16_f32 v125, v90, v91
    v_or_b32 v124, 1, v124
    v_maximum3_f32 v93, |v88|, |v89|, v93
    v_maximum3_f32 v93, |v90|, |v91|, v93
    v_cmp_nge_f32 vcc, 0x5d800000, v93
    s_nop 0
    s_or_b64 s[14:15], vcc, s[14:15]
    v_cmp_nle_f32 vcc, 0x37800000, v93
    s_nop 0
    s_or_b64 vcc, vcc, s[14:15]
    s_cselect_b32 s24, 1, 0
    s_andn2_b32 s24, s24, s5
    s_cbranch_scc1 L_k2_ns
    buffer_store_dwordx4 v[120:123], v8, s[32:35], s7 offen sc1
    s_mov_b64 exec, 0xffffffff
    buffer_store_dwordx2 v[124:125], v15, s[32:35], s6 offen sc1
    s_mov_b64 exec, -1
L_k2_ns:
    v_add_u32 v2, s24, 1
    ds_write_b32 v20, v2
    s_setprio 0
    s_cmp_eq_u32 s5, 1
    s_cbranch_scc1 L_k2_ae
L_k2_av:
    s_sleep 2
    ds_read_b32 v2, v21
    s_waitcnt lgkmcnt(0)
    v_cmp_eq_u32 vcc, 0, v2
    s_nop 0
    s_cbranch_vccnz L_k2_av
    v_cmp_eq_u32 vcc, 2, v2
    s_nop 0
    s_cbranch_vccnz L_k2_fb
L_k2_ae:
    s_endpgm
L_k2_es0:
    s_sleep 1
    ds_read_b32 v31, v21 offset:256
    s_waitcnt lgkmcnt(0)
    v_cmp_eq_u32 vcc, 0, v31
    s_nop 0
    s_and_b32 vcc_lo, vcc_lo, s20
    s_cbranch_scc1 L_k2_es0
    s_branch L_k2_ex0
L_k2_es1:
    s_sleep 1
    ds_read_b32 v31, v21 offset:288
    s_waitcnt lgkmcnt(0)
    v_cmp_eq_u32 vcc, 0, v31
    s_nop 0
    s_and_b32 vcc_lo, vcc_lo, s19
    s_cbranch_scc1 L_k2_es1
    s_branch L_k2_ex1
L_k2_es2:
    s_sleep 1
    ds_read_b32 v31, v21 offset:320
    s_waitcnt lgkmcnt(0)
    v_cmp_eq_u32 vcc, 0, v31
    s_nop 0
    s_and_b32 vcc_lo, vcc_lo, s20
    s_cbranch_scc1 L_k2_es2
    s_branch L_k2_ex2
L_k2_es3:
    s_sleep 1
    ds_read_b32 v31, v21 offset:352
    s_waitcnt lgkmcnt(0)
    v_cmp_eq_u32 vcc, 0, v31
    s_nop 0
    s_and_b32 vcc_lo, vcc_lo, s19
    s_cbranch_scc1 L_k2_es3
    s_branch L_k2_ex3
L_k2_es4:
    s_sleep 1
    ds_read_b32 v31, v21 offset:384
    s_waitcnt lgkmcnt(0)
    v_cmp_eq_u32 vcc, 0, v31
    s_nop 0
    s_and_b32 vcc_lo, vcc_lo, s20
    s_cbranch_scc1 L_k2_es4
    s_branch L_k2_ex4
L_k2_es5:
    s_sleep 1
    ds_read_b32 v31, v21 offset:416
    s_waitcnt lgkmcnt(0)
    v_cmp_eq_u32 vcc, 0, v31
    s_nop 0
    s_and_b32 vcc_lo, vcc_lo, s19
    s_cbranch_scc1 L_k2_es5
    s_branch L_k2_ex5
L_k2_es6:
    s_sleep 1
    ds_read_b32 v31, v21 offset:448
    s_waitcnt lgkmcnt(0)
    v_cmp_eq_u32 vcc, 0, v31
    s_nop 0
    s_and_b32 vcc_lo, vcc_lo, s20
    s_cbranch_scc1 L_k2_es6
    s_branch L_k2_ex6
L_k2_es7:
    s_sleep 1
    ds_read_b32 v31, v21 offset:480
    s_waitcnt lgkmcnt(0)
    v_cmp_eq_u32 vcc, 0, v31
    s_nop 0
    s_and_b32 vcc_lo, vcc_lo, s19
    s_cbranch_scc1 L_k2_es7
    s_branch L_k2_ex7
L_k2_pt:
    s_sub_u32 s25, s42, s38
    s_sub_u32 s26, s40, s36
    v_cvt_f32_u32 v3, s25
    s_mul_i32 s26, s26, 3700
    s_bfe_u32 s24, s2, 0x30003
    v_rcp_f32 v3, v3
    v_cvt_f32_u32 v4, s26
    s_lshl_b32 s24, s24, 8
    s_and_b32 s25, s2, 7
    s_lshl4_add_u32 s24, s25, s24
    v_lshlrev_b32 v2, 7, v8
    s_lshr_b32 s25, s2, 6
    s_lshl2_add_u32 s24, s25, s24
    s_add_u32 s24, s24, 22347776
    s_add_u32 s40, s40, 10
    v_mul_f32 v3, v3, v4
    v_cvt_u32_f32 v3, v3
    v_add_u32 v3, s40, v3
    v_or_b32 v3, 1, v3
    s_mov_b64 exec, 0xffffffff
    buffer_store_dword v3, v2, s[32:35], s24 offen sc1
    s_mov_b64 exec, -1
    s_branch L_k2_ptx
L_k2_ms:
    s_sleep 1
    ds_read_b32 v148, v19
    s_waitcnt lgkmcnt(0)
    v_cmp_eq_u32 vcc, 0, v148
    s_nop 0
    s_cbranch_vccnz L_k2_ms
    s_branch L_k2_mg
L_k2_fb:
    s_waitcnt vmcnt(0) lgkmcnt(0)
    s_mov_b32 s5, 1
    v_mov_b32 v2, 0
    ds_write_b32 v18, v2
    v_mov_b32 v26, 0xff800000
    v_mov_b32 v27, 0xff800000
    s_mov_b32 s25, 0x108
    s_mov_b32 s24, 0x427fff00
    s_mov_b32 s12, 0
    s_mov_b32 s11, 40960
L_k2_mx:
    s_waitcnt lgkmcnt(0)
    s_barrier
    s_mov_b32 m0, s4
    s_nop 0
    buffer_load_dwordx4 v5, s[32:35], s11 offen offset:0 sc1 lds
    buffer_load_dwordx4 v6, s[32:35], s11 offen offset:1024 sc1 lds
    buffer_load_dwordx4 v7, s[32:35], s11 offen offset:2048 sc1 lds
    s_add_u32 s11, s11, 987136
    s_waitcnt vmcnt(0)
    s_barrier
    ds_read_b128 v[44:47], v9 offset:25088
    ds_read_b64 v[48:49], v10 offset:25088
    s_waitcnt lgkmcnt(0)
    v_mfma_f32_32x32x16_bf16 v[136:151], v[44:47], v[32:35], 0
    v_mfma_f32_32x32x8_bf16 v[136:151], v[48:49], v[40:41], v[136:151]
    v_mfma_f32_32x32x16_bf16 v[152:167], v[44:47], v[36:39], 0
    v_mfma_f32_32x32x8_bf16 v[152:167], v[48:49], v[42:43], v[152:167]
    s_nop 9
    v_max3_f32 v26, v26, v136, v137
    v_max3_f32 v26, v26, v138, v139
    v_max3_f32 v26, v26, v140, v141
    v_max3_f32 v26, v26, v142, v143
    v_max3_f32 v26, v26, v144, v145
    v_max3_f32 v26, v26, v146, v147
    v_max3_f32 v26, v26, v148, v149
    v_max3_f32 v26, v26, v150, v151
    v_max3_f32 v27, v27, v152, v153
    v_max3_f32 v27, v27, v154, v155
    v_max3_f32 v27, v27, v156, v157
    v_max3_f32 v27, v27, v158, v159
    v_max3_f32 v27, v27, v160, v161
    v_max3_f32 v27, v27, v162, v163
    v_max3_f32 v27, v27, v164, v165
    v_max3_f32 v27, v27, v166, v167
    ds_read_b128 v[44:47], v9 offset:28224
    ds_read_b64 v[48:49], v10 offset:28224
    s_waitcnt lgkmcnt(0)
    v_mfma_f32_32x32x16_bf16 v[136:151], v[44:47], v[32:35], 0
    v_mfma_f32_32x32x8_bf16 v[136:151], v[48:49], v[40:41], v[136:151]
    v_mfma_f32_32x32x16_bf16 v[152:167], v[44:47], v[36:39], 0
    v_mfma_f32_32x32x8_bf16 v[152:167], v[48:49], v[42:43], v[152:167]
    s_nop 9
    v_max3_f32 v26, v26, v136, v137
    v_max3_f32 v26, v26, v138, v139
    v_max3_f32 v26, v26, v140, v141
    v_max3_f32 v26, v26, v142, v143
    v_max3_f32 v26, v26, v144, v145
    v_max3_f32 v26, v26, v146, v147
    v_max3_f32 v26, v26, v148, v149
    v_max3_f32 v26, v26, v150, v151
    v_max3_f32 v27, v27, v152, v153
    v_max3_f32 v27, v27, v154, v155
    v_max3_f32 v27, v27, v156, v157
    v_max3_f32 v27, v27, v158, v159
    v_max3_f32 v27, v27, v160, v161
    v_max3_f32 v27, v27, v162, v163
    v_max3_f32 v27, v27, v164, v165
    v_max3_f32 v27, v27, v166, v167
    ds_read_b128 v[44:47], v9 offset:31360
    ds_read_b64 v[48:49], v10 offset:31360
    s_waitcnt lgkmcnt(0)
    v_mfma_f32_32x32x16_bf16 v[136:151], v[44:47], v[32:35], 0
    v_mfma_f32_32x32x8_bf16 v[136:151], v[48:49], v[40:41], v[136:151]
    v_mfma_f32_32x32x16_bf16 v[152:167], v[44:47], v[36:39], 0
    v_mfma_f32_32x32x8_bf16 v[152:167], v[48:49], v[42:43], v[152:167]
    s_nop 9
    v_max3_f32 v26, v26, v136, v137
    v_max3_f32 v26, v26, v138, v139
    v_max3_f32 v26, v26, v140, v141
    v_max3_f32 v26, v26, v142, v143
    v_max3_f32 v26, v26, v144, v145
    v_max3_f32 v26, v26, v146, v147
    v_max3_f32 v26, v26, v148, v149
    v_max3_f32 v26, v26, v150, v151
    v_max3_f32 v27, v27, v152, v153
    v_max3_f32 v27, v27, v154, v155
    v_max3_f32 v27, v27, v156, v157
    v_max3_f32 v27, v27, v158, v159
    v_max3_f32 v27, v27, v160, v161
    v_max3_f32 v27, v27, v162, v163
    v_max3_f32 v27, v27, v164, v165
    v_max3_f32 v27, v27, v166, v167
    ds_read_b128 v[44:47], v9 offset:34496
    ds_read_b64 v[48:49], v10 offset:34496
    s_waitcnt lgkmcnt(0)
    v_mfma_f32_32x32x16_bf16 v[136:151], v[44:47], v[32:35], 0
    v_mfma_f32_32x32x8_bf16 v[136:151], v[48:49], v[40:41], v[136:151]
    v_mfma_f32_32x32x16_bf16 v[152:167], v[44:47], v[36:39], 0
    v_mfma_f32_32x32x8_bf16 v[152:167], v[48:49], v[42:43], v[152:167]
    s_nop 9
    v_max3_f32 v26, v26, v136, v137
    v_max3_f32 v26, v26, v138, v139
    v_max3_f32 v26, v26, v140, v141
    v_max3_f32 v26, v26, v142, v143
    v_max3_f32 v26, v26, v144, v145
    v_max3_f32 v26, v26, v146, v147
    v_max3_f32 v26, v26, v148, v149
    v_max3_f32 v26, v26, v150, v151
    v_max3_f32 v27, v27, v152, v153
    v_max3_f32 v27, v27, v154, v155
    v_max3_f32 v27, v27, v156, v157
    v_max3_f32 v27, v27, v158, v159
    v_max3_f32 v27, v27, v160, v161
    v_max3_f32 v27, v27, v162, v163
    v_max3_f32 v27, v27, v164, v165
    v_max3_f32 v27, v27, v166, v167
    s_add_u32 s12, s12, 1
    s_cmp_lt_u32 s12, 8
    s_cbranch_scc1 L_k2_mx
    s_barrier
    ds_write_b32 v16, v27
    ds_write_b32 v16, v26 offset:4
    s_waitcnt lgkmcnt(0)
    s_barrier
    ds_read_b64 v[48:49], v17
    v_mov_b32 v64, 0
    v_mov_b32 v65, 0
    v_mov_b32 v66, 0
    v_mov_b32 v67, 0
    v_mov_b32 v68, 0
    v_mov_b32 v69, 0
    v_mov_b32 v70, 0
    v_mov_b32 v71, 0
    v_mov_b32 v72, 0
    v_mov_b32 v73, 0
    v_mov_b32 v74, 0
    v_mov_b32 v75, 0
    v_mov_b32 v76, 0
    v_mov_b32 v77, 0
    v_mov_b32 v78, 0
    v_mov_b32 v79, 0
    v_mov_b32 v80, 0
    v_mov_b32 v81, 0
    v_mov_b32 v82, 0
    v_mov_b32 v83, 0
    v_mov_b32 v84, 0
    v_mov_b32 v85, 0
    v_mov_b32 v86, 0
    v_mov_b32 v87, 0
    v_mov_b32 v88, 0
    v_mov_b32 v89, 0
    v_mov_b32 v90, 0
    v_mov_b32 v91, 0
    v_mov_b32 v92, 0
    v_mov_b32 v93, 0
    v_mov_b32 v94, 0
    v_mov_b32 v95, 0
    s_waitcnt lgkmcnt(0)
    v_max_f32 v26, v26, v48
    v_mov_b32 v2, v26
    s_nop 1
    v_permlane32_swap_b32 v2, v26
    v_max_f32 v26, v26, v2
    v_max_f32 v27, v27, v49
    v_mov_b32 v2, v27
    s_nop 1
    v_permlane32_swap_b32 v2, v27
    v_max_f32 v27, v27, v2
    s_mov_b32 s12, 0
    s_mov_b32 s11, 40960
L_k2_ex:
    s_waitcnt lgkmcnt(0)
    s_barrier
    s_mov_b32 m0, s4
    s_nop 0
    buffer_load_dwordx4 v5, s[32:35], s11 offen offset:0 sc1 lds
    buffer_load_dwordx4 v6, s[32:35], s11 offen offset:1024 sc1 lds
    buffer_load_dwordx4 v7, s[32:35], s11 offen offset:2048 sc1 lds
    s_sub_u32 m0, s4, 25088
    s_add_u32 s26, s11, 22986752
    buffer_load_dwordx4 v6, s[32:35], s26 offen offset:1024 sc1 lds
    buffer_load_dwordx4 v7, s[32:35], s26 offen offset:2048 sc1 lds
    s_add_u32 s11, s11, 987136
    s_waitcnt vmcnt(0)
    s_barrier
    ds_read_b128 v[44:47], v9 offset:25088
    ds_read_b64 v[48:49], v10 offset:25088
    ds_read_b64_tr_b16 v[52:53], v11 offset:25088
    ds_read_b64_tr_b16 v[54:55], v12 offset:25088
    ds_read_b64_tr_b16 v[56:57], v13 offset:25088
    ds_read_b64_tr_b16 v[58:59], v14 offset:25088
    ds_read_b64_tr_b16 v[120:121], v11 offset:0
    ds_read_b64_tr_b16 v[122:123], v12 offset:0
    ds_read_b64_tr_b16 v[124:125], v13 offset:0
    ds_read_b64_tr_b16 v[126:127], v14 offset:0
    s_waitcnt lgkmcnt(0)
    v_cvt_f32_f16 v2, v52
    v_lshlrev_b32 v3, 16, v120
    v_cmp_class_f16 vcc, v52, s25
    s_nop 1
    v_cndmask_b32 v2, v3, v2, vcc
    v_lshrrev_b32 v52, 16, v52
    v_cvt_f32_f16 v4, v52
    v_and_b32 v3, 0xffff0000, v120
    v_cmp_class_f16 vcc, v52, s25
    s_nop 1
    v_cndmask_b32 v4, v3, v4, vcc
    v_cvt_pk_bf16_f32 v52, v2, v4
    v_cvt_f32_f16 v2, v53
    v_lshlrev_b32 v3, 16, v121
    v_cmp_class_f16 vcc, v53, s25
    s_nop 1
    v_cndmask_b32 v2, v3, v2, vcc
    v_lshrrev_b32 v53, 16, v53
    v_cvt_f32_f16 v4, v53
    v_and_b32 v3, 0xffff0000, v121
    v_cmp_class_f16 vcc, v53, s25
    s_nop 1
    v_cndmask_b32 v4, v3, v4, vcc
    v_cvt_pk_bf16_f32 v53, v2, v4
    v_cvt_f32_f16 v2, v54
    v_lshlrev_b32 v3, 16, v122
    v_cmp_class_f16 vcc, v54, s25
    s_nop 1
    v_cndmask_b32 v2, v3, v2, vcc
    v_lshrrev_b32 v54, 16, v54
    v_cvt_f32_f16 v4, v54
    v_and_b32 v3, 0xffff0000, v122
    v_cmp_class_f16 vcc, v54, s25
    s_nop 1
    v_cndmask_b32 v4, v3, v4, vcc
    v_cvt_pk_bf16_f32 v54, v2, v4
    v_cvt_f32_f16 v2, v55
    v_lshlrev_b32 v3, 16, v123
    v_cmp_class_f16 vcc, v55, s25
    s_nop 1
    v_cndmask_b32 v2, v3, v2, vcc
    v_lshrrev_b32 v55, 16, v55
    v_cvt_f32_f16 v4, v55
    v_and_b32 v3, 0xffff0000, v123
    v_cmp_class_f16 vcc, v55, s25
    s_nop 1
    v_cndmask_b32 v4, v3, v4, vcc
    v_cvt_pk_bf16_f32 v55, v2, v4
    v_cvt_f32_f16 v2, v56
    v_lshlrev_b32 v3, 16, v124
    v_cmp_class_f16 vcc, v56, s25
    s_nop 1
    v_cndmask_b32 v2, v3, v2, vcc
    v_lshrrev_b32 v56, 16, v56
    v_cvt_f32_f16 v4, v56
    v_and_b32 v3, 0xffff0000, v124
    v_cmp_class_f16 vcc, v56, s25
    s_nop 1
    v_cndmask_b32 v4, v3, v4, vcc
    v_cvt_pk_bf16_f32 v56, v2, v4
    v_cvt_f32_f16 v2, v57
    v_lshlrev_b32 v3, 16, v125
    v_cmp_class_f16 vcc, v57, s25
    s_nop 1
    v_cndmask_b32 v2, v3, v2, vcc
    v_lshrrev_b32 v57, 16, v57
    v_cvt_f32_f16 v4, v57
    v_and_b32 v3, 0xffff0000, v125
    v_cmp_class_f16 vcc, v57, s25
    s_nop 1
    v_cndmask_b32 v4, v3, v4, vcc
    v_cvt_pk_bf16_f32 v57, v2, v4
    v_cvt_f32_f16 v2, v58
    v_lshlrev_b32 v3, 16, v126
    v_cmp_class_f16 vcc, v58, s25
    s_nop 1
    v_cndmask_b32 v2, v3, v2, vcc
    v_lshrrev_b32 v58, 16, v58
    v_cvt_f32_f16 v4, v58
    v_and_b32 v3, 0xffff0000, v126
    v_cmp_class_f16 vcc, v58, s25
    s_nop 1
    v_cndmask_b32 v4, v3, v4, vcc
    v_cvt_pk_bf16_f32 v58, v2, v4
    v_cvt_f32_f16 v2, v59
    v_lshlrev_b32 v3, 16, v127
    v_cmp_class_f16 vcc, v59, s25
    s_nop 1
    v_cndmask_b32 v2, v3, v2, vcc
    v_lshrrev_b32 v59, 16, v59
    v_cvt_f32_f16 v4, v59
    v_and_b32 v3, 0xffff0000, v127
    v_cmp_class_f16 vcc, v59, s25
    s_nop 1
    v_cndmask_b32 v4, v3, v4, vcc
    v_cvt_pk_bf16_f32 v59, v2, v4
    v_mfma_f32_32x32x16_bf16 v[136:151], v[44:47], v[32:35], 0
    v_mfma_f32_32x32x8_bf16 v[136:151], v[48:49], v[40:41], v[136:151]
    v_mfma_f32_32x32x16_bf16 v[152:167], v[44:47], v[36:39], 0
    v_mfma_f32_32x32x8_bf16 v[152:167], v[48:49], v[42:43], v[152:167]
    s_nop 9
    v_sub_f32 v136, v136, v26
    v_sub_f32 v137, v137, v26
    v_sub_f32 v138, v138, v26
    v_sub_f32 v139, v139, v26
    v_sub_f32 v140, v140, v26
    v_sub_f32 v141, v141, v26
    v_sub_f32 v142, v142, v26
    v_sub_f32 v143, v143, v26
    v_sub_f32 v144, v144, v26
    v_sub_f32 v145, v145, v26
    v_sub_f32 v146, v146, v26
    v_sub_f32 v147, v147, v26
    v_sub_f32 v148, v148, v26
    v_sub_f32 v149, v149, v26
    v_sub_f32 v150, v150, v26
    v_sub_f32 v151, v151, v26
    v_mul_f32 v136, s24, v136
    v_mul_f32 v137, s24, v137
    v_mul_f32 v138, s24, v138
    v_mul_f32 v139, s24, v139
    v_mul_f32 v140, s24, v140
    v_mul_f32 v141, s24, v141
    v_mul_f32 v142, s24, v142
    v_mul_f32 v143, s24, v143
    v_mul_f32 v144, s24, v144
    v_mul_f32 v145, s24, v145
    v_mul_f32 v146, s24, v146
    v_mul_f32 v147, s24, v147
    v_mul_f32 v148, s24, v148
    v_mul_f32 v149, s24, v149
    v_mul_f32 v150, s24, v150
    v_mul_f32 v151, s24, v151
    v_exp_f32 v136, v136
    v_exp_f32 v137, v137
    v_exp_f32 v138, v138
    v_exp_f32 v139, v139
    v_exp_f32 v140, v140
    v_exp_f32 v141, v141
    v_exp_f32 v142, v142
    v_exp_f32 v143, v143
    v_exp_f32 v144, v144
    v_exp_f32 v145, v145
    v_exp_f32 v146, v146
    v_exp_f32 v147, v147
    v_exp_f32 v148, v148
    v_exp_f32 v149, v149
    v_exp_f32 v150, v150
    v_exp_f32 v151, v151
    v_cvt_pk_bf16_f32 v120, v136, v137
    v_cvt_pk_bf16_f32 v121, v138, v139
    v_cvt_pk_bf16_f32 v122, v140, v141
    v_cvt_pk_bf16_f32 v123, v142, v143
    v_cvt_pk_bf16_f32 v124, v144, v145
    v_cvt_pk_bf16_f32 v125, v146, v147
    v_cvt_pk_bf16_f32 v126, v148, v149
    v_cvt_pk_bf16_f32 v127, v150, v151
    v_mfma_f32_32x32x16_bf16 v[64:79], v[52:55], v[120:123], v[64:79]
    s_nop 0
    v_mfma_f32_32x32x16_bf16 v[64:79], v[56:59], v[124:127], v[64:79]
    v_sub_f32 v152, v152, v27
    v_sub_f32 v153, v153, v27
    v_sub_f32 v154, v154, v27
    v_sub_f32 v155, v155, v27
    v_sub_f32 v156, v156, v27
    v_sub_f32 v157, v157, v27
    v_sub_f32 v158, v158, v27
    v_sub_f32 v159, v159, v27
    v_sub_f32 v160, v160, v27
    v_sub_f32 v161, v161, v27
    v_sub_f32 v162, v162, v27
    v_sub_f32 v163, v163, v27
    v_sub_f32 v164, v164, v27
    v_sub_f32 v165, v165, v27
    v_sub_f32 v166, v166, v27
    v_sub_f32 v167, v167, v27
    v_mul_f32 v152, s24, v152
    v_mul_f32 v153, s24, v153
    v_mul_f32 v154, s24, v154
    v_mul_f32 v155, s24, v155
    v_mul_f32 v156, s24, v156
    v_mul_f32 v157, s24, v157
    v_mul_f32 v158, s24, v158
    v_mul_f32 v159, s24, v159
    v_mul_f32 v160, s24, v160
    v_mul_f32 v161, s24, v161
    v_mul_f32 v162, s24, v162
    v_mul_f32 v163, s24, v163
    v_mul_f32 v164, s24, v164
    v_mul_f32 v165, s24, v165
    v_mul_f32 v166, s24, v166
    v_mul_f32 v167, s24, v167
    v_exp_f32 v152, v152
    v_exp_f32 v153, v153
    v_exp_f32 v154, v154
    v_exp_f32 v155, v155
    v_exp_f32 v156, v156
    v_exp_f32 v157, v157
    v_exp_f32 v158, v158
    v_exp_f32 v159, v159
    v_exp_f32 v160, v160
    v_exp_f32 v161, v161
    v_exp_f32 v162, v162
    v_exp_f32 v163, v163
    v_exp_f32 v164, v164
    v_exp_f32 v165, v165
    v_exp_f32 v166, v166
    v_exp_f32 v167, v167
    v_cvt_pk_bf16_f32 v128, v152, v153
    v_cvt_pk_bf16_f32 v129, v154, v155
    v_cvt_pk_bf16_f32 v130, v156, v157
    v_cvt_pk_bf16_f32 v131, v158, v159
    v_cvt_pk_bf16_f32 v132, v160, v161
    v_cvt_pk_bf16_f32 v133, v162, v163
    v_cvt_pk_bf16_f32 v134, v164, v165
    v_cvt_pk_bf16_f32 v135, v166, v167
    v_mfma_f32_32x32x16_bf16 v[80:95], v[52:55], v[128:131], v[80:95]
    s_nop 0
    v_mfma_f32_32x32x16_bf16 v[80:95], v[56:59], v[132:135], v[80:95]
    ds_read_b128 v[44:47], v9 offset:28224
    ds_read_b64 v[48:49], v10 offset:28224
    ds_read_b64_tr_b16 v[52:53], v11 offset:28224
    ds_read_b64_tr_b16 v[54:55], v12 offset:28224
    ds_read_b64_tr_b16 v[56:57], v13 offset:28224
    ds_read_b64_tr_b16 v[58:59], v14 offset:28224
    ds_read_b64_tr_b16 v[120:121], v11 offset:3136
    ds_read_b64_tr_b16 v[122:123], v12 offset:3136
    ds_read_b64_tr_b16 v[124:125], v13 offset:3136
    ds_read_b64_tr_b16 v[126:127], v14 offset:3136
    s_waitcnt lgkmcnt(0)
    v_cvt_f32_f16 v2, v52
    v_lshlrev_b32 v3, 16, v120
    v_cmp_class_f16 vcc, v52, s25
    s_nop 1
    v_cndmask_b32 v2, v3, v2, vcc
    v_lshrrev_b32 v52, 16, v52
    v_cvt_f32_f16 v4, v52
    v_and_b32 v3, 0xffff0000, v120
    v_cmp_class_f16 vcc, v52, s25
    s_nop 1
    v_cndmask_b32 v4, v3, v4, vcc
    v_cvt_pk_bf16_f32 v52, v2, v4
    v_cvt_f32_f16 v2, v53
    v_lshlrev_b32 v3, 16, v121
    v_cmp_class_f16 vcc, v53, s25
    s_nop 1
    v_cndmask_b32 v2, v3, v2, vcc
    v_lshrrev_b32 v53, 16, v53
    v_cvt_f32_f16 v4, v53
    v_and_b32 v3, 0xffff0000, v121
    v_cmp_class_f16 vcc, v53, s25
    s_nop 1
    v_cndmask_b32 v4, v3, v4, vcc
    v_cvt_pk_bf16_f32 v53, v2, v4
    v_cvt_f32_f16 v2, v54
    v_lshlrev_b32 v3, 16, v122
    v_cmp_class_f16 vcc, v54, s25
    s_nop 1
    v_cndmask_b32 v2, v3, v2, vcc
    v_lshrrev_b32 v54, 16, v54
    v_cvt_f32_f16 v4, v54
    v_and_b32 v3, 0xffff0000, v122
    v_cmp_class_f16 vcc, v54, s25
    s_nop 1
    v_cndmask_b32 v4, v3, v4, vcc
    v_cvt_pk_bf16_f32 v54, v2, v4
    v_cvt_f32_f16 v2, v55
    v_lshlrev_b32 v3, 16, v123
    v_cmp_class_f16 vcc, v55, s25
    s_nop 1
    v_cndmask_b32 v2, v3, v2, vcc
    v_lshrrev_b32 v55, 16, v55
    v_cvt_f32_f16 v4, v55
    v_and_b32 v3, 0xffff0000, v123
    v_cmp_class_f16 vcc, v55, s25
    s_nop 1
    v_cndmask_b32 v4, v3, v4, vcc
    v_cvt_pk_bf16_f32 v55, v2, v4
    v_cvt_f32_f16 v2, v56
    v_lshlrev_b32 v3, 16, v124
    v_cmp_class_f16 vcc, v56, s25
    s_nop 1
    v_cndmask_b32 v2, v3, v2, vcc
    v_lshrrev_b32 v56, 16, v56
    v_cvt_f32_f16 v4, v56
    v_and_b32 v3, 0xffff0000, v124
    v_cmp_class_f16 vcc, v56, s25
    s_nop 1
    v_cndmask_b32 v4, v3, v4, vcc
    v_cvt_pk_bf16_f32 v56, v2, v4
    v_cvt_f32_f16 v2, v57
    v_lshlrev_b32 v3, 16, v125
    v_cmp_class_f16 vcc, v57, s25
    s_nop 1
    v_cndmask_b32 v2, v3, v2, vcc
    v_lshrrev_b32 v57, 16, v57
    v_cvt_f32_f16 v4, v57
    v_and_b32 v3, 0xffff0000, v125
    v_cmp_class_f16 vcc, v57, s25
    s_nop 1
    v_cndmask_b32 v4, v3, v4, vcc
    v_cvt_pk_bf16_f32 v57, v2, v4
    v_cvt_f32_f16 v2, v58
    v_lshlrev_b32 v3, 16, v126
    v_cmp_class_f16 vcc, v58, s25
    s_nop 1
    v_cndmask_b32 v2, v3, v2, vcc
    v_lshrrev_b32 v58, 16, v58
    v_cvt_f32_f16 v4, v58
    v_and_b32 v3, 0xffff0000, v126
    v_cmp_class_f16 vcc, v58, s25
    s_nop 1
    v_cndmask_b32 v4, v3, v4, vcc
    v_cvt_pk_bf16_f32 v58, v2, v4
    v_cvt_f32_f16 v2, v59
    v_lshlrev_b32 v3, 16, v127
    v_cmp_class_f16 vcc, v59, s25
    s_nop 1
    v_cndmask_b32 v2, v3, v2, vcc
    v_lshrrev_b32 v59, 16, v59
    v_cvt_f32_f16 v4, v59
    v_and_b32 v3, 0xffff0000, v127
    v_cmp_class_f16 vcc, v59, s25
    s_nop 1
    v_cndmask_b32 v4, v3, v4, vcc
    v_cvt_pk_bf16_f32 v59, v2, v4
    v_mfma_f32_32x32x16_bf16 v[136:151], v[44:47], v[32:35], 0
    v_mfma_f32_32x32x8_bf16 v[136:151], v[48:49], v[40:41], v[136:151]
    v_mfma_f32_32x32x16_bf16 v[152:167], v[44:47], v[36:39], 0
    v_mfma_f32_32x32x8_bf16 v[152:167], v[48:49], v[42:43], v[152:167]
    s_nop 9
    v_sub_f32 v136, v136, v26
    v_sub_f32 v137, v137, v26
    v_sub_f32 v138, v138, v26
    v_sub_f32 v139, v139, v26
    v_sub_f32 v140, v140, v26
    v_sub_f32 v141, v141, v26
    v_sub_f32 v142, v142, v26
    v_sub_f32 v143, v143, v26
    v_sub_f32 v144, v144, v26
    v_sub_f32 v145, v145, v26
    v_sub_f32 v146, v146, v26
    v_sub_f32 v147, v147, v26
    v_sub_f32 v148, v148, v26
    v_sub_f32 v149, v149, v26
    v_sub_f32 v150, v150, v26
    v_sub_f32 v151, v151, v26
    v_mul_f32 v136, s24, v136
    v_mul_f32 v137, s24, v137
    v_mul_f32 v138, s24, v138
    v_mul_f32 v139, s24, v139
    v_mul_f32 v140, s24, v140
    v_mul_f32 v141, s24, v141
    v_mul_f32 v142, s24, v142
    v_mul_f32 v143, s24, v143
    v_mul_f32 v144, s24, v144
    v_mul_f32 v145, s24, v145
    v_mul_f32 v146, s24, v146
    v_mul_f32 v147, s24, v147
    v_mul_f32 v148, s24, v148
    v_mul_f32 v149, s24, v149
    v_mul_f32 v150, s24, v150
    v_mul_f32 v151, s24, v151
    v_exp_f32 v136, v136
    v_exp_f32 v137, v137
    v_exp_f32 v138, v138
    v_exp_f32 v139, v139
    v_exp_f32 v140, v140
    v_exp_f32 v141, v141
    v_exp_f32 v142, v142
    v_exp_f32 v143, v143
    v_exp_f32 v144, v144
    v_exp_f32 v145, v145
    v_exp_f32 v146, v146
    v_exp_f32 v147, v147
    v_exp_f32 v148, v148
    v_exp_f32 v149, v149
    v_exp_f32 v150, v150
    v_exp_f32 v151, v151
    v_cvt_pk_bf16_f32 v120, v136, v137
    v_cvt_pk_bf16_f32 v121, v138, v139
    v_cvt_pk_bf16_f32 v122, v140, v141
    v_cvt_pk_bf16_f32 v123, v142, v143
    v_cvt_pk_bf16_f32 v124, v144, v145
    v_cvt_pk_bf16_f32 v125, v146, v147
    v_cvt_pk_bf16_f32 v126, v148, v149
    v_cvt_pk_bf16_f32 v127, v150, v151
    v_mfma_f32_32x32x16_bf16 v[64:79], v[52:55], v[120:123], v[64:79]
    s_nop 0
    v_mfma_f32_32x32x16_bf16 v[64:79], v[56:59], v[124:127], v[64:79]
    v_sub_f32 v152, v152, v27
    v_sub_f32 v153, v153, v27
    v_sub_f32 v154, v154, v27
    v_sub_f32 v155, v155, v27
    v_sub_f32 v156, v156, v27
    v_sub_f32 v157, v157, v27
    v_sub_f32 v158, v158, v27
    v_sub_f32 v159, v159, v27
    v_sub_f32 v160, v160, v27
    v_sub_f32 v161, v161, v27
    v_sub_f32 v162, v162, v27
    v_sub_f32 v163, v163, v27
    v_sub_f32 v164, v164, v27
    v_sub_f32 v165, v165, v27
    v_sub_f32 v166, v166, v27
    v_sub_f32 v167, v167, v27
    v_mul_f32 v152, s24, v152
    v_mul_f32 v153, s24, v153
    v_mul_f32 v154, s24, v154
    v_mul_f32 v155, s24, v155
    v_mul_f32 v156, s24, v156
    v_mul_f32 v157, s24, v157
    v_mul_f32 v158, s24, v158
    v_mul_f32 v159, s24, v159
    v_mul_f32 v160, s24, v160
    v_mul_f32 v161, s24, v161
    v_mul_f32 v162, s24, v162
    v_mul_f32 v163, s24, v163
    v_mul_f32 v164, s24, v164
    v_mul_f32 v165, s24, v165
    v_mul_f32 v166, s24, v166
    v_mul_f32 v167, s24, v167
    v_exp_f32 v152, v152
    v_exp_f32 v153, v153
    v_exp_f32 v154, v154
    v_exp_f32 v155, v155
    v_exp_f32 v156, v156
    v_exp_f32 v157, v157
    v_exp_f32 v158, v158
    v_exp_f32 v159, v159
    v_exp_f32 v160, v160
    v_exp_f32 v161, v161
    v_exp_f32 v162, v162
    v_exp_f32 v163, v163
    v_exp_f32 v164, v164
    v_exp_f32 v165, v165
    v_exp_f32 v166, v166
    v_exp_f32 v167, v167
    v_cvt_pk_bf16_f32 v128, v152, v153
    v_cvt_pk_bf16_f32 v129, v154, v155
    v_cvt_pk_bf16_f32 v130, v156, v157
    v_cvt_pk_bf16_f32 v131, v158, v159
    v_cvt_pk_bf16_f32 v132, v160, v161
    v_cvt_pk_bf16_f32 v133, v162, v163
    v_cvt_pk_bf16_f32 v134, v164, v165
    v_cvt_pk_bf16_f32 v135, v166, v167
    v_mfma_f32_32x32x16_bf16 v[80:95], v[52:55], v[128:131], v[80:95]
    s_nop 0
    v_mfma_f32_32x32x16_bf16 v[80:95], v[56:59], v[132:135], v[80:95]
    ds_read_b128 v[44:47], v9 offset:31360
    ds_read_b64 v[48:49], v10 offset:31360
    ds_read_b64_tr_b16 v[52:53], v11 offset:31360
    ds_read_b64_tr_b16 v[54:55], v12 offset:31360
    ds_read_b64_tr_b16 v[56:57], v13 offset:31360
    ds_read_b64_tr_b16 v[58:59], v14 offset:31360
    ds_read_b64_tr_b16 v[120:121], v11 offset:6272
    ds_read_b64_tr_b16 v[122:123], v12 offset:6272
    ds_read_b64_tr_b16 v[124:125], v13 offset:6272
    ds_read_b64_tr_b16 v[126:127], v14 offset:6272
    s_waitcnt lgkmcnt(0)
    v_cvt_f32_f16 v2, v52
    v_lshlrev_b32 v3, 16, v120
    v_cmp_class_f16 vcc, v52, s25
    s_nop 1
    v_cndmask_b32 v2, v3, v2, vcc
    v_lshrrev_b32 v52, 16, v52
    v_cvt_f32_f16 v4, v52
    v_and_b32 v3, 0xffff0000, v120
    v_cmp_class_f16 vcc, v52, s25
    s_nop 1
    v_cndmask_b32 v4, v3, v4, vcc
    v_cvt_pk_bf16_f32 v52, v2, v4
    v_cvt_f32_f16 v2, v53
    v_lshlrev_b32 v3, 16, v121
    v_cmp_class_f16 vcc, v53, s25
    s_nop 1
    v_cndmask_b32 v2, v3, v2, vcc
    v_lshrrev_b32 v53, 16, v53
    v_cvt_f32_f16 v4, v53
    v_and_b32 v3, 0xffff0000, v121
    v_cmp_class_f16 vcc, v53, s25
    s_nop 1
    v_cndmask_b32 v4, v3, v4, vcc
    v_cvt_pk_bf16_f32 v53, v2, v4
    v_cvt_f32_f16 v2, v54
    v_lshlrev_b32 v3, 16, v122
    v_cmp_class_f16 vcc, v54, s25
    s_nop 1
    v_cndmask_b32 v2, v3, v2, vcc
    v_lshrrev_b32 v54, 16, v54
    v_cvt_f32_f16 v4, v54
    v_and_b32 v3, 0xffff0000, v122
    v_cmp_class_f16 vcc, v54, s25
    s_nop 1
    v_cndmask_b32 v4, v3, v4, vcc
    v_cvt_pk_bf16_f32 v54, v2, v4
    v_cvt_f32_f16 v2, v55
    v_lshlrev_b32 v3, 16, v123
    v_cmp_class_f16 vcc, v55, s25
    s_nop 1
    v_cndmask_b32 v2, v3, v2, vcc
    v_lshrrev_b32 v55, 16, v55
    v_cvt_f32_f16 v4, v55
    v_and_b32 v3, 0xffff0000, v123
    v_cmp_class_f16 vcc, v55, s25
    s_nop 1
    v_cndmask_b32 v4, v3, v4, vcc
    v_cvt_pk_bf16_f32 v55, v2, v4
    v_cvt_f32_f16 v2, v56
    v_lshlrev_b32 v3, 16, v124
    v_cmp_class_f16 vcc, v56, s25
    s_nop 1
    v_cndmask_b32 v2, v3, v2, vcc
    v_lshrrev_b32 v56, 16, v56
    v_cvt_f32_f16 v4, v56
    v_and_b32 v3, 0xffff0000, v124
    v_cmp_class_f16 vcc, v56, s25
    s_nop 1
    v_cndmask_b32 v4, v3, v4, vcc
    v_cvt_pk_bf16_f32 v56, v2, v4
    v_cvt_f32_f16 v2, v57
    v_lshlrev_b32 v3, 16, v125
    v_cmp_class_f16 vcc, v57, s25
    s_nop 1
    v_cndmask_b32 v2, v3, v2, vcc
    v_lshrrev_b32 v57, 16, v57
    v_cvt_f32_f16 v4, v57
    v_and_b32 v3, 0xffff0000, v125
    v_cmp_class_f16 vcc, v57, s25
    s_nop 1
    v_cndmask_b32 v4, v3, v4, vcc
    v_cvt_pk_bf16_f32 v57, v2, v4
    v_cvt_f32_f16 v2, v58
    v_lshlrev_b32 v3, 16, v126
    v_cmp_class_f16 vcc, v58, s25
    s_nop 1
    v_cndmask_b32 v2, v3, v2, vcc
    v_lshrrev_b32 v58, 16, v58
    v_cvt_f32_f16 v4, v58
    v_and_b32 v3, 0xffff0000, v126
    v_cmp_class_f16 vcc, v58, s25
    s_nop 1
    v_cndmask_b32 v4, v3, v4, vcc
    v_cvt_pk_bf16_f32 v58, v2, v4
    v_cvt_f32_f16 v2, v59
    v_lshlrev_b32 v3, 16, v127
    v_cmp_class_f16 vcc, v59, s25
    s_nop 1
    v_cndmask_b32 v2, v3, v2, vcc
    v_lshrrev_b32 v59, 16, v59
    v_cvt_f32_f16 v4, v59
    v_and_b32 v3, 0xffff0000, v127
    v_cmp_class_f16 vcc, v59, s25
    s_nop 1
    v_cndmask_b32 v4, v3, v4, vcc
    v_cvt_pk_bf16_f32 v59, v2, v4
    v_mfma_f32_32x32x16_bf16 v[136:151], v[44:47], v[32:35], 0
    v_mfma_f32_32x32x8_bf16 v[136:151], v[48:49], v[40:41], v[136:151]
    v_mfma_f32_32x32x16_bf16 v[152:167], v[44:47], v[36:39], 0
    v_mfma_f32_32x32x8_bf16 v[152:167], v[48:49], v[42:43], v[152:167]
    s_nop 9
    v_sub_f32 v136, v136, v26
    v_sub_f32 v137, v137, v26
    v_sub_f32 v138, v138, v26
    v_sub_f32 v139, v139, v26
    v_sub_f32 v140, v140, v26
    v_sub_f32 v141, v141, v26
    v_sub_f32 v142, v142, v26
    v_sub_f32 v143, v143, v26
    v_sub_f32 v144, v144, v26
    v_sub_f32 v145, v145, v26
    v_sub_f32 v146, v146, v26
    v_sub_f32 v147, v147, v26
    v_sub_f32 v148, v148, v26
    v_sub_f32 v149, v149, v26
    v_sub_f32 v150, v150, v26
    v_sub_f32 v151, v151, v26
    v_mul_f32 v136, s24, v136
    v_mul_f32 v137, s24, v137
    v_mul_f32 v138, s24, v138
    v_mul_f32 v139, s24, v139
    v_mul_f32 v140, s24, v140
    v_mul_f32 v141, s24, v141
    v_mul_f32 v142, s24, v142
    v_mul_f32 v143, s24, v143
    v_mul_f32 v144, s24, v144
    v_mul_f32 v145, s24, v145
    v_mul_f32 v146, s24, v146
    v_mul_f32 v147, s24, v147
    v_mul_f32 v148, s24, v148
    v_mul_f32 v149, s24, v149
    v_mul_f32 v150, s24, v150
    v_mul_f32 v151, s24, v151
    v_exp_f32 v136, v136
    v_exp_f32 v137, v137
    v_exp_f32 v138, v138
    v_exp_f32 v139, v139
    v_exp_f32 v140, v140
    v_exp_f32 v141, v141
    v_exp_f32 v142, v142
    v_exp_f32 v143, v143
    v_exp_f32 v144, v144
    v_exp_f32 v145, v145
    v_exp_f32 v146, v146
    v_exp_f32 v147, v147
    v_exp_f32 v148, v148
    v_exp_f32 v149, v149
    v_exp_f32 v150, v150
    v_exp_f32 v151, v151
    v_cvt_pk_bf16_f32 v120, v136, v137
    v_cvt_pk_bf16_f32 v121, v138, v139
    v_cvt_pk_bf16_f32 v122, v140, v141
    v_cvt_pk_bf16_f32 v123, v142, v143
    v_cvt_pk_bf16_f32 v124, v144, v145
    v_cvt_pk_bf16_f32 v125, v146, v147
    v_cvt_pk_bf16_f32 v126, v148, v149
    v_cvt_pk_bf16_f32 v127, v150, v151
    v_mfma_f32_32x32x16_bf16 v[64:79], v[52:55], v[120:123], v[64:79]
    s_nop 0
    v_mfma_f32_32x32x16_bf16 v[64:79], v[56:59], v[124:127], v[64:79]
    v_sub_f32 v152, v152, v27
    v_sub_f32 v153, v153, v27
    v_sub_f32 v154, v154, v27
    v_sub_f32 v155, v155, v27
    v_sub_f32 v156, v156, v27
    v_sub_f32 v157, v157, v27
    v_sub_f32 v158, v158, v27
    v_sub_f32 v159, v159, v27
    v_sub_f32 v160, v160, v27
    v_sub_f32 v161, v161, v27
    v_sub_f32 v162, v162, v27
    v_sub_f32 v163, v163, v27
    v_sub_f32 v164, v164, v27
    v_sub_f32 v165, v165, v27
    v_sub_f32 v166, v166, v27
    v_sub_f32 v167, v167, v27
    v_mul_f32 v152, s24, v152
    v_mul_f32 v153, s24, v153
    v_mul_f32 v154, s24, v154
    v_mul_f32 v155, s24, v155
    v_mul_f32 v156, s24, v156
    v_mul_f32 v157, s24, v157
    v_mul_f32 v158, s24, v158
    v_mul_f32 v159, s24, v159
    v_mul_f32 v160, s24, v160
    v_mul_f32 v161, s24, v161
    v_mul_f32 v162, s24, v162
    v_mul_f32 v163, s24, v163
    v_mul_f32 v164, s24, v164
    v_mul_f32 v165, s24, v165
    v_mul_f32 v166, s24, v166
    v_mul_f32 v167, s24, v167
    v_exp_f32 v152, v152
    v_exp_f32 v153, v153
    v_exp_f32 v154, v154
    v_exp_f32 v155, v155
    v_exp_f32 v156, v156
    v_exp_f32 v157, v157
    v_exp_f32 v158, v158
    v_exp_f32 v159, v159
    v_exp_f32 v160, v160
    v_exp_f32 v161, v161
    v_exp_f32 v162, v162
    v_exp_f32 v163, v163
    v_exp_f32 v164, v164
    v_exp_f32 v165, v165
    v_exp_f32 v166, v166
    v_exp_f32 v167, v167
    v_cvt_pk_bf16_f32 v128, v152, v153
    v_cvt_pk_bf16_f32 v129, v154, v155
    v_cvt_pk_bf16_f32 v130, v156, v157
    v_cvt_pk_bf16_f32 v131, v158, v159
    v_cvt_pk_bf16_f32 v132, v160, v161
    v_cvt_pk_bf16_f32 v133, v162, v163
    v_cvt_pk_bf16_f32 v134, v164, v165
    v_cvt_pk_bf16_f32 v135, v166, v167
    v_mfma_f32_32x32x16_bf16 v[80:95], v[52:55], v[128:131], v[80:95]
    s_nop 0
    v_mfma_f32_32x32x16_bf16 v[80:95], v[56:59], v[132:135], v[80:95]
    ds_read_b128 v[44:47], v9 offset:34496
    ds_read_b64 v[48:49], v10 offset:34496
    ds_read_b64_tr_b16 v[52:53], v11 offset:34496
    ds_read_b64_tr_b16 v[54:55], v12 offset:34496
    ds_read_b64_tr_b16 v[56:57], v13 offset:34496
    ds_read_b64_tr_b16 v[58:59], v14 offset:34496
    ds_read_b64_tr_b16 v[120:121], v11 offset:9408
    ds_read_b64_tr_b16 v[122:123], v12 offset:9408
    ds_read_b64_tr_b16 v[124:125], v13 offset:9408
    ds_read_b64_tr_b16 v[126:127], v14 offset:9408
    s_waitcnt lgkmcnt(0)
    v_cvt_f32_f16 v2, v52
    v_lshlrev_b32 v3, 16, v120
    v_cmp_class_f16 vcc, v52, s25
    s_nop 1
    v_cndmask_b32 v2, v3, v2, vcc
    v_lshrrev_b32 v52, 16, v52
    v_cvt_f32_f16 v4, v52
    v_and_b32 v3, 0xffff0000, v120
    v_cmp_class_f16 vcc, v52, s25
    s_nop 1
    v_cndmask_b32 v4, v3, v4, vcc
    v_cvt_pk_bf16_f32 v52, v2, v4
    v_cvt_f32_f16 v2, v53
    v_lshlrev_b32 v3, 16, v121
    v_cmp_class_f16 vcc, v53, s25
    s_nop 1
    v_cndmask_b32 v2, v3, v2, vcc
    v_lshrrev_b32 v53, 16, v53
    v_cvt_f32_f16 v4, v53
    v_and_b32 v3, 0xffff0000, v121
    v_cmp_class_f16 vcc, v53, s25
    s_nop 1
    v_cndmask_b32 v4, v3, v4, vcc
    v_cvt_pk_bf16_f32 v53, v2, v4
    v_cvt_f32_f16 v2, v54
    v_lshlrev_b32 v3, 16, v122
    v_cmp_class_f16 vcc, v54, s25
    s_nop 1
    v_cndmask_b32 v2, v3, v2, vcc
    v_lshrrev_b32 v54, 16, v54
    v_cvt_f32_f16 v4, v54
    v_and_b32 v3, 0xffff0000, v122
    v_cmp_class_f16 vcc, v54, s25
    s_nop 1
    v_cndmask_b32 v4, v3, v4, vcc
    v_cvt_pk_bf16_f32 v54, v2, v4
    v_cvt_f32_f16 v2, v55
    v_lshlrev_b32 v3, 16, v123
    v_cmp_class_f16 vcc, v55, s25
    s_nop 1
    v_cndmask_b32 v2, v3, v2, vcc
    v_lshrrev_b32 v55, 16, v55
    v_cvt_f32_f16 v4, v55
    v_and_b32 v3, 0xffff0000, v123
    v_cmp_class_f16 vcc, v55, s25
    s_nop 1
    v_cndmask_b32 v4, v3, v4, vcc
    v_cvt_pk_bf16_f32 v55, v2, v4
    v_cvt_f32_f16 v2, v56
    v_lshlrev_b32 v3, 16, v124
    v_cmp_class_f16 vcc, v56, s25
    s_nop 1
    v_cndmask_b32 v2, v3, v2, vcc
    v_lshrrev_b32 v56, 16, v56
    v_cvt_f32_f16 v4, v56
    v_and_b32 v3, 0xffff0000, v124
    v_cmp_class_f16 vcc, v56, s25
    s_nop 1
    v_cndmask_b32 v4, v3, v4, vcc
    v_cvt_pk_bf16_f32 v56, v2, v4
    v_cvt_f32_f16 v2, v57
    v_lshlrev_b32 v3, 16, v125
    v_cmp_class_f16 vcc, v57, s25
    s_nop 1
    v_cndmask_b32 v2, v3, v2, vcc
    v_lshrrev_b32 v57, 16, v57
    v_cvt_f32_f16 v4, v57
    v_and_b32 v3, 0xffff0000, v125
    v_cmp_class_f16 vcc, v57, s25
    s_nop 1
    v_cndmask_b32 v4, v3, v4, vcc
    v_cvt_pk_bf16_f32 v57, v2, v4
    v_cvt_f32_f16 v2, v58
    v_lshlrev_b32 v3, 16, v126
    v_cmp_class_f16 vcc, v58, s25
    s_nop 1
    v_cndmask_b32 v2, v3, v2, vcc
    v_lshrrev_b32 v58, 16, v58
    v_cvt_f32_f16 v4, v58
    v_and_b32 v3, 0xffff0000, v126
    v_cmp_class_f16 vcc, v58, s25
    s_nop 1
    v_cndmask_b32 v4, v3, v4, vcc
    v_cvt_pk_bf16_f32 v58, v2, v4
    v_cvt_f32_f16 v2, v59
    v_lshlrev_b32 v3, 16, v127
    v_cmp_class_f16 vcc, v59, s25
    s_nop 1
    v_cndmask_b32 v2, v3, v2, vcc
    v_lshrrev_b32 v59, 16, v59
    v_cvt_f32_f16 v4, v59
    v_and_b32 v3, 0xffff0000, v127
    v_cmp_class_f16 vcc, v59, s25
    s_nop 1
    v_cndmask_b32 v4, v3, v4, vcc
    v_cvt_pk_bf16_f32 v59, v2, v4
    v_mfma_f32_32x32x16_bf16 v[136:151], v[44:47], v[32:35], 0
    v_mfma_f32_32x32x8_bf16 v[136:151], v[48:49], v[40:41], v[136:151]
    v_mfma_f32_32x32x16_bf16 v[152:167], v[44:47], v[36:39], 0
    v_mfma_f32_32x32x8_bf16 v[152:167], v[48:49], v[42:43], v[152:167]
    s_nop 9
    v_sub_f32 v136, v136, v26
    v_sub_f32 v137, v137, v26
    v_sub_f32 v138, v138, v26
    v_sub_f32 v139, v139, v26
    v_sub_f32 v140, v140, v26
    v_sub_f32 v141, v141, v26
    v_sub_f32 v142, v142, v26
    v_sub_f32 v143, v143, v26
    v_sub_f32 v144, v144, v26
    v_sub_f32 v145, v145, v26
    v_sub_f32 v146, v146, v26
    v_sub_f32 v147, v147, v26
    v_sub_f32 v148, v148, v26
    v_sub_f32 v149, v149, v26
    v_sub_f32 v150, v150, v26
    v_sub_f32 v151, v151, v26
    v_mul_f32 v136, s24, v136
    v_mul_f32 v137, s24, v137
    v_mul_f32 v138, s24, v138
    v_mul_f32 v139, s24, v139
    v_mul_f32 v140, s24, v140
    v_mul_f32 v141, s24, v141
    v_mul_f32 v142, s24, v142
    v_mul_f32 v143, s24, v143
    v_mul_f32 v144, s24, v144
    v_mul_f32 v145, s24, v145
    v_mul_f32 v146, s24, v146
    v_mul_f32 v147, s24, v147
    v_mul_f32 v148, s24, v148
    v_mul_f32 v149, s24, v149
    v_mul_f32 v150, s24, v150
    v_mul_f32 v151, s24, v151
    v_exp_f32 v136, v136
    v_exp_f32 v137, v137
    v_exp_f32 v138, v138
    v_exp_f32 v139, v139
    v_exp_f32 v140, v140
    v_exp_f32 v141, v141
    v_exp_f32 v142, v142
    v_exp_f32 v143, v143
    v_exp_f32 v144, v144
    v_exp_f32 v145, v145
    v_exp_f32 v146, v146
    v_exp_f32 v147, v147
    v_exp_f32 v148, v148
    v_exp_f32 v149, v149
    v_exp_f32 v150, v150
    v_exp_f32 v151, v151
    v_cvt_pk_bf16_f32 v120, v136, v137
    v_cvt_pk_bf16_f32 v121, v138, v139
    v_cvt_pk_bf16_f32 v122, v140, v141
    v_cvt_pk_bf16_f32 v123, v142, v143
    v_cvt_pk_bf16_f32 v124, v144, v145
    v_cvt_pk_bf16_f32 v125, v146, v147
    v_cvt_pk_bf16_f32 v126, v148, v149
    v_cvt_pk_bf16_f32 v127, v150, v151
    v_mfma_f32_32x32x16_bf16 v[64:79], v[52:55], v[120:123], v[64:79]
    s_nop 0
    v_mfma_f32_32x32x16_bf16 v[64:79], v[56:59], v[124:127], v[64:79]
    v_sub_f32 v152, v152, v27
    v_sub_f32 v153, v153, v27
    v_sub_f32 v154, v154, v27
    v_sub_f32 v155, v155, v27
    v_sub_f32 v156, v156, v27
    v_sub_f32 v157, v157, v27
    v_sub_f32 v158, v158, v27
    v_sub_f32 v159, v159, v27
    v_sub_f32 v160, v160, v27
    v_sub_f32 v161, v161, v27
    v_sub_f32 v162, v162, v27
    v_sub_f32 v163, v163, v27
    v_sub_f32 v164, v164, v27
    v_sub_f32 v165, v165, v27
    v_sub_f32 v166, v166, v27
    v_sub_f32 v167, v167, v27
    v_mul_f32 v152, s24, v152
    v_mul_f32 v153, s24, v153
    v_mul_f32 v154, s24, v154
    v_mul_f32 v155, s24, v155
    v_mul_f32 v156, s24, v156
    v_mul_f32 v157, s24, v157
    v_mul_f32 v158, s24, v158
    v_mul_f32 v159, s24, v159
    v_mul_f32 v160, s24, v160
    v_mul_f32 v161, s24, v161
    v_mul_f32 v162, s24, v162
    v_mul_f32 v163, s24, v163
    v_mul_f32 v164, s24, v164
    v_mul_f32 v165, s24, v165
    v_mul_f32 v166, s24, v166
    v_mul_f32 v167, s24, v167
    v_exp_f32 v152, v152
    v_exp_f32 v153, v153
    v_exp_f32 v154, v154
    v_exp_f32 v155, v155
    v_exp_f32 v156, v156
    v_exp_f32 v157, v157
    v_exp_f32 v158, v158
    v_exp_f32 v159, v159
    v_exp_f32 v160, v160
    v_exp_f32 v161, v161
    v_exp_f32 v162, v162
    v_exp_f32 v163, v163
    v_exp_f32 v164, v164
    v_exp_f32 v165, v165
    v_exp_f32 v166, v166
    v_exp_f32 v167, v167
    v_cvt_pk_bf16_f32 v128, v152, v153
    v_cvt_pk_bf16_f32 v129, v154, v155
    v_cvt_pk_bf16_f32 v130, v156, v157
    v_cvt_pk_bf16_f32 v131, v158, v159
    v_cvt_pk_bf16_f32 v132, v160, v161
    v_cvt_pk_bf16_f32 v133, v162, v163
    v_cvt_pk_bf16_f32 v134, v164, v165
    v_cvt_pk_bf16_f32 v135, v166, v167
    v_mfma_f32_32x32x16_bf16 v[80:95], v[52:55], v[128:131], v[80:95]
    s_nop 0
    v_mfma_f32_32x32x16_bf16 v[80:95], v[56:59], v[132:135], v[80:95]
    s_add_u32 s12, s12, 1
    s_cmp_lt_u32 s12, 8
    s_cbranch_scc1 L_k2_ex
    s_barrier
    ds_write_b128 v16, v[64:67] offset:0
    ds_write_b128 v16, v[68:71] offset:1024
    ds_write_b128 v16, v[72:75] offset:2048
    v_or_b32 v76, 1, v76
    ds_write_b32 v18, v76
    s_branch L_k2_mg
.section .rodata,"a"
.p2align 6
.amdhsa_kernel k1_kernel
  .amdhsa_next_free_vgpr 168
  .amdhsa_next_free_sgpr 102
  .amdhsa_accum_offset 168
  .amdhsa_group_segment_fixed_size 0
  .amdhsa_kernarg_size 88
  .amdhsa_user_sgpr_count 2
  .amdhsa_user_sgpr_kernarg_segment_ptr 1
  .amdhsa_system_sgpr_workgroup_id_x 1
.end_amdhsa_kernel
```
